```python
import torch

def _softmax(x, axis=-1):
    return torch.softmax(x, dim=axis)
def _gelu(x):
    return torch.nn.functional.gelu(x, approximate="tanh")
def _silu(x):
    return torch.nn.functional.silu(x)
def _sigmoid(x):
    return torch.sigmoid(x)
def _layernorm(x, axis=-1, eps=1e-5):
    m = x.mean(dim=axis, keepdim=True)
    v = x.var(dim=axis, keepdim=True, unbiased=False)
    return (x - m) / torch.sqrt(v + eps)
def _scatter_add(tgt, idx, src, axis=0):
    return tgt.clone().index_add_(axis, idx, src)
def _segment_sum(src, seg, n):
    out = torch.zeros((n,) + src.shape[1:], dtype=src.dtype)
    return out.index_add_(0, seg, src)
def _pad(x, pw):
    flat = tuple(v for pair in reversed(pw) for v in pair)
    return torch.nn.functional.pad(x, flat)

kernel_name = 'sequential_preLN__spectral_gfnet__mixer_s_mlp__prompt'

def setup_inputs():

    _w = (lambda a: (lambda t: t.to(torch.bfloat16) if t.is_floating_point() else t)(torch.as_tensor(a)))
    def _A_setup():
        B, S, D = 1, 2048, 576
        Df = D // 2 + 1
        return {
            "x": _w((lambda *s: torch.randn(*s, dtype=torch.bfloat16) * 0.05)(B, S, D)),
            "w_r": _w((lambda *s: torch.randn(*s, dtype=torch.bfloat16) * 0.4)(S, Df) * 0.02),
            "w_i": _w((lambda *s: torch.randn(*s, dtype=torch.bfloat16) * 0.4)(S, Df) * 0.02),
        }
    _A_in = _A_setup()

    def _B_setup():
        B, S, D, F = 1, 2048, 576, 4608
        return {
            "x":  _w((lambda *s: torch.randn(*s, dtype=torch.bfloat16) * 0.05)(B, S, D)),
            "w1": _w((lambda *s: torch.randn(*s, dtype=torch.bfloat16) * 0.8)(D, D) * (D ** -0.5)),
            "w2": _w((lambda *s: torch.randn(*s, dtype=torch.bfloat16) * 0.8)(D, D) * (D ** -0.5)),
            "w3": _w((lambda *s: torch.randn(*s, dtype=torch.bfloat16) * 0.8)(D, F) * (D ** -0.5)),
            "w4": _w((lambda *s: torch.randn(*s, dtype=torch.bfloat16) * 0.8)(F, D) * (F ** -0.5)),
        }
    _B_in = _B_setup()

    return {
        "A_x": _A_in["x"],
        "A_w_r": _A_in["w_r"],
        "A_w_i": _A_in["w_i"],
        "B_x": _B_in["x"],
        "B_w1": _B_in["w1"],
        "B_w2": _B_in["w2"],
        "B_w3": _B_in["w3"],
        "B_w4": _B_in["w4"],
    }

def reference(A_x, A_w_r, A_w_i, B_x, B_w1, B_w2, B_w3, B_w4):
    def _A_ref(x, w_r, w_i):
        B, S, D = x.shape
        X = (lambda x, axes=(-2,-1): torch.fft.rfft2(x.float(), dim=axes))(x, axes=(-2, -1))
        W = w_r + 1j * w_i
        X = X * W
        y = (lambda x, s, axes=(-2,-1): torch.fft.irfft2(x, s=s, dim=axes).to(torch.bfloat16))(X, (S, D), axes=(-2, -1))
        return y

    def _B_ref(x, w1, w2, w3, w4):
        B, S, D = x.shape
        h = _gelu(_layernorm(x, axis=-1) @ w1)
        c = D // 4
        g0 = _pad(h[:, :, 0*c:1*c], ((0, 0), (1, 0), (0, 0)))[:, :S, :]
        g1 = _pad(h[:, :, 1*c:2*c], ((0, 0), (0, 1), (0, 0)))[:, 1:, :]
        g2 = _pad(h[:, :, 2*c:3*c], ((0, 0), (2, 0), (0, 0)))[:, :S, :]
        g3 = _pad(h[:, :, 3*c:   ], ((0, 0), (0, 2), (0, 0)))[:, 2:, :]
        hs = torch.concatenate([g0, g1, g2, g3], axis=-1) @ w2
        x1 = x + hs
        h2 = _gelu(_layernorm(x1, axis=-1) @ w3) @ w4
        return x1 + h2

    x = A_x
    h = x + _A_ref(_layernorm(x, axis=-1), A_w_r, A_w_i)
    h2 = h + _B_ref(_layernorm(h, axis=-1), B_w1, B_w2, B_w3, B_w4)
    return h2
```

```asm
; @launch grid=(256,1,1) block=(768,1,1) lds=150560
.amdgcn_target "amdgcn-amd-amdhsa--gfx950"
.text
.p2align 8
CODE_START:
.globl sequential_preLN__spectral_gfnet__mixer_s_mlp__prompt_kernel
.p2align 8
.type sequential_preLN__spectral_gfnet__mixer_s_mlp__prompt_kernel,@function
sequential_preLN__spectral_gfnet__mixer_s_mlp__prompt_kernel:

    s_setprio 3
    s_load_dwordx4 s[40:43], s[0:1], 0
    s_load_dwordx2 s[44:45], s[0:1], 16
    s_load_dwordx2 s[12:13], s[0:1], 80
    s_mov_b32 s14, 0x322e000
    s_mov_b32 s15, 0x20000
    s_mov_b32 s10, 0x240000
    s_mov_b32 s11, 0x20000
    s_load_dwordx2 s[4:5], s[0:1], 72
    s_mov_b32 s6, 0x100
    s_mov_b32 s7, 0x20000
    v_lshrrev_b32 v1, 6, v0
    s_nop 0
    v_readfirstlane_b32 s3, v1
    v_and_b32 v0, 63, v0
    s_cmp_lt_u32 s3, 9
    s_cbranch_scc1 Lq_1
    s_getpc_b64 s[46:47]
Lpc_2:
    s_sub_u32 s46, s46, Lpc_2-CODE_START
    s_subb_u32 s47, s47, 0
    s_sub_u32 s48, s3, 9
    s_lshl_b32 s48, s48, 12
    v_lshlrev_b32 v97, 6, v0
    v_add_u32 v97, s48, v97
    global_load_dword v97, v97, s[46:47]
Lq_1:
    s_cmp_ge_u32 s2, 192
    s_cbranch_scc1 K1_side
    s_and_b32 s16, s2, 7
    s_bfe_u32 s18, s2, 0x30003
    s_lshr_b32 s19, s2, 6
    s_lshr_b32 s17, s16, 2
    s_lshl_b32 s17, s17, 5
    s_and_b32 s20, s16, 3
    s_lshl_b32 s20, s20, 2
    s_add_u32 s17, s17, s20
    s_lshl_b32 s17, s17, 5
    s_lshl_b32 s20, s18, 2
    s_add_u32 s17, s17, s20
    s_mul_i32 s20, s17, 1152
    s_lshl_b32 s21, s3, 6
    s_add_u32 s20, s20, s21
    s_add_u32 s21, s20, 589824
    v_lshrrev_b32 v1, 2, v0
    v_and_b32 v2, 3, v0
    v_and_b32 v4, 3, v1
    v_lshlrev_b32 v4, 5, v4
    v_lshrrev_b32 v6, 4, v0
    v_add_u32 v6, v4, v6
    v_mul_u32_u24 v4, 1152, v6
    v_lshl_add_u32 v4, v2, 4, v4
    s_cmp_ge_u32 s3, 9
    s_cbranch_scc1 Lnox_3
    s_waitcnt lgkmcnt(0)
    s_mov_b32 s8, s40
    s_mov_b32 s9, s41
    buffer_load_dwordx4 v[8:11], v4, s[8:11], s20 offen offset:0
    buffer_load_dwordx4 v[12:15], v4, s[8:11], s20 offen offset:576
    buffer_load_dwordx4 v[16:19], v4, s[8:11], s21 offen offset:0
    buffer_load_dwordx4 v[20:23], v4, s[8:11], s21 offen offset:576
Lnox_3:
    s_lshr_b32 s23, s2, 3
    s_mul_i32 s23, s23, 12
    s_add_u32 s23, s23, s3
    s_setprio 0
    s_mul_i32 s22, s19, 12
    s_add_u32 s22, s22, s3
    s_lshl_b32 s24, s22, 4
    s_cmp_lt_u32 s22, 18
    s_cselect_b32 s25, 2, -287
    s_add_i32 s24, s24, s25
    v_and_b32 v60, 14, v0
    v_add_u32 v60, s24, v60
    v_cvt_f32_u32 v76, v60
    v_mul_f32 v76, 0x3ae38e39, v76
    v_cmp_eq_u32 vcc, 288, v60
    v_mov_b32 v80, 0x3d715bef
    v_mov_b32 v61, 0x3d2aaaab
    v_cndmask_b32 v80, v80, v61, vcc
    v_and_b32 v60, 1, v0
    v_cvt_f32_u32 v60, v60
    v_mul_f32 v78, 0x3e800000, v60
    v_lshrrev_b32 v60, 4, v0
    v_lshlrev_b32 v60, 3, v60
    v_cvt_f32_u32 v60, v60
    v_fmac_f32 v78, v60, v76
    s_waitcnt lgkmcnt(0)
    s_mul_i32 s37, s23, 7282
    s_lshr_b32 s37, s37, 16
    s_mul_i32 s38, s37, 9
    s_sub_u32 s38, s23, s38
    s_and_b32 s36, s16, 3
    s_lshl_b32 s36, s36, 4
    s_lshr_b32 s39, s16, 2
    s_lshl_b32 s39, s39, 10
    s_add_u32 s36, s36, s39
    s_and_b32 s39, s37, 15
    s_lshl_b32 s39, s39, 6
    s_add_u32 s36, s36, s39
    s_mul_i32 s36, s36, 578
    s_lshl_b32 s38, s38, 10
    s_add_u32 s36, s36, s38
    s_lshr_b32 s37, s37, 1
    v_lshlrev_b32 v7, 4, v0
    s_cmp_ge_u32 s37, 8
    s_cselect_b32 s40, s44, s42
    s_cselect_b32 s41, s45, s43
    s_mov_b32 s42, 1183744
    s_mov_b32 s43, 0x20000
    buffer_load_dword v100, v7, s[40:43], s36 offen
    s_getpc_b64 s[68:69]
Lpc_4:
    s_sub_u32 s68, s68, Lpc_4-CODE_START
    s_subb_u32 s69, s69, 0
    s_lshl_b32 s70, s23, 8
    s_min_u32 s70, s70, CODE_END-CODE_START-256
    s_add_u32 s68, s68, s70
    s_addc_u32 s69, s69, 0
    s_load_dword s71, s[68:69], 0
    s_load_dword s72, s[68:69], 128
    s_load_dword s71, s[68:69], 64
    s_load_dword s72, s[68:69], 192
    s_mov_b32 s24, 0x00000000
    s_mov_b32 s25, 0x3f800000
    v_pk_fma_f32 v[60:61], v[76:77], s[24:25], v[78:79] op_sel_hi:[0,1,0]
    s_mov_b32 s24, 0x40000000
    s_mov_b32 s25, 0x40400000
    v_pk_fma_f32 v[62:63], v[76:77], s[24:25], v[78:79] op_sel_hi:[0,1,0]
    s_mov_b32 s24, 0x40800000
    s_mov_b32 s25, 0x40a00000
    v_pk_fma_f32 v[64:65], v[76:77], s[24:25], v[78:79] op_sel_hi:[0,1,0]
    s_mov_b32 s24, 0x40c00000
    s_mov_b32 s25, 0x40e00000
    v_pk_fma_f32 v[66:67], v[76:77], s[24:25], v[78:79] op_sel_hi:[0,1,0]
    v_mul_f32 v78, 0x42000000, v76
    v_pk_add_f32 v[68:69], v[60:61], v[78:79] op_sel_hi:[1,0]
    v_pk_add_f32 v[70:71], v[62:63], v[78:79] op_sel_hi:[1,0]
    v_pk_add_f32 v[72:73], v[64:65], v[78:79] op_sel_hi:[1,0]
    v_pk_add_f32 v[74:75], v[66:67], v[78:79] op_sel_hi:[1,0]
    v_cos_f32 v78, v78
    v_cos_f32 v60, v60
    v_cos_f32 v61, v61
    v_cos_f32 v62, v62
    v_cos_f32 v63, v63
    v_cos_f32 v64, v64
    v_cos_f32 v65, v65
    v_cos_f32 v66, v66
    v_cos_f32 v67, v67
    v_cos_f32 v68, v68
    v_cos_f32 v69, v69
    v_cos_f32 v70, v70
    v_cos_f32 v71, v71
    v_cos_f32 v72, v72
    v_cos_f32 v73, v73
    v_cos_f32 v74, v74
    v_cos_f32 v75, v75
    v_add_f32 v78, v78, v78
    v_pk_mul_f32 v[60:61], v[60:61], v[80:81] op_sel_hi:[1,0]
    v_pk_mul_f32 v[62:63], v[62:63], v[80:81] op_sel_hi:[1,0]
    v_pk_mul_f32 v[64:65], v[64:65], v[80:81] op_sel_hi:[1,0]
    v_pk_mul_f32 v[66:67], v[66:67], v[80:81] op_sel_hi:[1,0]
    v_pk_mul_f32 v[68:69], v[68:69], v[80:81] op_sel_hi:[1,0]
    v_pk_mul_f32 v[70:71], v[70:71], v[80:81] op_sel_hi:[1,0]
    v_pk_mul_f32 v[72:73], v[72:73], v[80:81] op_sel_hi:[1,0]
    v_pk_mul_f32 v[74:75], v[74:75], v[80:81] op_sel_hi:[1,0]
    v_cvt_pk_bf16_f32 v24, v60, v61
    v_cvt_pk_bf16_f32 v25, v62, v63
    v_cvt_pk_bf16_f32 v26, v64, v65
    v_cvt_pk_bf16_f32 v27, v66, v67
    v_cvt_pk_bf16_f32 v28, v68, v69
    v_cvt_pk_bf16_f32 v29, v70, v71
    v_cvt_pk_bf16_f32 v30, v72, v73
    v_cvt_pk_bf16_f32 v31, v74, v75
    v_pk_fma_f32 v[60:61], v[68:69], v[78:79], v[60:61] op_sel_hi:[1,0,1] neg_lo:[0,0,1] neg_hi:[0,0,1]
    v_pk_fma_f32 v[62:63], v[70:71], v[78:79], v[62:63] op_sel_hi:[1,0,1] neg_lo:[0,0,1] neg_hi:[0,0,1]
    v_pk_fma_f32 v[64:65], v[72:73], v[78:79], v[64:65] op_sel_hi:[1,0,1] neg_lo:[0,0,1] neg_hi:[0,0,1]
    v_pk_fma_f32 v[66:67], v[74:75], v[78:79], v[66:67] op_sel_hi:[1,0,1] neg_lo:[0,0,1] neg_hi:[0,0,1]
    v_cvt_pk_bf16_f32 v32, v60, v61
    v_cvt_pk_bf16_f32 v33, v62, v63
    v_cvt_pk_bf16_f32 v34, v64, v65
    v_cvt_pk_bf16_f32 v35, v66, v67
    v_pk_fma_f32 v[68:69], v[60:61], v[78:79], v[68:69] op_sel_hi:[1,0,1] neg_lo:[0,0,1] neg_hi:[0,0,1]
    v_pk_fma_f32 v[70:71], v[62:63], v[78:79], v[70:71] op_sel_hi:[1,0,1] neg_lo:[0,0,1] neg_hi:[0,0,1]
    v_pk_fma_f32 v[72:73], v[64:65], v[78:79], v[72:73] op_sel_hi:[1,0,1] neg_lo:[0,0,1] neg_hi:[0,0,1]
    v_pk_fma_f32 v[74:75], v[66:67], v[78:79], v[74:75] op_sel_hi:[1,0,1] neg_lo:[0,0,1] neg_hi:[0,0,1]
    v_cvt_pk_bf16_f32 v36, v68, v69
    v_cvt_pk_bf16_f32 v37, v70, v71
    v_cvt_pk_bf16_f32 v38, v72, v73
    v_cvt_pk_bf16_f32 v39, v74, v75
    v_pk_fma_f32 v[60:61], v[68:69], v[78:79], v[60:61] op_sel_hi:[1,0,1] neg_lo:[0,0,1] neg_hi:[0,0,1]
    v_pk_fma_f32 v[62:63], v[70:71], v[78:79], v[62:63] op_sel_hi:[1,0,1] neg_lo:[0,0,1] neg_hi:[0,0,1]
    v_pk_fma_f32 v[64:65], v[72:73], v[78:79], v[64:65] op_sel_hi:[1,0,1] neg_lo:[0,0,1] neg_hi:[0,0,1]
    v_pk_fma_f32 v[66:67], v[74:75], v[78:79], v[66:67] op_sel_hi:[1,0,1] neg_lo:[0,0,1] neg_hi:[0,0,1]
    v_cvt_pk_bf16_f32 v40, v60, v61
    v_cvt_pk_bf16_f32 v41, v62, v63
    v_cvt_pk_bf16_f32 v42, v64, v65
    v_cvt_pk_bf16_f32 v43, v66, v67
    v_pk_fma_f32 v[68:69], v[60:61], v[78:79], v[68:69] op_sel_hi:[1,0,1] neg_lo:[0,0,1] neg_hi:[0,0,1]
    v_pk_fma_f32 v[70:71], v[62:63], v[78:79], v[70:71] op_sel_hi:[1,0,1] neg_lo:[0,0,1] neg_hi:[0,0,1]
    v_pk_fma_f32 v[72:73], v[64:65], v[78:79], v[72:73] op_sel_hi:[1,0,1] neg_lo:[0,0,1] neg_hi:[0,0,1]
    v_pk_fma_f32 v[74:75], v[66:67], v[78:79], v[74:75] op_sel_hi:[1,0,1] neg_lo:[0,0,1] neg_hi:[0,0,1]
    v_cvt_pk_bf16_f32 v44, v68, v69
    v_cvt_pk_bf16_f32 v45, v70, v71
    v_cvt_pk_bf16_f32 v46, v72, v73
    v_cvt_pk_bf16_f32 v47, v74, v75
    v_pk_fma_f32 v[60:61], v[68:69], v[78:79], v[60:61] op_sel_hi:[1,0,1] neg_lo:[0,0,1] neg_hi:[0,0,1]
    v_pk_fma_f32 v[62:63], v[70:71], v[78:79], v[62:63] op_sel_hi:[1,0,1] neg_lo:[0,0,1] neg_hi:[0,0,1]
    v_pk_fma_f32 v[64:65], v[72:73], v[78:79], v[64:65] op_sel_hi:[1,0,1] neg_lo:[0,0,1] neg_hi:[0,0,1]
    v_pk_fma_f32 v[66:67], v[74:75], v[78:79], v[66:67] op_sel_hi:[1,0,1] neg_lo:[0,0,1] neg_hi:[0,0,1]
    v_cvt_pk_bf16_f32 v48, v60, v61
    v_cvt_pk_bf16_f32 v49, v62, v63
    v_cvt_pk_bf16_f32 v50, v64, v65
    v_cvt_pk_bf16_f32 v51, v66, v67
    v_pk_fma_f32 v[68:69], v[60:61], v[78:79], v[68:69] op_sel_hi:[1,0,1] neg_lo:[0,0,1] neg_hi:[0,0,1]
    v_pk_fma_f32 v[70:71], v[62:63], v[78:79], v[70:71] op_sel_hi:[1,0,1] neg_lo:[0,0,1] neg_hi:[0,0,1]
    v_pk_fma_f32 v[72:73], v[64:65], v[78:79], v[72:73] op_sel_hi:[1,0,1] neg_lo:[0,0,1] neg_hi:[0,0,1]
    v_pk_fma_f32 v[74:75], v[66:67], v[78:79], v[74:75] op_sel_hi:[1,0,1] neg_lo:[0,0,1] neg_hi:[0,0,1]
    v_cvt_pk_bf16_f32 v52, v68, v69
    v_cvt_pk_bf16_f32 v53, v70, v71
    v_cvt_pk_bf16_f32 v54, v72, v73
    v_cvt_pk_bf16_f32 v55, v74, v75
    v_pk_fma_f32 v[60:61], v[68:69], v[78:79], v[60:61] op_sel_hi:[1,0,1] neg_lo:[0,0,1] neg_hi:[0,0,1]
    v_pk_fma_f32 v[62:63], v[70:71], v[78:79], v[62:63] op_sel_hi:[1,0,1] neg_lo:[0,0,1] neg_hi:[0,0,1]
    v_pk_fma_f32 v[64:65], v[72:73], v[78:79], v[64:65] op_sel_hi:[1,0,1] neg_lo:[0,0,1] neg_hi:[0,0,1]
    v_pk_fma_f32 v[66:67], v[74:75], v[78:79], v[66:67] op_sel_hi:[1,0,1] neg_lo:[0,0,1] neg_hi:[0,0,1]
    v_cvt_pk_bf16_f32 v56, v60, v61
    v_cvt_pk_bf16_f32 v57, v62, v63
    v_cvt_pk_bf16_f32 v58, v64, v65
    v_cvt_pk_bf16_f32 v59, v66, v67
    v_lshrrev_b32 v3, 3, v0
    v_and_b32 v3, 6, v3
    v_xor_b32 v3, v3, v0
    v_lshlrev_b32 v3, 4, v3
    s_cmp_ge_u32 s22, 18
    s_cselect_b32 s23, 9216, 0
    v_add_u32 v3, s23, v3
    s_lshl_b32 s23, s22, 4
    v_add_u32 v90, s23, v1
    v_lshlrev_b32 v90, 12, v90
    v_lshl_add_u32 v90, v2, 4, v90
    s_lshl_b32 s25, s3, 10
    s_add_u32 s25, s25, 40960
    v_and_b32 v91, 15, v0
    v_lshlrev_b32 v91, 6, v91
    v_and_b32 v92, 0x30, v0
    v_add3_u32 v91, v91, v92, s25
    v_lshlrev_b32 v92, 4, v0
    v_add_u32 v92, s25, v92
    s_lshl_b32 s26, s16, 8
    s_lshr_b32 s24, s18, 2
    s_lshl_b32 s24, s24, 11
    s_add_u32 s26, s26, s24
    s_and_b32 s24, s18, 3
    s_lshl_b32 s24, s24, 6
    s_add_u32 s26, s26, s24
    s_cmp_ge_u32 s3, 9
    s_cbranch_scc1 Lnoln_5
    s_mov_b32 s30, 0x3f803f80
    v_mov_b32 v60, 0
    v_mov_b32 v61, 0
    v_mov_b32 v62, 0
    v_mov_b32 v63, 0
    v_lshlrev_b32 v5, 2, v0
    s_lshl_b32 s23, s3, 8
    v_add_u32 v64, s23, v5
    s_waitcnt vmcnt(1)
    s_setprio 2
    v_dot2c_f32_bf16 v60, s30, v8
    v_dot2c_f32_bf16 v62, v8, v8
    v_dot2c_f32_bf16 v61, s30, v16
    v_dot2c_f32_bf16 v63, v16, v16
    v_dot2c_f32_bf16 v60, s30, v9
    v_dot2c_f32_bf16 v62, v9, v9
    v_dot2c_f32_bf16 v61, s30, v17
    v_dot2c_f32_bf16 v63, v17, v17
    v_dot2c_f32_bf16 v60, s30, v10
    v_dot2c_f32_bf16 v62, v10, v10
    v_dot2c_f32_bf16 v61, s30, v18
    v_dot2c_f32_bf16 v63, v18, v18
    v_dot2c_f32_bf16 v60, s30, v11
    v_dot2c_f32_bf16 v62, v11, v11
    v_dot2c_f32_bf16 v61, s30, v19
    v_dot2c_f32_bf16 v63, v19, v19
    v_dot2c_f32_bf16 v60, s30, v12
    v_dot2c_f32_bf16 v62, v12, v12
    v_dot2c_f32_bf16 v61, s30, v20
    v_dot2c_f32_bf16 v63, v20, v20
    v_dot2c_f32_bf16 v60, s30, v13
    v_dot2c_f32_bf16 v62, v13, v13
    v_dot2c_f32_bf16 v61, s30, v21
    v_dot2c_f32_bf16 v63, v21, v21
    v_dot2c_f32_bf16 v60, s30, v14
    v_dot2c_f32_bf16 v62, v14, v14
    v_dot2c_f32_bf16 v61, s30, v22
    v_dot2c_f32_bf16 v63, v22, v22
    v_dot2c_f32_bf16 v60, s30, v15
    v_dot2c_f32_bf16 v62, v15, v15
    v_dot2c_f32_bf16 v61, s30, v23
    v_dot2c_f32_bf16 v63, v23, v23
    v_add_f32_dpp v60, v60, v60 quad_perm:[1,0,3,2] row_mask:0xf bank_mask:0xf
    s_nop 0
    v_add_f32_dpp v61, v61, v61 quad_perm:[1,0,3,2] row_mask:0xf bank_mask:0xf
    v_add_f32_dpp v62, v62, v62 quad_perm:[1,0,3,2] row_mask:0xf bank_mask:0xf
    v_add_f32_dpp v63, v63, v63 quad_perm:[1,0,3,2] row_mask:0xf bank_mask:0xf
    v_add_f32_dpp v60, v60, v60 quad_perm:[2,3,0,1] row_mask:0xf bank_mask:0xf
    v_add_f32_dpp v61, v61, v61 quad_perm:[2,3,0,1] row_mask:0xf bank_mask:0xf
    v_add_f32_dpp v62, v62, v62 quad_perm:[2,3,0,1] row_mask:0xf bank_mask:0xf
    v_add_f32_dpp v63, v63, v63 quad_perm:[2,3,0,1] row_mask:0xf bank_mask:0xf
    v_cmp_eq_u32 vcc, 1, v2
    s_nop 1
    v_cndmask_b32 v60, v60, v61, vcc
    v_cmp_eq_u32 vcc, 2, v2
    s_nop 1
    v_cndmask_b32 v60, v60, v62, vcc
    v_cmp_eq_u32 vcc, 3, v2
    s_nop 1
    v_cndmask_b32 v60, v60, v63, vcc
    ds_write_b32 v64, v60 offset:36864
    s_mov_b32 s31, 0xffff0000
    v_lshlrev_b32 v136, 16, v8
    v_and_b32 v137, s31, v8
    v_lshlrev_b32 v138, 16, v12
    v_and_b32 v139, s31, v12
    v_lshlrev_b32 v140, 16, v9
    v_and_b32 v141, s31, v9
    v_lshlrev_b32 v142, 16, v13
    v_and_b32 v143, s31, v13
    v_lshlrev_b32 v144, 16, v10
    v_and_b32 v145, s31, v10
    v_lshlrev_b32 v146, 16, v14
    v_and_b32 v147, s31, v14
    v_lshlrev_b32 v148, 16, v11
    v_and_b32 v149, s31, v11
    v_lshlrev_b32 v150, 16, v15
    v_and_b32 v151, s31, v15
    v_pk_add_f32 v[104:105], v[136:137], v[138:139]
    v_pk_add_f32 v[120:121], v[136:137], v[138:139] neg_lo:[0,1] neg_hi:[0,1]
    v_pk_add_f32 v[106:107], v[140:141], v[142:143]
    v_pk_add_f32 v[122:123], v[140:141], v[142:143] neg_lo:[0,1] neg_hi:[0,1]
    v_pk_add_f32 v[108:109], v[144:145], v[146:147]
    v_pk_add_f32 v[124:125], v[144:145], v[146:147] neg_lo:[0,1] neg_hi:[0,1]
    v_pk_add_f32 v[110:111], v[148:149], v[150:151]
    v_pk_add_f32 v[126:127], v[148:149], v[150:151] neg_lo:[0,1] neg_hi:[0,1]
    s_waitcnt lgkmcnt(0)
    s_barrier
    ds_read2st64_b32 v[60:61], v5 offset0:144 offset1:145
    ds_read2st64_b32 v[62:63], v5 offset0:146 offset1:147
    ds_read2st64_b32 v[64:65], v5 offset0:148 offset1:149
    ds_read2st64_b32 v[66:67], v5 offset0:150 offset1:151
    ds_read_b32 v68, v5 offset:38912
    v_lshlrev_b32 v136, 16, v16
    v_and_b32 v137, s31, v16
    v_lshlrev_b32 v138, 16, v20
    v_and_b32 v139, s31, v20
    v_lshlrev_b32 v140, 16, v17
    v_and_b32 v141, s31, v17
    v_lshlrev_b32 v142, 16, v21
    v_and_b32 v143, s31, v21
    v_lshlrev_b32 v144, 16, v18
    v_and_b32 v145, s31, v18
    v_lshlrev_b32 v146, 16, v22
    v_and_b32 v147, s31, v22
    v_lshlrev_b32 v148, 16, v19
    v_and_b32 v149, s31, v19
    v_lshlrev_b32 v150, 16, v23
    v_and_b32 v151, s31, v23
    v_pk_add_f32 v[112:113], v[136:137], v[138:139]
    v_pk_add_f32 v[128:129], v[136:137], v[138:139] neg_lo:[0,1] neg_hi:[0,1]
    v_pk_add_f32 v[114:115], v[140:141], v[142:143]
    v_pk_add_f32 v[130:131], v[140:141], v[142:143] neg_lo:[0,1] neg_hi:[0,1]
    v_pk_add_f32 v[116:117], v[144:145], v[146:147]
    v_pk_add_f32 v[132:133], v[144:145], v[146:147] neg_lo:[0,1] neg_hi:[0,1]
    v_pk_add_f32 v[118:119], v[148:149], v[150:151]
    v_pk_add_f32 v[134:135], v[148:149], v[150:151] neg_lo:[0,1] neg_hi:[0,1]
    s_waitcnt lgkmcnt(0)
    v_pk_add_f32 v[60:61], v[60:61], v[62:63]
    v_pk_add_f32 v[64:65], v[64:65], v[66:67]
    v_pk_add_f32 v[60:61], v[60:61], v[64:65]
    v_add_f32 v60, v60, v61
    v_add_f32 v60, v60, v68
    s_nop 1
    v_mov_b32_dpp v61, v60 quad_perm:[2,3,2,3] row_mask:0xf bank_mask:0xf
    v_mov_b32_dpp v60, v60 quad_perm:[0,1,0,1] row_mask:0xf bank_mask:0xf
    v_mul_f32 v60, 0x3ae38e39, v60
    v_mul_f32 v62, v60, v60
    v_mov_b32 v63, 0x3ae38e39
    v_fma_f32 v61, v61, v63, -v62
    v_max_f32 v61, 0, v61
    v_add_f32 v61, 0x3727c5ac, v61
    v_rsq_f32 v62, v61
    s_lshl_b32 s23, s3, 10
    v_lshlrev_b32 v5, 1, v2
    v_xor_b32 v5, v5, v1
    v_lshlrev_b32 v5, 4, v5
    v_lshl_add_u32 v5, v2, 8, v5
    v_add_u32 v5, s23, v5
    v_mul_f32 v63, v60, v62
    v_mul_f32 v63, -2.0, v63
    v_mov_b32_dpp v64, v62 quad_perm:[0,0,0,0] row_mask:0xf bank_mask:0xf
    s_nop 0
    v_mov_b32_dpp v65, v63 quad_perm:[0,0,0,0] row_mask:0xf bank_mask:0xf
    v_mov_b32_dpp v66, v62 quad_perm:[1,1,1,1] row_mask:0xf bank_mask:0xf
    v_mov_b32_dpp v67, v63 quad_perm:[1,1,1,1] row_mask:0xf bank_mask:0xf
    v_pk_fma_f32 v[104:105], v[104:105], v[64:65], v[64:65] op_sel:[0,0,1] op_sel_hi:[1,0,1]
    v_pk_mul_f32 v[120:121], v[120:121], v[64:65] op_sel_hi:[1,0]
    v_pk_fma_f32 v[106:107], v[106:107], v[64:65], v[64:65] op_sel:[0,0,1] op_sel_hi:[1,0,1]
    v_pk_mul_f32 v[122:123], v[122:123], v[64:65] op_sel_hi:[1,0]
    v_pk_fma_f32 v[108:109], v[108:109], v[64:65], v[64:65] op_sel:[0,0,1] op_sel_hi:[1,0,1]
    v_pk_mul_f32 v[124:125], v[124:125], v[64:65] op_sel_hi:[1,0]
    v_pk_fma_f32 v[110:111], v[110:111], v[64:65], v[64:65] op_sel:[0,0,1] op_sel_hi:[1,0,1]
    v_pk_mul_f32 v[126:127], v[126:127], v[64:65] op_sel_hi:[1,0]
    v_cvt_pk_bf16_f32 v8, v104, v105
    v_cvt_pk_bf16_f32 v12, v120, v121
    v_cvt_pk_bf16_f32 v9, v106, v107
    v_cvt_pk_bf16_f32 v13, v122, v123
    v_cvt_pk_bf16_f32 v10, v108, v109
    v_cvt_pk_bf16_f32 v14, v124, v125
    v_cvt_pk_bf16_f32 v11, v110, v111
    v_cvt_pk_bf16_f32 v15, v126, v127
    ds_write_b128 v5, v[8:11] offset:0
    ds_write_b128 v5, v[12:15] offset:9216
    v_pk_fma_f32 v[112:113], v[112:113], v[66:67], v[66:67] op_sel:[0,0,1] op_sel_hi:[1,0,1]
    v_pk_mul_f32 v[128:129], v[128:129], v[66:67] op_sel_hi:[1,0]
    v_pk_fma_f32 v[114:115], v[114:115], v[66:67], v[66:67] op_sel:[0,0,1] op_sel_hi:[1,0,1]
    v_pk_mul_f32 v[130:131], v[130:131], v[66:67] op_sel_hi:[1,0]
    v_pk_fma_f32 v[116:117], v[116:117], v[66:67], v[66:67] op_sel:[0,0,1] op_sel_hi:[1,0,1]
    v_pk_mul_f32 v[132:133], v[132:133], v[66:67] op_sel_hi:[1,0]
    v_pk_fma_f32 v[118:119], v[118:119], v[66:67], v[66:67] op_sel:[0,0,1] op_sel_hi:[1,0,1]
    v_pk_mul_f32 v[134:135], v[134:135], v[66:67] op_sel_hi:[1,0]
    v_cvt_pk_bf16_f32 v16, v112, v113
    v_cvt_pk_bf16_f32 v20, v128, v129
    v_cvt_pk_bf16_f32 v17, v114, v115
    v_cvt_pk_bf16_f32 v21, v130, v131
    v_cvt_pk_bf16_f32 v18, v116, v117
    v_cvt_pk_bf16_f32 v22, v132, v133
    v_cvt_pk_bf16_f32 v19, v118, v119
    v_cvt_pk_bf16_f32 v23, v134, v135
    ds_write_b128 v5, v[16:19] offset:18432
    ds_write_b128 v5, v[20:23] offset:27648
    s_cmp_lg_u32 s3, 7
    s_cbranch_scc1 Ljoin_6
    v_lshl_add_u32 v65, v2, 8, v6
    v_add_u32 v65, s17, v65
    v_lshlrev_b32 v65, 2, v65
    s_lshr_b32 s23, s16, 2
    s_lshl_b32 s23, s23, 12
    s_and_b32 s24, s16, 3
    s_lshl_b32 s24, s24, 8
    s_add_u32 s23, s23, s24
    s_lshr_b32 s24, s18, 2
    s_lshl_b32 s24, s24, 10
    s_add_u32 s23, s23, s24
    s_and_b32 s24, s18, 3
    s_lshl_b32 s24, s24, 6
    s_add_u32 s23, s23, s24
    v_lshlrev_b32 v64, 11, v2
    v_lshl_add_u32 v64, v1, 2, v64
    v_add_u32 v64, s23, v64
    v_mul_f32 v66, v61, v62
    v_mul_f32 v67, 0x3a000000, v62
    s_mov_b32 s23, 0x2dc6000
    s_mov_b32 exec_lo, 0x33333333
    s_mov_b32 exec_hi, 0x33333333
    s_lshl_b32 s24, s19, 13
    s_add_u32 s24, s24, 0x2dce000
    buffer_store_dword v67, v64, s[12:15], s24 offen sc1
    s_cmp_lg_u32 s19, 0
    s_cbranch_scc1 Lns_7
    v_lshlrev_b32 v65, 7, v2
    v_lshl_add_u32 v65, v1, 3, v65
    v_mov_b32 v67, v60
    s_lshl_b32 s24, s16, 3
    s_add_u32 s24, s24, s18
    s_lshl_b32 s24, s24, 8
    s_add_u32 s24, s24, 0x2dc8000
    buffer_store_dwordx2 v[66:67], v65, s[12:15], s24 offen sc1
    s_branch Lns_7
    s_add_u32 s23, s23, 8192
    buffer_store_dword v60, v65, s[12:15], s23 offen sc1
    s_add_u32 s23, s23, 8192
    buffer_store_dword v66, v65, s[12:15], s23 offen sc1
Lns_7:
    s_mov_b64 exec, -1
    s_branch Ljoin_6
Lnoln_5:
    s_barrier
Ljoin_6:
    s_waitcnt lgkmcnt(0)
    s_barrier
    ds_read_b128 v[104:107], v3 offset:0
    ds_read_b128 v[108:111], v3 offset:18432
    ds_read_b128 v[112:115], v3 offset:1024
    ds_read_b128 v[116:119], v3 offset:19456
    ds_read_b128 v[120:123], v3 offset:2048
    ds_read_b128 v[124:127], v3 offset:20480
    ds_read_b128 v[128:131], v3 offset:3072
    ds_read_b128 v[132:135], v3 offset:21504
    ds_read_b128 v[136:139], v3 offset:4096
    ds_read_b128 v[140:143], v3 offset:22528
    ds_read_b128 v[144:147], v3 offset:5120
    ds_read_b128 v[148:151], v3 offset:23552
    s_waitcnt lgkmcnt(11)
    v_mfma_f32_16x16x32_bf16 v[76:79], v[104:107], v[24:27], 0
    ds_read_b128 v[104:107], v3 offset:6144
    s_waitcnt lgkmcnt(11)
    v_mfma_f32_16x16x32_bf16 v[84:87], v[108:111], v[24:27], 0
    ds_read_b128 v[108:111], v3 offset:24576
    s_waitcnt lgkmcnt(11)
    v_mfma_f32_16x16x32_bf16 v[76:79], v[112:115], v[28:31], v[76:79]
    ds_read_b128 v[112:115], v3 offset:7168
    s_waitcnt lgkmcnt(11)
    v_mfma_f32_16x16x32_bf16 v[84:87], v[116:119], v[28:31], v[84:87]
    ds_read_b128 v[116:119], v3 offset:25600
    s_waitcnt lgkmcnt(11)
    v_mfma_f32_16x16x32_bf16 v[76:79], v[120:123], v[32:35], v[76:79]
    ds_read_b128 v[120:123], v3 offset:8192
    s_waitcnt lgkmcnt(11)
    v_mfma_f32_16x16x32_bf16 v[84:87], v[124:127], v[32:35], v[84:87]
    ds_read_b128 v[124:127], v3 offset:26624
    s_waitcnt lgkmcnt(11)
    v_mfma_f32_16x16x32_bf16 v[76:79], v[128:131], v[36:39], v[76:79]
    s_waitcnt lgkmcnt(10)
    v_mfma_f32_16x16x32_bf16 v[84:87], v[132:135], v[36:39], v[84:87]
    s_waitcnt lgkmcnt(9)
    v_mfma_f32_16x16x32_bf16 v[76:79], v[136:139], v[40:43], v[76:79]
    s_waitcnt lgkmcnt(8)
    v_mfma_f32_16x16x32_bf16 v[84:87], v[140:143], v[40:43], v[84:87]
    s_waitcnt lgkmcnt(7)
    v_mfma_f32_16x16x32_bf16 v[76:79], v[144:147], v[44:47], v[76:79]
    s_waitcnt lgkmcnt(6)
    v_mfma_f32_16x16x32_bf16 v[84:87], v[148:151], v[44:47], v[84:87]
    s_waitcnt lgkmcnt(5)
    v_mfma_f32_16x16x32_bf16 v[76:79], v[104:107], v[48:51], v[76:79]
    s_waitcnt lgkmcnt(4)
    v_mfma_f32_16x16x32_bf16 v[84:87], v[108:111], v[48:51], v[84:87]
    s_waitcnt lgkmcnt(3)
    v_mfma_f32_16x16x32_bf16 v[76:79], v[112:115], v[52:55], v[76:79]
    s_waitcnt lgkmcnt(2)
    v_mfma_f32_16x16x32_bf16 v[84:87], v[116:119], v[52:55], v[84:87]
    s_waitcnt lgkmcnt(1)
    v_mfma_f32_16x16x32_bf16 v[76:79], v[120:123], v[56:59], v[76:79]
    s_waitcnt lgkmcnt(0)
    v_mfma_f32_16x16x32_bf16 v[84:87], v[124:127], v[56:59], v[84:87]
    s_nop 5
    v_cvt_pk_bf16_f32 v8, v76, v77
    v_cvt_pk_bf16_f32 v9, v78, v79
    v_cvt_pk_bf16_f32 v10, v84, v85
    v_cvt_pk_bf16_f32 v11, v86, v87
    ds_write_b128 v91, v[8:11]
    s_waitcnt lgkmcnt(0)
    ds_read_b128 v[12:15], v92
    s_waitcnt lgkmcnt(0)
    buffer_store_dwordx4 v[12:15], v90, s[12:15], s26 offen sc1
    s_lshl_b32 s28, s2, 5
    s_add_u32 s28, s28, 0x2dee800
    v_mov_b32 v8, 150552
    v_mov_b32 v9, 0
    ds_write_b32 v8, v9
    ds_write_b32 v8, v9 offset:4
    s_waitcnt lgkmcnt(0)
    s_cmp_lg_u32 s3, 1
    s_cbranch_scc1 Lr_8
    s_and_b32 s46, s2, 3
    s_lshl_b32 s46, s46, 6
    v_lshlrev_b32 v98, 2, v0
    v_add_u32 v98, s46, v98
    s_mov_b64 exec, 3
    s_mov_b32 s93, 0x1fffff
Lpoll_9:
    buffer_load_dword v99, v98, s[4:7], 0 offen sc1
    s_and_b32 s92, s93, 63
    s_cbranch_scc1 Lchk_11
    s_waitcnt vmcnt(0)
    v_mov_b32 v99, 0
    buffer_atomic_or v99, v98, s[4:7], 0 offen sc0 sc1
Lchk_11:
    s_waitcnt vmcnt(0)
    v_cmp_eq_u32 vcc, 0, v99
    s_nop 4
    s_cbranch_vccz Lgo_10
    s_mov_b64 exec, vcc
    s_sleep 4
    s_sub_u32 s93, s93, 1
    s_cbranch_scc0 Lpoll_9
Lgo_10:
    s_mov_b64 exec, -1
Lr_8:
    s_waitcnt vmcnt(0)
    s_barrier
    s_cmp_lg_u32 s3, 0
    s_cbranch_scc1 Lp_12
    v_mov_b32 v8, 1
    v_mul_u32_u24 v9, 32768, v0
    s_mov_b64 exec, 0xff
    buffer_store_dword v8, v9, s[12:15], s28 offen sc1
    s_mov_b64 exec, -1
Lp_12:
    s_branch P2_entry
K1_side:
    s_cmp_ge_u32 s2, 240
    s_cbranch_scc1 K1_w2
    s_mov_b32 s18, 1183744
    s_mov_b32 s19, 0x20000
    s_mov_b32 s22, 1183744
    s_mov_b32 s23, 0x20000
    s_and_b32 s24, s2, 3
    s_bfe_u32 s25, s2, 0x10002
    s_sub_u32 s30, s2, 192
    s_lshr_b32 s30, s30, 3
    s_cmp_ge_u32 s3, 6
    s_cselect_b32 s31, 1, 0
    s_mul_i32 s32, s31, 6
    s_sub_u32 s32, s3, s32
    s_mul_i32 s26, s30, 6
    s_add_u32 s26, s26, s32
    s_lshl_b32 s27, s24, 4
    s_lshl_b32 s28, s25, 10
    s_add_u32 s27, s27, s28
    s_mul_i32 s27, s27, 578
    s_mul_i32 s28, s30, 96
    s_add_u32 s27, s27, s28
    s_cmp_ge_u32 s3, 7
    s_waitcnt lgkmcnt(0)
    s_cbranch_scc1 Lnodma_14
    s_mov_b32 s16, s42
    s_mov_b32 s17, s43
    s_mov_b32 s20, s44
    s_mov_b32 s21, s45
    s_lshl_b32 s28, s3, 8
    s_lshl_b32 s29, s3, 12
    v_add_u32 v1, s28, v0
    s_add_u32 s28, s28, 64
    v_mul_u32_u24 v2, 9363, v1
    v_lshrrev_b32 v2, 16, v2
    v_mul_u32_u24 v3, 7, v2
    v_sub_u32 v1, v1, v3
    v_and_b32 v3, 0xf0, v2
    v_mul_u32_u24 v3, 3, v3
    v_add_u32 v3, v2, v3
    v_mul_u32_u24 v3, 578, v3
    v_and_b32 v2, 1, v2
    v_lshl_add_u32 v3, v2, 1, v3
    v_lshl_add_u32 v4, v1, 4, v3
    s_add_u32 m0, s29, 0
    s_nop 0
    buffer_load_dwordx4 v4, s[16:19], s27 offen  lds
    s_add_u32 m0, s29, 28672
    s_nop 0
    buffer_load_dwordx4 v4, s[20:23], s27 offen  lds
    v_add_u32 v1, s28, v0
    s_add_u32 s28, s28, 64
    v_mul_u32_u24 v2, 9363, v1
    v_lshrrev_b32 v2, 16, v2
    v_mul_u32_u24 v3, 7, v2
    v_sub_u32 v1, v1, v3
    v_and_b32 v3, 0xf0, v2
    v_mul_u32_u24 v3, 3, v3
    v_add_u32 v3, v2, v3
    v_mul_u32_u24 v3, 578, v3
    v_and_b32 v2, 1, v2
    v_lshl_add_u32 v3, v2, 1, v3
    v_lshl_add_u32 v4, v1, 4, v3
    s_add_u32 m0, s29, 1024
    s_nop 0
    buffer_load_dwordx4 v4, s[16:19], s27 offen  lds
    s_add_u32 m0, s29, 29696
    s_nop 0
    buffer_load_dwordx4 v4, s[20:23], s27 offen  lds
    v_add_u32 v1, s28, v0
    s_add_u32 s28, s28, 64
    v_mul_u32_u24 v2, 9363, v1
    v_lshrrev_b32 v2, 16, v2
    v_mul_u32_u24 v3, 7, v2
    v_sub_u32 v1, v1, v3
    v_and_b32 v3, 0xf0, v2
    v_mul_u32_u24 v3, 3, v3
    v_add_u32 v3, v2, v3
    v_mul_u32_u24 v3, 578, v3
    v_and_b32 v2, 1, v2
    v_lshl_add_u32 v3, v2, 1, v3
    v_lshl_add_u32 v4, v1, 4, v3
    s_add_u32 m0, s29, 2048
    s_nop 0
    buffer_load_dwordx4 v4, s[16:19], s27 offen  lds
    s_add_u32 m0, s29, 30720
    s_nop 0
    buffer_load_dwordx4 v4, s[20:23], s27 offen  lds
    v_add_u32 v1, s28, v0
    v_mul_u32_u24 v2, 9363, v1
    v_lshrrev_b32 v2, 16, v2
    v_mul_u32_u24 v3, 7, v2
    v_sub_u32 v1, v1, v3
    v_and_b32 v3, 0xf0, v2
    v_mul_u32_u24 v3, 3, v3
    v_add_u32 v3, v2, v3
    v_mul_u32_u24 v3, 578, v3
    v_and_b32 v2, 1, v2
    v_lshl_add_u32 v3, v2, 1, v3
    v_lshl_add_u32 v4, v1, 4, v3
    s_add_u32 m0, s29, 3072
    s_nop 0
    buffer_load_dwordx4 v4, s[16:19], s27 offen  lds
    s_add_u32 m0, s29, 31744
    s_nop 0
    buffer_load_dwordx4 v4, s[20:23], s27 offen  lds
    s_branch Lj_15
Lnodma_14:
    s_cmp_lg_u32 s3, 11
    s_cbranch_scc1 Lj_15
    s_and_b32 s46, s2, 3
    s_lshl_b32 s46, s46, 6
    v_lshlrev_b32 v98, 2, v0
    v_add_u32 v98, s46, v98
    s_mov_b64 exec, 3
    s_mov_b32 s93, 0x1fffff
Lpoll_16:
    buffer_load_dword v99, v98, s[4:7], 0 offen sc1
    s_and_b32 s92, s93, 63
    s_cbranch_scc1 Lchk_18
    s_waitcnt vmcnt(0)
    v_mov_b32 v99, 0
    buffer_atomic_or v99, v98, s[4:7], 0 offen sc0 sc1
Lchk_18:
    s_waitcnt vmcnt(0)
    v_cmp_eq_u32 vcc, 0, v99
    s_nop 4
    s_cbranch_vccz Lgo_17
    s_mov_b64 exec, vcc
    s_sleep 4
    s_sub_u32 s93, s93, 1
    s_cbranch_scc0 Lpoll_16
Lgo_17:
    s_mov_b64 exec, -1
Lj_15:
    v_and_b32 v1, 15, v0
    v_lshrrev_b32 v2, 4, v0
    v_lshl_add_u32 v1, v2, 6, v1
    v_mul_u32_u24 v1, 112, v1
    s_lshl_b32 s28, s32, 4
    s_lshl_b32 s29, s31, 3
    s_add_u32 s28, s28, s29
    v_add_u32 v1, s28, v1
    v_and_b32 v2, 1, v0
    v_xor_b32 v2, 1, v2
    v_lshlrev_b32 v2, 4, v2
    s_lshl_b32 s28, s26, 15
    s_lshl_b32 s29, s24, 11
    s_add_u32 s28, s28, s29
    s_lshl_b32 s29, s25, 10
    s_add_u32 s28, s28, s29
    s_lshl_b32 s29, s31, 14
    s_add_u32 s28, s28, s29
    s_add_u32 s28, s28, 0x240000
    s_add_u32 s29, s28, 1179648
    s_mov_b32 s42, 0x5040100
    s_mov_b32 s43, 0x7060302
    v_lshlrev_b32 v3, 4, v0
    s_waitcnt vmcnt(0)
    s_barrier
    ds_read_b64 v[8:9], v1 offset:0
    ds_read_b32 v10, v1 offset:8
    ds_read_b64 v[24:25], v1 offset:28672
    ds_read_b32 v26, v1 offset:28680
    ds_read_b64 v[12:13], v1 offset:1792
    ds_read_b32 v14, v1 offset:1800
    ds_read_b64 v[28:29], v1 offset:30464
    ds_read_b32 v30, v1 offset:30472
    ds_read_b64 v[16:17], v1 offset:3584
    ds_read_b32 v18, v1 offset:3592
    ds_read_b64 v[32:33], v1 offset:32256
    ds_read_b32 v34, v1 offset:32264
    s_waitcnt lgkmcnt(8)
    ds_read_b64 v[20:21], v1 offset:5376
    ds_read_b32 v22, v1 offset:5384
    ds_read_b64 v[36:37], v1 offset:34048
    ds_read_b32 v38, v1 offset:34056
    s_waitcnt lgkmcnt(0)
    v_alignbit_b32 v8, v9, v8, v2
    v_alignbit_b32 v9, v10, v9, v2
    v_alignbit_b32 v24, v25, v24, v2
    v_alignbit_b32 v25, v26, v25, v2
    v_alignbit_b32 v12, v13, v12, v2
    v_alignbit_b32 v13, v14, v13, v2
    v_alignbit_b32 v28, v29, v28, v2
    v_alignbit_b32 v29, v30, v29, v2
    v_alignbit_b32 v16, v17, v16, v2
    v_alignbit_b32 v17, v18, v17, v2
    v_alignbit_b32 v32, v33, v32, v2
    v_alignbit_b32 v33, v34, v33, v2
    v_alignbit_b32 v20, v21, v20, v2
    v_alignbit_b32 v21, v22, v21, v2
    v_alignbit_b32 v36, v37, v36, v2
    v_alignbit_b32 v37, v38, v37, v2
    v_perm_b32 v40, v24, v8, s42
    v_perm_b32 v41, v28, v12, s42
    v_perm_b32 v42, v32, v16, s42
    v_perm_b32 v43, v36, v20, s42
    buffer_store_dwordx4 v[40:43], v3, s[12:15], s29 offen sc1
    s_add_u32 s29, s29, 8192
    v_perm_b32 v44, v24, v8, s43
    v_perm_b32 v45, v28, v12, s43
    v_perm_b32 v46, v32, v16, s43
    v_perm_b32 v47, v36, v20, s43
    buffer_store_dwordx4 v[44:47], v3, s[12:15], s28 offen sc1
    s_add_u32 s28, s28, 8192
    v_perm_b32 v48, v25, v9, s42
    v_perm_b32 v49, v29, v13, s42
    v_perm_b32 v50, v33, v17, s42
    v_perm_b32 v51, v37, v21, s42
    buffer_store_dwordx4 v[48:51], v3, s[12:15], s29 offen sc1
    s_add_u32 s29, s29, 8192
    v_perm_b32 v52, v25, v9, s43
    v_perm_b32 v53, v29, v13, s43
    v_perm_b32 v54, v33, v17, s43
    v_perm_b32 v55, v37, v21, s43
    buffer_store_dwordx4 v[52:55], v3, s[12:15], s28 offen sc1
    s_add_u32 s28, s28, 8192
    s_branch K1_sidedone
K1_w2:
    s_cmp_ge_u32 s2, 256
    s_cbranch_scc1 K1_exit
    s_cmp_lt_u32 s2, 254
    s_waitcnt lgkmcnt(0)
    s_cbranch_scc1 Lz_19
    s_sub_u32 s25, s2, 254
    s_mul_i32 s26, s3, 43
    s_lshr_b32 s26, s26, 7
    s_mul_i32 s27, s26, 3
    s_sub_u32 s27, s3, s27
    s_lshl_b32 s24, s25, 2
    s_add_u32 s24, s24, s26
    s_mul_i32 s24, s24, 32768
    s_mul_i32 s27, s27, 6144
    s_add_u32 s24, s24, s27
    s_add_u32 s24, s24, 0x2dee000
    v_lshlrev_b32 v1, 4, v0
    v_mov_b32 v4, 0
    v_mov_b32 v5, 0
    v_mov_b32 v6, 0
    v_mov_b32 v7, 0
    buffer_store_dwordx4 v[4:7], v1, s[12:15], s24 offen sc1
    s_add_u32 s24, s24, 1024
    buffer_store_dwordx4 v[4:7], v1, s[12:15], s24 offen sc1
    s_add_u32 s24, s24, 1024
    buffer_store_dwordx4 v[4:7], v1, s[12:15], s24 offen sc1
    s_add_u32 s24, s24, 1024
    buffer_store_dwordx4 v[4:7], v1, s[12:15], s24 offen sc1
    s_add_u32 s24, s24, 1024
    buffer_store_dwordx4 v[4:7], v1, s[12:15], s24 offen sc1
    s_add_u32 s24, s24, 1024
    buffer_store_dwordx4 v[4:7], v1, s[12:15], s24 offen sc1
    s_add_u32 s24, s24, 1024
    s_mul_i32 s24, s25, 12
    s_add_u32 s24, s24, s3
    s_mul_i32 s24, s24, 1024
    s_add_u32 s24, s24, 0x2dd6000
    buffer_store_dwordx4 v[4:7], v1, s[12:15], s24 offen offset:0 sc1
    s_waitcnt vmcnt(0)
    s_barrier
    s_cmp_lg_u32 s3, 0
    s_cbranch_scc1 Lz_19
    s_lshl_b32 s25, s25, 2
    v_mov_b32 v8, 1
    v_lshlrev_b32 v4, 6, v0
    s_mov_b64 exec, 15
    buffer_store_dword v8, v4, s[4:7], s25 offen sc1
    s_mov_b64 exec, -1
Lz_19:
    s_cmp_lg_u32 s3, 11
    s_cbranch_scc1 Lr_20
    s_and_b32 s46, s2, 3
    s_lshl_b32 s46, s46, 6
    v_lshlrev_b32 v98, 2, v0
    v_add_u32 v98, s46, v98
    s_mov_b64 exec, 3
    s_mov_b32 s93, 0x1fffff
Lpoll_21:
    buffer_load_dword v99, v98, s[4:7], 0 offen sc1
    s_and_b32 s92, s93, 63
    s_cbranch_scc1 Lchk_23
    s_waitcnt vmcnt(0)
    v_mov_b32 v99, 0
    buffer_atomic_or v99, v98, s[4:7], 0 offen sc0 sc1
Lchk_23:
    s_waitcnt vmcnt(0)
    v_cmp_eq_u32 vcc, 0, v99
    s_nop 4
    s_cbranch_vccz Lgo_22
    s_mov_b64 exec, vcc
    s_sleep 4
    s_sub_u32 s93, s93, 1
    s_cbranch_scc0 Lpoll_21
Lgo_22:
    s_mov_b64 exec, -1
Lr_20:
    s_sub_u32 s50, s3, 6
    s_cmp_ge_u32 s50, 6
    s_cbranch_scc1 Lw_24
    s_load_dwordx2 s[56:57], s[0:1], 32
    s_mov_b32 s58, 0xa2000
    s_mov_b32 s59, 0x20000
    s_bfe_u32 s51, s2, 0x10003
    s_mul_i32 s51, s51, 6
    s_add_u32 s50, s50, s51
    s_and_b32 s51, s2, 7
    s_cmp_ge_u32 s50, 9
    s_cselect_b32 s62, 8, s51
    s_cselect_b32 s63, s51, s50
    s_cmp_ge_u32 s50, 10
    s_cselect_b32 s63, 8, s63
    v_mul_u32_u24 v1, 1152, v0
    s_waitcnt lgkmcnt(0)
    s_mul_i32 s64, s63, 73728
    s_lshl_b32 s65, s62, 7
    s_add_u32 s64, s64, s65
    buffer_load_dword v2, v1, s[56:59], s64 offen
    buffer_load_dword v2, v1, s[56:59], s64 offen offset:64
Lw_24:
    s_cmp_ge_u32 s3, 6
    s_cbranch_scc1 K1_sidedone
    s_sub_u32 s24, s2, 240
    s_mul_i32 s24, s24, 6
    s_add_u32 s24, s24, s3
    s_cmp_ge_u32 s24, 81
    s_cbranch_scc1 K1_sidedone
    s_load_dwordx2 s[16:17], s[0:1], 40
    s_mov_b32 s18, 0xa2000
    s_mov_b32 s19, 0x20000
    s_mul_i32 s25, s24, 7282
    s_lshr_b32 s25, s25, 16
    s_mul_i32 s26, s25, 9
    s_sub_u32 s26, s24, s26
    s_waitcnt lgkmcnt(0)
    s_lshl_b32 s44, s3, 13
    v_lshrrev_b32 v3, 3, v0
    v_and_b32 v4, 2, v3
    v_and_b32 v1, 7, v0
    v_xor_b32 v1, v1, v4
    v_lshlrev_b32 v1, 4, v1
    v_mul_u32_u24 v3, 1152, v3
    v_xor_b32 v2, 64, v1
    v_add_u32 v1, v1, v3
    v_add_u32 v2, v2, v3
    s_mov_b32 s41, s44
    s_mul_i32 s40, s26, 73728
    s_lshl_b32 s45, s25, 7
    s_add_u32 s40, s40, s45
    s_mov_b32 m0, s41
    s_nop 0
    buffer_load_dwordx4 v1, s[16:19], s40 offen nt lds
    s_add_u32 s41, s41, 1024
    s_add_u32 s40, s40, 9216
    s_mov_b32 m0, s41
    s_nop 0
    buffer_load_dwordx4 v2, s[16:19], s40 offen nt lds
    s_add_u32 s41, s41, 1024
    s_add_u32 s40, s40, 9216
    s_mov_b32 m0, s41
    s_nop 0
    buffer_load_dwordx4 v1, s[16:19], s40 offen nt lds
    s_add_u32 s41, s41, 1024
    s_add_u32 s40, s40, 9216
    s_mov_b32 m0, s41
    s_nop 0
    buffer_load_dwordx4 v2, s[16:19], s40 offen nt lds
    s_add_u32 s41, s41, 1024
    s_add_u32 s40, s40, 9216
    s_mov_b32 m0, s41
    s_nop 0
    buffer_load_dwordx4 v1, s[16:19], s40 offen nt lds
    s_add_u32 s41, s41, 1024
    s_add_u32 s40, s40, 9216
    s_mov_b32 m0, s41
    s_nop 0
    buffer_load_dwordx4 v2, s[16:19], s40 offen nt lds
    s_add_u32 s41, s41, 1024
    s_add_u32 s40, s40, 9216
    s_mov_b32 m0, s41
    s_nop 0
    buffer_load_dwordx4 v1, s[16:19], s40 offen nt lds
    s_add_u32 s41, s41, 1024
    s_add_u32 s40, s40, 9216
    s_mov_b32 m0, s41
    s_nop 0
    buffer_load_dwordx4 v2, s[16:19], s40 offen nt lds
    s_add_u32 s41, s41, 1024
    s_add_u32 s40, s40, 9216
    v_lshrrev_b32 v1, 4, v0
    v_bfe_u32 v2, v0, 2, 2
    v_lshl_add_u32 v3, v1, 3, v2
    v_lshlrev_b32 v3, 7, v3
    v_and_b32 v1, 1, v1
    v_lshlrev_b32 v1, 1, v1
    v_lshrrev_b32 v2, 1, v2
    v_or_b32 v1, v1, v2
    v_lshl_add_u32 v3, v1, 5, v3
    v_and_b32 v2, 3, v0
    v_lshl_add_u32 v3, v2, 3, v3
    v_xor_b32 v4, 32, v3
    v_xor_b32 v5, 64, v3
    v_xor_b32 v6, 96, v3
    v_add_u32 v3, s44, v3
    v_add_u32 v4, s44, v4
    v_add_u32 v5, s44, v5
    v_add_u32 v6, s44, v6
    v_lshlrev_b32 v1, 4, v0
    s_waitcnt vmcnt(0)
    ds_read_b64_tr_b16 v[16:17], v3 offset:0
    ds_read_b64_tr_b16 v[18:19], v3 offset:512
    ds_read_b64_tr_b16 v[20:21], v3 offset:4096
    ds_read_b64_tr_b16 v[22:23], v3 offset:4608
    ds_read_b64_tr_b16 v[24:25], v4 offset:0
    ds_read_b64_tr_b16 v[26:27], v4 offset:512
    ds_read_b64_tr_b16 v[28:29], v4 offset:4096
    ds_read_b64_tr_b16 v[30:31], v4 offset:4608
    ds_read_b64_tr_b16 v[32:33], v5 offset:0
    ds_read_b64_tr_b16 v[34:35], v5 offset:512
    ds_read_b64_tr_b16 v[36:37], v5 offset:4096
    ds_read_b64_tr_b16 v[38:39], v5 offset:4608
    ds_read_b64_tr_b16 v[40:41], v6 offset:0
    ds_read_b64_tr_b16 v[42:43], v6 offset:512
    ds_read_b64_tr_b16 v[44:45], v6 offset:4096
    ds_read_b64_tr_b16 v[46:47], v6 offset:4608
    s_mul_i32 s45, s25, 73728
    s_lshl_b32 s46, s26, 11
    s_add_u32 s45, s45, s46
    s_add_u32 s42, s45, 0x1062000
    s_waitcnt lgkmcnt(12)
    buffer_store_dwordx4 v[16:19], v1, s[12:15], s42 offen sc1
    buffer_store_dwordx4 v[20:23], v1, s[12:15], s42 offen offset:1024 sc1
    s_mul_i32 s45, s25, 73728
    s_lshl_b32 s46, s26, 11
    s_add_u32 s45, s45, s46
    s_add_u32 s42, s45, 0x1066800
    s_waitcnt lgkmcnt(8)
    buffer_store_dwordx4 v[24:27], v1, s[12:15], s42 offen sc1
    buffer_store_dwordx4 v[28:31], v1, s[12:15], s42 offen offset:1024 sc1
    s_mul_i32 s45, s25, 73728
    s_lshl_b32 s46, s26, 11
    s_add_u32 s45, s45, s46
    s_add_u32 s42, s45, 0x106b000
    s_waitcnt lgkmcnt(4)
    buffer_store_dwordx4 v[32:35], v1, s[12:15], s42 offen sc1
    buffer_store_dwordx4 v[36:39], v1, s[12:15], s42 offen offset:1024 sc1
    s_mul_i32 s45, s25, 73728
    s_lshl_b32 s46, s26, 11
    s_add_u32 s45, s45, s46
    s_add_u32 s42, s45, 0x106f800
    s_waitcnt lgkmcnt(0)
    buffer_store_dwordx4 v[40:43], v1, s[12:15], s42 offen sc1
    buffer_store_dwordx4 v[44:47], v1, s[12:15], s42 offen offset:1024 sc1
    s_nop 1
K1_sidedone:
    s_setprio 0
    s_lshl_b32 s28, s2, 5
    s_add_u32 s28, s28, 0x2dee800
    s_waitcnt lgkmcnt(0)
    s_waitcnt vmcnt(0)
    s_barrier
    s_cmp_lg_u32 s3, 0
    s_cbranch_scc1 Lp_25
    v_mov_b32 v8, 1
    v_mul_u32_u24 v9, 32768, v0
    s_mov_b64 exec, 0xff
    buffer_store_dword v8, v9, s[12:15], s28 offen sc1
    s_mov_b64 exec, -1
Lp_25:
    s_branch K3_side
K1_exit:
    s_endpgm
P2_entry:
    s_setprio 0
    s_lshl_b32 s35, s2, 5
    s_add_u32 s35, s35, 0x2df0800
    s_cmp_ge_u32 s2, 144
    s_cbranch_scc1 P2_cw1
    s_and_b32 s16, s2, 7
    s_lshr_b32 s17, s2, 3
    s_mul_i32 s16, s16, 9
    s_lshr_b32 s18, s17, 1
    s_add_u32 s16, s16, s18
    s_mul_i32 s30, s16, 43
    s_lshr_b32 s30, s30, 10
    s_cmp_ge_u32 s3, 8
    s_cbranch_scc1 P2_help
    s_and_b32 s17, s17, 1
    s_lshl_b32 s17, s17, 1
    s_lshr_b32 s33, s3, 2
    s_add_u32 s17, s17, s33
    s_lshl_b32 s18, s16, 2
    s_add_u32 s18, s18, s17
    s_and_b32 s19, s3, 3
    s_lshr_b32 s34, s19, 1
    s_lshl_b32 s20, s18, 13
    s_lshl_b32 s21, s34, 10
    s_xor_b32 s22, s21, 1024
    s_add_u32 s21, s21, s20
    s_add_u32 s22, s22, s20
    s_add_u32 s23, s21, 4096
    s_add_u32 s24, s22, 4096
    s_lshl_b32 s25, s19, 11
    s_lshl_b32 s26, s30, 13
    s_add_u32 s26, s26, s25
    s_add_u32 s26, s26, 0x2dce000
    s_add_u32 s25, s25, s20
    s_add_u32 s25, s25, 0x240000
    v_and_b32 v1, 15, v0
    v_lshrrev_b32 v2, 4, v0
    v_lshlrev_b32 v4, 4, v0
    s_lshl_b32 s27, s19, 4
    v_add_u32 v3, s27, v1
    v_cvt_f32_u32 v8, v3
    v_lshlrev_b32 v3, 2, v2
    v_cvt_f32_u32 v9, v3
    v_cvt_f32_u32 v10, v1
    s_mov_b32 s28, 0x80008000
    s_brev_b32 s29, 1
    v_and_b32 v11, 1, v1
    v_mul_lo_u32 v11, v11, s28
    s_lshl_b32 s27, s34, 5
    v_cvt_f32_u32 v3, s27
    v_add_f32 v3, v3, v9
    v_mul_f32 v13, 0x3c800000, v8
    v_mul_f32 v12, v13, v3
    v_mov_b32 v16, v12
    v_fmamk_f32 v17, v13, 0x3f800000, v12
    v_fmamk_f32 v18, v13, 0x40000000, v12
    v_fmamk_f32 v19, v13, 0x40400000, v12
    v_fmamk_f32 v20, v13, 0x41800000, v12
    v_fmamk_f32 v21, v13, 0x41880000, v12
    v_fmamk_f32 v22, v13, 0x41900000, v12
    v_fmamk_f32 v23, v13, 0x41980000, v12
    v_sin_f32 v24, v16
    v_cos_f32 v16, v16
    v_sin_f32 v25, v17
    v_cos_f32 v17, v17
    v_sin_f32 v26, v18
    v_cos_f32 v18, v18
    v_sin_f32 v27, v19
    v_cos_f32 v19, v19
    v_sin_f32 v28, v20
    v_cos_f32 v20, v20
    v_sin_f32 v29, v21
    v_cos_f32 v21, v21
    v_sin_f32 v30, v22
    v_cos_f32 v22, v22
    v_sin_f32 v31, v23
    v_cos_f32 v23, v23
    v_cvt_pk_bf16_f32 v40, v16, v17
    v_cvt_pk_bf16_f32 v48, v24, v25
    v_cvt_pk_bf16_f32 v41, v18, v19
    v_cvt_pk_bf16_f32 v49, v26, v27
    v_cvt_pk_bf16_f32 v42, v20, v21
    v_cvt_pk_bf16_f32 v50, v28, v29
    v_cvt_pk_bf16_f32 v43, v22, v23
    v_cvt_pk_bf16_f32 v51, v30, v31
    v_xor_b32 v44, v11, v40
    v_xor_b32 v52, v11, v48
    v_xor_b32 v45, v11, v41
    v_xor_b32 v53, v11, v49
    v_xor_b32 v46, v11, v42
    v_xor_b32 v54, v11, v50
    v_xor_b32 v47, v11, v43
    v_xor_b32 v55, v11, v51
    v_xor_b32 v56, s28, v48
    v_xor_b32 v57, s28, v49
    v_xor_b32 v58, s28, v50
    v_xor_b32 v59, s28, v51
    v_xor_b32 v60, s28, v52
    v_xor_b32 v61, s28, v53
    v_xor_b32 v62, s28, v54
    v_xor_b32 v63, s28, v55
    v_mul_f32 v13, 0x3d000000, v10
    v_mul_f32 v12, v13, v9
    v_mov_b32 v16, v12
    v_fmamk_f32 v17, v13, 0x3f800000, v12
    v_fmamk_f32 v18, v13, 0x40000000, v12
    v_fmamk_f32 v19, v13, 0x40400000, v12
    v_fmamk_f32 v20, v13, 0x41800000, v12
    v_fmamk_f32 v21, v13, 0x41880000, v12
    v_fmamk_f32 v22, v13, 0x41900000, v12
    v_fmamk_f32 v23, v13, 0x41980000, v12
    v_sin_f32 v24, v16
    v_cos_f32 v16, v16
    v_sin_f32 v25, v17
    v_cos_f32 v17, v17
    v_sin_f32 v26, v18
    v_cos_f32 v18, v18
    v_sin_f32 v27, v19
    v_cos_f32 v19, v19
    v_sin_f32 v28, v20
    v_cos_f32 v20, v20
    v_sin_f32 v29, v21
    v_cos_f32 v21, v21
    v_sin_f32 v30, v22
    v_cos_f32 v22, v22
    v_sin_f32 v31, v23
    v_cos_f32 v23, v23
    v_cvt_pk_bf16_f32 v64, v16, v17
    v_cvt_pk_bf16_f32 v72, v24, v25
    v_cvt_pk_bf16_f32 v65, v18, v19
    v_cvt_pk_bf16_f32 v73, v26, v27
    v_cvt_pk_bf16_f32 v66, v20, v21
    v_cvt_pk_bf16_f32 v74, v28, v29
    v_cvt_pk_bf16_f32 v67, v22, v23
    v_cvt_pk_bf16_f32 v75, v30, v31
    v_xor_b32 v68, s29, v64
    v_xor_b32 v76, s29, v72
    v_xor_b32 v69, s29, v65
    v_xor_b32 v77, s29, v73
    v_xor_b32 v70, s29, v66
    v_xor_b32 v78, s29, v74
    v_xor_b32 v71, s29, v67
    v_xor_b32 v79, s29, v75
    v_xor_b32 v80, s28, v72
    v_xor_b32 v81, s28, v73
    v_xor_b32 v82, s28, v74
    v_xor_b32 v83, s28, v75
    v_xor_b32 v84, s28, v76
    v_xor_b32 v85, s28, v77
    v_xor_b32 v86, s28, v78
    v_xor_b32 v87, s28, v79
    v_mul_f32 v13, 0x3a000000, v8
    v_mul_f32 v12, v13, v9
    v_mov_b32 v104, v12
    v_fmamk_f32 v105, v13, 0x3f800000, v12
    v_fmamk_f32 v106, v13, 0x40000000, v12
    v_fmamk_f32 v107, v13, 0x40400000, v12
    v_fmamk_f32 v108, v13, 0x41800000, v12
    v_fmamk_f32 v109, v13, 0x41880000, v12
    v_fmamk_f32 v110, v13, 0x41900000, v12
    v_fmamk_f32 v111, v13, 0x41980000, v12
    v_sin_f32 v112, v104
    v_cos_f32 v104, v104
    v_sin_f32 v113, v105
    v_cos_f32 v105, v105
    v_sin_f32 v114, v106
    v_cos_f32 v106, v106
    v_sin_f32 v115, v107
    v_cos_f32 v107, v107
    v_sin_f32 v116, v108
    v_cos_f32 v108, v108
    v_sin_f32 v117, v109
    v_cos_f32 v109, v109
    v_sin_f32 v118, v110
    v_cos_f32 v110, v110
    v_sin_f32 v119, v111
    v_cos_f32 v111, v111
    s_lshl_b32 s27, s19, 4
    v_cvt_f32_u32 v3, s27
    v_add_f32 v3, v3, v9
    v_mul_f32 v13, 0x3a000000, v10
    v_mul_f32 v12, v13, v3
    v_mov_b32 v120, v12
    v_fmamk_f32 v121, v13, 0x3f800000, v12
    v_fmamk_f32 v122, v13, 0x40000000, v12
    v_fmamk_f32 v123, v13, 0x40400000, v12
    v_sin_f32 v128, v120
    v_cos_f32 v120, v120
    v_sin_f32 v129, v121
    v_cos_f32 v121, v121
    v_sin_f32 v130, v122
    v_cos_f32 v122, v122
    v_sin_f32 v131, v123
    v_cos_f32 v123, v123
    v_add_f32 v10, 0x41800000, v10
    v_mul_f32 v13, 0x3a000000, v10
    v_mul_f32 v12, v13, v3
    v_mov_b32 v124, v12
    v_fmamk_f32 v125, v13, 0x3f800000, v12
    v_fmamk_f32 v126, v13, 0x40000000, v12
    v_fmamk_f32 v127, v13, 0x40400000, v12
    v_sin_f32 v132, v124
    v_cos_f32 v124, v124
    v_sin_f32 v133, v125
    v_cos_f32 v125, v125
    v_sin_f32 v134, v126
    v_cos_f32 v126, v126
    v_sin_f32 v135, v127
    v_cos_f32 v127, v127
    s_lshl_b32 s37, s3, 11
    s_add_u32 s37, s37, 32768
    s_lshl_b32 s38, s19, 11
    s_add_u32 s38, s38, s20
    s_lshl_b32 s27, s33, 13
    s_lshl_b32 s31, s34, 10
    s_add_u32 s31, s31, s27
    s_and_b32 s32, s19, 1
    s_lshl_b32 s36, s32, 3
    s_add_u32 s36, s36, s31
    v_add_u32 v5, s36, v4
    v_add_u32 v6, s31, v4
    s_xor_b32 s31, s31, 1024
    v_add_u32 v7, s31, v4
    s_lshl_b32 s27, s33, 2
    s_lshl_b32 s31, s19, 12
    s_add_u32 s27, s27, s31
    s_add_u32 s27, s27, 16384
    v_lshlrev_b32 v3, 3, v1
    v_lshl_add_u32 v3, v2, 10, v3
    v_add_u32 v3, s27, v3
    s_lshl_b32 s31, s3, 11
    s_add_u32 s27, s31, 16384
    v_add_u32 v1, s27, v4
    s_lshr_b32 s27, s18, 1
    s_lshl_b32 s27, s27, 14
    s_add_u32 s27, s27, s31
    s_add_u32 s27, s27, 0x6c0000
    s_mov_b32 s31, 0xffff0000
    s_lshl_b32 s39, s33, 2
    s_add_u32 s39, s39, 49152
    v_mov_b32 v2, s39
    v_mov_b32 v160, 0
    ds_write_b32 v2, v160
    s_waitcnt lgkmcnt(0)
    s_barrier
    buffer_load_dwordx4 v[8:11], v4, s[12:15], s21 offen offset:0 sc1
    buffer_load_dwordx4 v[24:27], v4, s[12:15], s23 offen offset:0 sc1
    buffer_load_dwordx4 v[12:15], v4, s[12:15], s22 offen offset:0 sc1
    buffer_load_dwordx4 v[28:31], v4, s[12:15], s24 offen offset:0 sc1
    buffer_load_dwordx4 v[16:19], v4, s[12:15], s21 offen offset:2048 sc1
    buffer_load_dwordx4 v[32:35], v4, s[12:15], s23 offen offset:2048 sc1
    buffer_load_dwordx4 v[20:23], v4, s[12:15], s22 offen offset:2048 sc1
    buffer_load_dwordx4 v[36:39], v4, s[12:15], s24 offen offset:2048 sc1
    s_waitcnt vmcnt(6)
    buffer_load_dwordx4 v[136:139], v4, s[12:15], s25 offen offset:0 sc1
    buffer_load_dwordx4 v[140:143], v4, s[12:15], s25 offen offset:1024 sc1
    buffer_load_dwordx4 v[152:155], v4, s[12:15], s26 offen offset:0 sc1
    buffer_load_dwordx4 v[156:159], v4, s[12:15], s26 offen offset:1024 sc1
    v_mfma_f32_16x16x32_bf16 v[88:91], v[8:11], v[40:43], 0
    v_mfma_f32_16x16x32_bf16 v[96:99], v[24:27], v[40:43], 0
    v_mfma_f32_16x16x32_bf16 v[88:91], v[24:27], v[48:51], v[88:91]
    v_mfma_f32_16x16x32_bf16 v[96:99], v[8:11], v[56:59], v[96:99]
    s_waitcnt vmcnt(8)
    v_mfma_f32_16x16x32_bf16 v[88:91], v[12:15], v[44:47], v[88:91]
    v_mfma_f32_16x16x32_bf16 v[96:99], v[28:31], v[44:47], v[96:99]
    v_mfma_f32_16x16x32_bf16 v[88:91], v[28:31], v[52:55], v[88:91]
    v_mfma_f32_16x16x32_bf16 v[96:99], v[12:15], v[60:63], v[96:99]
    s_waitcnt vmcnt(6)
    v_mfma_f32_16x16x32_bf16 v[92:95], v[16:19], v[40:43], 0
    v_mfma_f32_16x16x32_bf16 v[100:103], v[32:35], v[40:43], 0
    v_mfma_f32_16x16x32_bf16 v[92:95], v[32:35], v[48:51], v[92:95]
    v_mfma_f32_16x16x32_bf16 v[100:103], v[16:19], v[56:59], v[100:103]
    s_waitcnt vmcnt(4)
    v_mfma_f32_16x16x32_bf16 v[92:95], v[20:23], v[44:47], v[92:95]
    v_mfma_f32_16x16x32_bf16 v[100:103], v[36:39], v[44:47], v[100:103]
    v_mfma_f32_16x16x32_bf16 v[92:95], v[36:39], v[52:55], v[92:95]
    v_mfma_f32_16x16x32_bf16 v[100:103], v[20:23], v[60:63], v[100:103]
    s_cmp_eq_u32 s32, 0
    s_cbranch_scc1 Llo_26
    v_mov_b64 v[8:9], v[10:11]
    v_mov_b64 v[16:17], v[18:19]
    v_mov_b64 v[24:25], v[26:27]
    v_mov_b64 v[32:33], v[34:35]
Llo_26:
    s_nop 7
    v_pk_mul_f32 v[160:161], v[88:89], v[104:105]
    v_pk_mul_f32 v[162:163], v[96:97], v[104:105]
    v_pk_mul_f32 v[164:165], v[90:91], v[106:107]
    v_pk_mul_f32 v[166:167], v[98:99], v[106:107]
    v_pk_fma_f32 v[160:161], v[96:97], v[112:113], v[160:161]
    v_pk_fma_f32 v[162:163], v[88:89], v[112:113], v[162:163] neg_lo:[1,0,0] neg_hi:[1,0,0]
    v_pk_fma_f32 v[164:165], v[98:99], v[114:115], v[164:165]
    v_pk_fma_f32 v[166:167], v[90:91], v[114:115], v[166:167] neg_lo:[1,0,0] neg_hi:[1,0,0]
    v_cvt_pk_bf16_f32 v144, v160, v161
    v_cvt_pk_bf16_f32 v148, v162, v163
    v_cvt_pk_bf16_f32 v145, v164, v165
    v_cvt_pk_bf16_f32 v149, v166, v167
    v_pk_mul_f32 v[160:161], v[92:93], v[108:109]
    v_pk_mul_f32 v[162:163], v[100:101], v[108:109]
    v_pk_mul_f32 v[164:165], v[94:95], v[110:111]
    v_pk_mul_f32 v[166:167], v[102:103], v[110:111]
    v_pk_fma_f32 v[160:161], v[100:101], v[116:117], v[160:161]
    v_pk_fma_f32 v[162:163], v[92:93], v[116:117], v[162:163] neg_lo:[1,0,0] neg_hi:[1,0,0]
    v_pk_fma_f32 v[164:165], v[102:103], v[118:119], v[164:165]
    v_pk_fma_f32 v[166:167], v[94:95], v[118:119], v[166:167] neg_lo:[1,0,0] neg_hi:[1,0,0]
    v_cvt_pk_bf16_f32 v146, v160, v161
    v_cvt_pk_bf16_f32 v150, v162, v163
    v_cvt_pk_bf16_f32 v147, v164, v165
    v_cvt_pk_bf16_f32 v151, v166, v167
    s_nop 0
    v_mfma_f32_16x16x32_bf16 v[88:91], v[64:67], v[144:147], 0
    v_mfma_f32_16x16x32_bf16 v[96:99], v[64:67], v[148:151], 0
    v_mfma_f32_16x16x32_bf16 v[92:95], v[68:71], v[144:147], 0
    v_mfma_f32_16x16x32_bf16 v[100:103], v[68:71], v[148:151], 0
    v_mfma_f32_16x16x32_bf16 v[88:91], v[72:75], v[148:151], v[88:91]
    v_mfma_f32_16x16x32_bf16 v[96:99], v[80:83], v[144:147], v[96:99]
    v_mfma_f32_16x16x32_bf16 v[92:95], v[76:79], v[148:151], v[92:95]
    v_mfma_f32_16x16x32_bf16 v[100:103], v[84:87], v[144:147], v[100:103]
    s_waitcnt vmcnt(2)
    v_lshlrev_b32 v104, 16, v136
    v_and_b32 v112, s31, v136
    v_lshlrev_b32 v105, 16, v137
    v_and_b32 v113, s31, v137
    v_lshlrev_b32 v106, 16, v138
    v_and_b32 v114, s31, v138
    v_lshlrev_b32 v107, 16, v139
    v_and_b32 v115, s31, v139
    v_lshlrev_b32 v108, 16, v140
    v_and_b32 v116, s31, v140
    v_lshlrev_b32 v109, 16, v141
    v_and_b32 v117, s31, v141
    v_lshlrev_b32 v110, 16, v142
    v_and_b32 v118, s31, v142
    v_lshlrev_b32 v111, 16, v143
    v_and_b32 v119, s31, v143
    v_pk_mul_f32 v[160:161], v[88:89], v[104:105]
    v_pk_mul_f32 v[162:163], v[96:97], v[104:105]
    v_pk_mul_f32 v[164:165], v[90:91], v[106:107]
    v_pk_mul_f32 v[166:167], v[98:99], v[106:107]
    v_pk_fma_f32 v[160:161], v[96:97], v[112:113], v[160:161] neg_lo:[1,0,0] neg_hi:[1,0,0]
    v_pk_fma_f32 v[162:163], v[88:89], v[112:113], v[162:163]
    v_pk_fma_f32 v[164:165], v[98:99], v[114:115], v[164:165] neg_lo:[1,0,0] neg_hi:[1,0,0]
    v_pk_fma_f32 v[166:167], v[90:91], v[114:115], v[166:167]
    v_cvt_pk_bf16_f32 v144, v160, v161
    v_cvt_pk_bf16_f32 v148, v162, v163
    v_cvt_pk_bf16_f32 v145, v164, v165
    v_cvt_pk_bf16_f32 v149, v166, v167
    v_pk_mul_f32 v[160:161], v[92:93], v[108:109]
    v_pk_mul_f32 v[162:163], v[100:101], v[108:109]
    v_pk_mul_f32 v[164:165], v[94:95], v[110:111]
    v_pk_mul_f32 v[166:167], v[102:103], v[110:111]
    v_pk_fma_f32 v[160:161], v[100:101], v[116:117], v[160:161] neg_lo:[1,0,0] neg_hi:[1,0,0]
    v_pk_fma_f32 v[162:163], v[92:93], v[116:117], v[162:163]
    v_pk_fma_f32 v[164:165], v[102:103], v[118:119], v[164:165] neg_lo:[1,0,0] neg_hi:[1,0,0]
    v_pk_fma_f32 v[166:167], v[94:95], v[118:119], v[166:167]
    v_cvt_pk_bf16_f32 v146, v160, v161
    v_cvt_pk_bf16_f32 v150, v162, v163
    v_cvt_pk_bf16_f32 v147, v164, v165
    v_cvt_pk_bf16_f32 v151, v166, v167
    s_nop 0
    v_mfma_f32_16x16x32_bf16 v[88:91], v[144:147], v[64:67], 0
    v_mfma_f32_16x16x32_bf16 v[96:99], v[148:151], v[64:67], 0
    v_mfma_f32_16x16x32_bf16 v[92:95], v[144:147], v[68:71], 0
    v_mfma_f32_16x16x32_bf16 v[100:103], v[148:151], v[68:71], 0
    v_mfma_f32_16x16x32_bf16 v[88:91], v[148:151], v[80:83], v[88:91]
    v_mfma_f32_16x16x32_bf16 v[96:99], v[144:147], v[72:75], v[96:99]
    v_mfma_f32_16x16x32_bf16 v[92:95], v[148:151], v[84:87], v[92:95]
    v_mfma_f32_16x16x32_bf16 v[100:103], v[144:147], v[76:79], v[100:103]
    v_lshlrev_b32 v104, 16, v8
    v_and_b32 v105, s31, v8
    v_lshlrev_b32 v112, 16, v24
    v_and_b32 v113, s31, v24
    v_lshlrev_b32 v106, 16, v9
    v_and_b32 v107, s31, v9
    v_lshlrev_b32 v114, 16, v25
    v_and_b32 v115, s31, v25
    v_lshlrev_b32 v108, 16, v16
    v_and_b32 v109, s31, v16
    v_lshlrev_b32 v116, 16, v32
    v_and_b32 v117, s31, v32
    v_lshlrev_b32 v110, 16, v17
    v_and_b32 v111, s31, v17
    v_lshlrev_b32 v118, 16, v33
    v_and_b32 v119, s31, v33
    v_pk_mul_f32 v[160:161], v[88:89], v[120:121]
    v_pk_mul_f32 v[162:163], v[96:97], v[120:121]
    v_pk_mul_f32 v[164:165], v[90:91], v[122:123]
    v_pk_mul_f32 v[166:167], v[98:99], v[122:123]
    v_pk_fma_f32 v[160:161], v[96:97], v[128:129], v[160:161] neg_lo:[1,0,0] neg_hi:[1,0,0]
    v_pk_fma_f32 v[162:163], v[88:89], v[128:129], v[162:163]
    v_pk_fma_f32 v[164:165], v[98:99], v[130:131], v[164:165] neg_lo:[1,0,0] neg_hi:[1,0,0]
    v_pk_fma_f32 v[166:167], v[90:91], v[130:131], v[166:167]
    v_cvt_pk_bf16_f32 v144, v160, v161
    v_cvt_pk_bf16_f32 v148, v162, v163
    v_cvt_pk_bf16_f32 v145, v164, v165
    v_cvt_pk_bf16_f32 v149, v166, v167
    v_pk_mul_f32 v[160:161], v[92:93], v[124:125]
    v_pk_mul_f32 v[162:163], v[100:101], v[124:125]
    v_pk_mul_f32 v[164:165], v[94:95], v[126:127]
    v_pk_mul_f32 v[166:167], v[102:103], v[126:127]
    v_pk_fma_f32 v[160:161], v[100:101], v[132:133], v[160:161] neg_lo:[1,0,0] neg_hi:[1,0,0]
    v_pk_fma_f32 v[162:163], v[92:93], v[132:133], v[162:163]
    v_pk_fma_f32 v[164:165], v[102:103], v[134:135], v[164:165] neg_lo:[1,0,0] neg_hi:[1,0,0]
    v_pk_fma_f32 v[166:167], v[94:95], v[134:135], v[166:167]
    v_cvt_pk_bf16_f32 v146, v160, v161
    v_cvt_pk_bf16_f32 v150, v162, v163
    v_cvt_pk_bf16_f32 v147, v164, v165
    v_cvt_pk_bf16_f32 v151, v166, v167
    ds_write_b64 v5, v[144:145] offset:0
    ds_write_b64 v5, v[146:147] offset:2048
    ds_write_b64 v5, v[148:149] offset:4096
    ds_write_b64 v5, v[150:151] offset:6144
    s_waitcnt lgkmcnt(0)
    s_barrier
    ds_read_b128 v[8:11], v6 offset:0
    ds_read_b128 v[24:27], v6 offset:4096
    ds_read_b128 v[12:15], v7 offset:0
    ds_read_b128 v[28:31], v7 offset:4096
    ds_read_b128 v[16:19], v6 offset:2048
    ds_read_b128 v[32:35], v6 offset:6144
    ds_read_b128 v[20:23], v7 offset:2048
    ds_read_b128 v[36:39], v7 offset:6144
    s_waitcnt lgkmcnt(6)
    v_mfma_f32_16x16x32_bf16 v[88:91], v[40:43], v[8:11], 0
    v_mfma_f32_16x16x32_bf16 v[96:99], v[40:43], v[24:27], 0
    v_mfma_f32_16x16x32_bf16 v[88:91], v[56:59], v[24:27], v[88:91]
    v_mfma_f32_16x16x32_bf16 v[96:99], v[48:51], v[8:11], v[96:99]
    s_waitcnt lgkmcnt(4)
    v_mfma_f32_16x16x32_bf16 v[88:91], v[44:47], v[12:15], v[88:91]
    v_mfma_f32_16x16x32_bf16 v[96:99], v[44:47], v[28:31], v[96:99]
    v_mfma_f32_16x16x32_bf16 v[88:91], v[60:63], v[28:31], v[88:91]
    v_mfma_f32_16x16x32_bf16 v[96:99], v[52:55], v[12:15], v[96:99]
    s_waitcnt lgkmcnt(2)
    v_mfma_f32_16x16x32_bf16 v[92:95], v[40:43], v[16:19], 0
    v_mfma_f32_16x16x32_bf16 v[100:103], v[40:43], v[32:35], 0
    v_mfma_f32_16x16x32_bf16 v[92:95], v[56:59], v[32:35], v[92:95]
    v_mfma_f32_16x16x32_bf16 v[100:103], v[48:51], v[16:19], v[100:103]
    s_waitcnt lgkmcnt(0)
    v_mfma_f32_16x16x32_bf16 v[92:95], v[44:47], v[20:23], v[92:95]
    v_mfma_f32_16x16x32_bf16 v[100:103], v[44:47], v[36:39], v[100:103]
    v_mfma_f32_16x16x32_bf16 v[92:95], v[60:63], v[36:39], v[92:95]
    v_mfma_f32_16x16x32_bf16 v[100:103], v[52:55], v[20:23], v[100:103]
    s_waitcnt vmcnt(0)
    v_pk_fma_f32 v[104:105], v[88:89], v[152:153], v[104:105]
    v_pk_fma_f32 v[112:113], v[96:97], v[152:153], v[112:113]
    v_pk_fma_f32 v[106:107], v[90:91], v[154:155], v[106:107]
    v_pk_fma_f32 v[114:115], v[98:99], v[154:155], v[114:115]
    v_cvt_pk_bf16_f32 v136, v104, v112
    ds_write_b32 v3, v136 offset:0
    v_cvt_pk_bf16_f32 v137, v105, v113
    ds_write_b32 v3, v137 offset:256
    v_cvt_pk_bf16_f32 v138, v106, v114
    ds_write_b32 v3, v138 offset:512
    v_cvt_pk_bf16_f32 v139, v107, v115
    ds_write_b32 v3, v139 offset:768
    v_pk_fma_f32 v[108:109], v[92:93], v[156:157], v[108:109]
    v_pk_fma_f32 v[116:117], v[100:101], v[156:157], v[116:117]
    v_pk_fma_f32 v[110:111], v[94:95], v[158:159], v[110:111]
    v_pk_fma_f32 v[118:119], v[102:103], v[158:159], v[118:119]
    v_cvt_pk_bf16_f32 v140, v108, v116
    ds_write_b32 v3, v140 offset:128
    v_cvt_pk_bf16_f32 v141, v109, v117
    ds_write_b32 v3, v141 offset:384
    v_cvt_pk_bf16_f32 v142, v110, v118
    ds_write_b32 v3, v142 offset:640
    v_cvt_pk_bf16_f32 v143, v111, v119
    ds_write_b32 v3, v143 offset:896
    s_waitcnt lgkmcnt(0)
    s_barrier
    ds_read_b128 v[88:91], v1
    ds_read_b128 v[96:99], v1 offset:1024
    s_waitcnt lgkmcnt(1)
    buffer_store_dwordx4 v[88:91], v4, s[12:15], s27 offen sc1
    s_waitcnt lgkmcnt(0)
    buffer_store_dwordx4 v[96:99], v4, s[12:15], s27 offen offset:1024 sc1
    s_branch P2_done
P2_help:
    s_cmp_ge_u32 s3, 10
    s_cbranch_scc1 Lb_27
    s_and_b32 s22, s2, 7
    s_mul_i32 s22, s22, 32768
    s_add_u32 s22, s22, 0x2dee800
    v_lshlrev_b32 v1, 5, v0
    s_lshl_b32 s20, s30, 11
    s_add_u32 s20, s20, s22
    s_cmp_eq_u32 s3, 8
    s_cbranch_scc1 L5_28
    s_cmp_ge_u32 s16, 36
    s_cselect_b32 s21, 36, 0
    s_sub_u32 s21, s16, s21
    s_mul_i32 s21, s21, 43
    s_lshr_b32 s21, s21, 8
    s_lshl_b32 s21, s21, 8
    s_add_u32 s20, s21, s22
    s_add_u32 s20, s20, 6144
    s_mov_b64 exec, 0xff
L5_28:
    s_mov_b32 s93, 0x1fffff
Lpoll_29:
    buffer_load_dword v2, v1, s[12:15], s20 offen sc1
    s_and_b32 s92, s93, 63
    s_cbranch_scc1 Lchk_31
    s_waitcnt vmcnt(0)
    v_mov_b32 v2, 0
    buffer_atomic_or v2, v1, s[12:15], s20 offen sc0 sc1
Lchk_31:
    s_waitcnt vmcnt(0)
    v_cmp_eq_u32 vcc, 0, v2
    s_nop 4
    s_cbranch_vccz Lgo_30
    s_mov_b64 exec, vcc
    s_sleep 3
    s_sub_u32 s93, s93, 1
    s_cbranch_scc0 Lpoll_29
Lgo_30:
    s_mov_b64 exec, -1
    s_cmp_eq_u32 s3, 8
    s_cbranch_scc1 Lb_27
    v_mov_b32 v1, 150552
    v_mov_b32 v2, 1
    ds_write_b32 v1, v2
Lb_27:
    s_barrier
    s_barrier
    s_barrier
    s_branch P2_done
P2_cw1:
    s_cmp_ge_u32 s2, 189
    s_cbranch_scc1 PA_entry
    s_load_dwordx2 s[8:9], s[0:1], 32
    s_mov_b32 s10, 0xa2000
    s_mov_b32 s11, 0x20000
    s_sub_u32 s16, s2, 144
    s_and_b32 s17, s16, 7
    s_lshr_b32 s18, s16, 3
    s_sub_u32 s19, s16, 40
    s_cmp_ge_u32 s16, 40
    s_cselect_b32 s17, 8, s17
    s_cselect_b32 s18, s19, s18
    v_lshrrev_b32 v3, 3, v0
    v_and_b32 v4, 2, v3
    v_and_b32 v1, 7, v0
    v_xor_b32 v1, v1, v4
    v_lshlrev_b32 v1, 4, v1
    v_mul_u32_u24 v3, 1152, v3
    v_xor_b32 v2, 64, v1
    v_add_u32 v1, v1, v3
    v_add_u32 v2, v2, v3
    s_mul_i32 s20, s3, 55296
    s_lshl_b32 s21, s17, 7
    s_add_u32 s20, s20, s21
    s_mul_i32 s21, s3, 6144
    s_waitcnt lgkmcnt(0)
    s_add_u32 m0, s21, 0
    s_nop 0
    buffer_load_dwordx4 v1, s[8:11], s20 offen lds
    s_add_u32 s20, s20, 9216
    s_add_u32 m0, s21, 1024
    s_nop 0
    buffer_load_dwordx4 v2, s[8:11], s20 offen lds
    s_add_u32 s20, s20, 9216
    s_add_u32 m0, s21, 2048
    s_nop 0
    buffer_load_dwordx4 v1, s[8:11], s20 offen lds
    s_add_u32 s20, s20, 9216
    s_add_u32 m0, s21, 3072
    s_nop 0
    buffer_load_dwordx4 v2, s[8:11], s20 offen lds
    s_add_u32 s20, s20, 9216
    s_add_u32 m0, s21, 4096
    s_nop 0
    buffer_load_dwordx4 v1, s[8:11], s20 offen lds
    s_add_u32 s20, s20, 9216
    s_add_u32 m0, s21, 5120
    s_nop 0
    buffer_load_dwordx4 v2, s[8:11], s20 offen lds
    s_cmp_eq_u32 s18, 0
    s_cselect_b32 s19, 8, 7
    s_cselect_b32 s22, 0, 1
    s_cmp_ge_u32 s3, s19
    s_cbranch_scc1 Lidle_32
    s_mul_i32 s19, s18, 7
    s_add_u32 s22, s22, s19
    s_add_u32 s22, s22, s3
    s_lshl_b32 s24, s22, 4
    s_cmp_lt_u32 s22, 18
    s_cselect_b32 s25, 2, -287
    s_add_i32 s24, s24, s25
    v_and_b32 v60, 14, v0
    v_add_u32 v60, s24, v60
    v_cvt_f32_u32 v76, v60
    v_mul_f32 v76, 0x3ae38e39, v76
    v_cmp_eq_u32 vcc, 288, v60
    v_mov_b32 v80, 0x3d715bef
    v_mov_b32 v61, 0x3d2aaaab
    v_cndmask_b32 v80, v80, v61, vcc
    v_and_b32 v60, 1, v0
    v_cvt_f32_u32 v60, v60
    v_mul_f32 v78, 0x3e800000, v60
    v_lshrrev_b32 v60, 4, v0
    v_lshlrev_b32 v60, 3, v60
    v_cvt_f32_u32 v60, v60
    v_fmac_f32 v78, v60, v76
    s_mov_b32 s24, 0x00000000
    s_mov_b32 s25, 0x3f800000
    v_pk_fma_f32 v[60:61], v[76:77], s[24:25], v[78:79] op_sel_hi:[0,1,0]
    s_mov_b32 s24, 0x40000000
    s_mov_b32 s25, 0x40400000
    v_pk_fma_f32 v[62:63], v[76:77], s[24:25], v[78:79] op_sel_hi:[0,1,0]
    s_mov_b32 s24, 0x40800000
    s_mov_b32 s25, 0x40a00000
    v_pk_fma_f32 v[64:65], v[76:77], s[24:25], v[78:79] op_sel_hi:[0,1,0]
    s_mov_b32 s24, 0x40c00000
    s_mov_b32 s25, 0x40e00000
    v_pk_fma_f32 v[66:67], v[76:77], s[24:25], v[78:79] op_sel_hi:[0,1,0]
    v_mul_f32 v78, 0x42000000, v76
    v_pk_add_f32 v[68:69], v[60:61], v[78:79] op_sel_hi:[1,0]
    v_pk_add_f32 v[70:71], v[62:63], v[78:79] op_sel_hi:[1,0]
    v_pk_add_f32 v[72:73], v[64:65], v[78:79] op_sel_hi:[1,0]
    v_pk_add_f32 v[74:75], v[66:67], v[78:79] op_sel_hi:[1,0]
    v_cos_f32 v78, v78
    v_cos_f32 v60, v60
    v_cos_f32 v61, v61
    v_cos_f32 v62, v62
    v_cos_f32 v63, v63
    v_cos_f32 v64, v64
    v_cos_f32 v65, v65
    v_cos_f32 v66, v66
    v_cos_f32 v67, v67
    v_cos_f32 v68, v68
    v_cos_f32 v69, v69
    v_cos_f32 v70, v70
    v_cos_f32 v71, v71
    v_cos_f32 v72, v72
    v_cos_f32 v73, v73
    v_cos_f32 v74, v74
    v_cos_f32 v75, v75
    v_add_f32 v78, v78, v78
    v_pk_mul_f32 v[60:61], v[60:61], v[80:81] op_sel_hi:[1,0]
    v_pk_mul_f32 v[62:63], v[62:63], v[80:81] op_sel_hi:[1,0]
    v_pk_mul_f32 v[64:65], v[64:65], v[80:81] op_sel_hi:[1,0]
    v_pk_mul_f32 v[66:67], v[66:67], v[80:81] op_sel_hi:[1,0]
    v_pk_mul_f32 v[68:69], v[68:69], v[80:81] op_sel_hi:[1,0]
    v_pk_mul_f32 v[70:71], v[70:71], v[80:81] op_sel_hi:[1,0]
    v_pk_mul_f32 v[72:73], v[72:73], v[80:81] op_sel_hi:[1,0]
    v_pk_mul_f32 v[74:75], v[74:75], v[80:81] op_sel_hi:[1,0]
    v_cvt_pk_bf16_f32 v24, v60, v61
    v_cvt_pk_bf16_f32 v25, v62, v63
    v_cvt_pk_bf16_f32 v26, v64, v65
    v_cvt_pk_bf16_f32 v27, v66, v67
    v_cvt_pk_bf16_f32 v28, v68, v69
    v_cvt_pk_bf16_f32 v29, v70, v71
    v_cvt_pk_bf16_f32 v30, v72, v73
    v_cvt_pk_bf16_f32 v31, v74, v75
    v_pk_fma_f32 v[60:61], v[68:69], v[78:79], v[60:61] op_sel_hi:[1,0,1] neg_lo:[0,0,1] neg_hi:[0,0,1]
    v_pk_fma_f32 v[62:63], v[70:71], v[78:79], v[62:63] op_sel_hi:[1,0,1] neg_lo:[0,0,1] neg_hi:[0,0,1]
    v_pk_fma_f32 v[64:65], v[72:73], v[78:79], v[64:65] op_sel_hi:[1,0,1] neg_lo:[0,0,1] neg_hi:[0,0,1]
    v_pk_fma_f32 v[66:67], v[74:75], v[78:79], v[66:67] op_sel_hi:[1,0,1] neg_lo:[0,0,1] neg_hi:[0,0,1]
    v_cvt_pk_bf16_f32 v32, v60, v61
    v_cvt_pk_bf16_f32 v33, v62, v63
    v_cvt_pk_bf16_f32 v34, v64, v65
    v_cvt_pk_bf16_f32 v35, v66, v67
    v_pk_fma_f32 v[68:69], v[60:61], v[78:79], v[68:69] op_sel_hi:[1,0,1] neg_lo:[0,0,1] neg_hi:[0,0,1]
    v_pk_fma_f32 v[70:71], v[62:63], v[78:79], v[70:71] op_sel_hi:[1,0,1] neg_lo:[0,0,1] neg_hi:[0,0,1]
    v_pk_fma_f32 v[72:73], v[64:65], v[78:79], v[72:73] op_sel_hi:[1,0,1] neg_lo:[0,0,1] neg_hi:[0,0,1]
    v_pk_fma_f32 v[74:75], v[66:67], v[78:79], v[74:75] op_sel_hi:[1,0,1] neg_lo:[0,0,1] neg_hi:[0,0,1]
    v_cvt_pk_bf16_f32 v36, v68, v69
    v_cvt_pk_bf16_f32 v37, v70, v71
    v_cvt_pk_bf16_f32 v38, v72, v73
    v_cvt_pk_bf16_f32 v39, v74, v75
    v_pk_fma_f32 v[60:61], v[68:69], v[78:79], v[60:61] op_sel_hi:[1,0,1] neg_lo:[0,0,1] neg_hi:[0,0,1]
    v_pk_fma_f32 v[62:63], v[70:71], v[78:79], v[62:63] op_sel_hi:[1,0,1] neg_lo:[0,0,1] neg_hi:[0,0,1]
    v_pk_fma_f32 v[64:65], v[72:73], v[78:79], v[64:65] op_sel_hi:[1,0,1] neg_lo:[0,0,1] neg_hi:[0,0,1]
    v_pk_fma_f32 v[66:67], v[74:75], v[78:79], v[66:67] op_sel_hi:[1,0,1] neg_lo:[0,0,1] neg_hi:[0,0,1]
    v_cvt_pk_bf16_f32 v40, v60, v61
    v_cvt_pk_bf16_f32 v41, v62, v63
    v_cvt_pk_bf16_f32 v42, v64, v65
    v_cvt_pk_bf16_f32 v43, v66, v67
    v_pk_fma_f32 v[68:69], v[60:61], v[78:79], v[68:69] op_sel_hi:[1,0,1] neg_lo:[0,0,1] neg_hi:[0,0,1]
    v_pk_fma_f32 v[70:71], v[62:63], v[78:79], v[70:71] op_sel_hi:[1,0,1] neg_lo:[0,0,1] neg_hi:[0,0,1]
    v_pk_fma_f32 v[72:73], v[64:65], v[78:79], v[72:73] op_sel_hi:[1,0,1] neg_lo:[0,0,1] neg_hi:[0,0,1]
    v_pk_fma_f32 v[74:75], v[66:67], v[78:79], v[74:75] op_sel_hi:[1,0,1] neg_lo:[0,0,1] neg_hi:[0,0,1]
    v_cvt_pk_bf16_f32 v44, v68, v69
    v_cvt_pk_bf16_f32 v45, v70, v71
    v_cvt_pk_bf16_f32 v46, v72, v73
    v_cvt_pk_bf16_f32 v47, v74, v75
    v_pk_fma_f32 v[60:61], v[68:69], v[78:79], v[60:61] op_sel_hi:[1,0,1] neg_lo:[0,0,1] neg_hi:[0,0,1]
    v_pk_fma_f32 v[62:63], v[70:71], v[78:79], v[62:63] op_sel_hi:[1,0,1] neg_lo:[0,0,1] neg_hi:[0,0,1]
    v_pk_fma_f32 v[64:65], v[72:73], v[78:79], v[64:65] op_sel_hi:[1,0,1] neg_lo:[0,0,1] neg_hi:[0,0,1]
    v_pk_fma_f32 v[66:67], v[74:75], v[78:79], v[66:67] op_sel_hi:[1,0,1] neg_lo:[0,0,1] neg_hi:[0,0,1]
    v_cvt_pk_bf16_f32 v48, v60, v61
    v_cvt_pk_bf16_f32 v49, v62, v63
    v_cvt_pk_bf16_f32 v50, v64, v65
    v_cvt_pk_bf16_f32 v51, v66, v67
    v_pk_fma_f32 v[68:69], v[60:61], v[78:79], v[68:69] op_sel_hi:[1,0,1] neg_lo:[0,0,1] neg_hi:[0,0,1]
    v_pk_fma_f32 v[70:71], v[62:63], v[78:79], v[70:71] op_sel_hi:[1,0,1] neg_lo:[0,0,1] neg_hi:[0,0,1]
    v_pk_fma_f32 v[72:73], v[64:65], v[78:79], v[72:73] op_sel_hi:[1,0,1] neg_lo:[0,0,1] neg_hi:[0,0,1]
    v_pk_fma_f32 v[74:75], v[66:67], v[78:79], v[74:75] op_sel_hi:[1,0,1] neg_lo:[0,0,1] neg_hi:[0,0,1]
    v_cvt_pk_bf16_f32 v52, v68, v69
    v_cvt_pk_bf16_f32 v53, v70, v71
    v_cvt_pk_bf16_f32 v54, v72, v73
    v_cvt_pk_bf16_f32 v55, v74, v75
    v_pk_fma_f32 v[60:61], v[68:69], v[78:79], v[60:61] op_sel_hi:[1,0,1] neg_lo:[0,0,1] neg_hi:[0,0,1]
    v_pk_fma_f32 v[62:63], v[70:71], v[78:79], v[62:63] op_sel_hi:[1,0,1] neg_lo:[0,0,1] neg_hi:[0,0,1]
    v_pk_fma_f32 v[64:65], v[72:73], v[78:79], v[64:65] op_sel_hi:[1,0,1] neg_lo:[0,0,1] neg_hi:[0,0,1]
    v_pk_fma_f32 v[66:67], v[74:75], v[78:79], v[66:67] op_sel_hi:[1,0,1] neg_lo:[0,0,1] neg_hi:[0,0,1]
    v_cvt_pk_bf16_f32 v56, v60, v61
    v_cvt_pk_bf16_f32 v57, v62, v63
    v_cvt_pk_bf16_f32 v58, v64, v65
    v_cvt_pk_bf16_f32 v59, v66, v67
    v_bfe_u32 v6, v0, 4, 1
    v_mul_u32_u24 v5, 18432, v6
    v_lshrrev_b32 v6, 5, v0
    v_lshl_add_u32 v5, v6, 8, v5
    v_and_b32 v6, 15, v0
    v_lshl_add_u32 v5, v6, 4, v5
    v_lshrrev_b32 v6, 4, v0
    v_bfe_u32 v7, v0, 2, 2
    v_lshl_add_u32 v8, v6, 3, v7
    v_lshlrev_b32 v8, 7, v8
    v_and_b32 v6, 1, v6
    v_lshlrev_b32 v6, 1, v6
    v_lshrrev_b32 v7, 1, v7
    v_or_b32 v6, v6, v7
    v_lshl_add_u32 v8, v6, 5, v8
    v_and_b32 v7, 3, v0
    v_lshl_add_u32 v8, v7, 3, v8
    v_xor_b32 v9, 32, v8
    v_xor_b32 v10, 64, v8
    v_xor_b32 v11, 96, v8
    v_add_u32 v12, 36864, v8
    v_add_u32 v13, 36864, v9
    v_add_u32 v14, 36864, v10
    v_add_u32 v15, 36864, v11
    s_mul_i32 s19, s17, 73728
    s_lshl_b32 s21, s22, 9
    s_add_u32 s19, s19, s21
    s_add_u32 s19, s19, 0x1104000
    s_add_u32 s20, s19, 36864
    s_cmp_ge_u32 s22, 18
    s_cselect_b32 s21, 0xbf800000, 1.0
    s_waitcnt vmcnt(0)
    s_barrier
    ds_read_b64_tr_b16 v[112:113], v8 offset:0
    ds_read_b64_tr_b16 v[114:115], v8 offset:512
    ds_read_b64_tr_b16 v[116:117], v9 offset:0
    ds_read_b64_tr_b16 v[118:119], v9 offset:512
    ds_read_b64_tr_b16 v[120:121], v10 offset:0
    ds_read_b64_tr_b16 v[122:123], v10 offset:512
    ds_read_b64_tr_b16 v[124:125], v11 offset:0
    ds_read_b64_tr_b16 v[126:127], v11 offset:512
    ds_read_b64_tr_b16 v[128:129], v8 offset:4096
    ds_read_b64_tr_b16 v[130:131], v8 offset:4608
    ds_read_b64_tr_b16 v[132:133], v9 offset:4096
    ds_read_b64_tr_b16 v[134:135], v9 offset:4608
    s_waitcnt lgkmcnt(10)
    v_mfma_f32_16x16x32_bf16 v[80:83], v[24:27], v[112:115], 0
    ds_read_b64_tr_b16 v[112:113], v10 offset:4096
    ds_read_b64_tr_b16 v[114:115], v10 offset:4608
    s_waitcnt lgkmcnt(10)
    v_mfma_f32_16x16x32_bf16 v[84:87], v[24:27], v[116:119], 0
    ds_read_b64_tr_b16 v[116:117], v11 offset:4096
    ds_read_b64_tr_b16 v[118:119], v11 offset:4608
    s_waitcnt lgkmcnt(10)
    v_mfma_f32_16x16x32_bf16 v[88:91], v[24:27], v[120:123], 0
    ds_read_b64_tr_b16 v[120:121], v8 offset:8192
    ds_read_b64_tr_b16 v[122:123], v8 offset:8704
    s_waitcnt lgkmcnt(10)
    v_mfma_f32_16x16x32_bf16 v[92:95], v[24:27], v[124:127], 0
    ds_read_b64_tr_b16 v[124:125], v9 offset:8192
    ds_read_b64_tr_b16 v[126:127], v9 offset:8704
    s_waitcnt lgkmcnt(10)
    v_mfma_f32_16x16x32_bf16 v[80:83], v[28:31], v[128:131], v[80:83]
    ds_read_b64_tr_b16 v[128:129], v10 offset:8192
    ds_read_b64_tr_b16 v[130:131], v10 offset:8704
    s_waitcnt lgkmcnt(10)
    v_mfma_f32_16x16x32_bf16 v[84:87], v[28:31], v[132:135], v[84:87]
    ds_read_b64_tr_b16 v[132:133], v11 offset:8192
    ds_read_b64_tr_b16 v[134:135], v11 offset:8704
    s_waitcnt lgkmcnt(10)
    v_mfma_f32_16x16x32_bf16 v[88:91], v[28:31], v[112:115], v[88:91]
    ds_read_b64_tr_b16 v[112:113], v8 offset:12288
    ds_read_b64_tr_b16 v[114:115], v8 offset:12800
    s_waitcnt lgkmcnt(10)
    v_mfma_f32_16x16x32_bf16 v[92:95], v[28:31], v[116:119], v[92:95]
    ds_read_b64_tr_b16 v[116:117], v9 offset:12288
    ds_read_b64_tr_b16 v[118:119], v9 offset:12800
    s_waitcnt lgkmcnt(10)
    v_mfma_f32_16x16x32_bf16 v[80:83], v[32:35], v[120:123], v[80:83]
    ds_read_b64_tr_b16 v[120:121], v10 offset:12288
    ds_read_b64_tr_b16 v[122:123], v10 offset:12800
    s_waitcnt lgkmcnt(10)
    v_mfma_f32_16x16x32_bf16 v[84:87], v[32:35], v[124:127], v[84:87]
    ds_read_b64_tr_b16 v[124:125], v11 offset:12288
    ds_read_b64_tr_b16 v[126:127], v11 offset:12800
    s_waitcnt lgkmcnt(10)
    v_mfma_f32_16x16x32_bf16 v[88:91], v[32:35], v[128:131], v[88:91]
    ds_read_b64_tr_b16 v[128:129], v8 offset:16384
    ds_read_b64_tr_b16 v[130:131], v8 offset:16896
    s_waitcnt lgkmcnt(10)
    v_mfma_f32_16x16x32_bf16 v[92:95], v[32:35], v[132:135], v[92:95]
    ds_read_b64_tr_b16 v[132:133], v9 offset:16384
    ds_read_b64_tr_b16 v[134:135], v9 offset:16896
    s_waitcnt lgkmcnt(10)
    v_mfma_f32_16x16x32_bf16 v[80:83], v[36:39], v[112:115], v[80:83]
    ds_read_b64_tr_b16 v[112:113], v10 offset:16384
    ds_read_b64_tr_b16 v[114:115], v10 offset:16896
    s_waitcnt lgkmcnt(10)
    v_mfma_f32_16x16x32_bf16 v[84:87], v[36:39], v[116:119], v[84:87]
    ds_read_b64_tr_b16 v[116:117], v11 offset:16384
    ds_read_b64_tr_b16 v[118:119], v11 offset:16896
    s_waitcnt lgkmcnt(10)
    v_mfma_f32_16x16x32_bf16 v[88:91], v[36:39], v[120:123], v[88:91]
    ds_read_b64_tr_b16 v[120:121], v8 offset:20480
    ds_read_b64_tr_b16 v[122:123], v8 offset:20992
    s_waitcnt lgkmcnt(10)
    v_mfma_f32_16x16x32_bf16 v[92:95], v[36:39], v[124:127], v[92:95]
    ds_read_b64_tr_b16 v[124:125], v9 offset:20480
    ds_read_b64_tr_b16 v[126:127], v9 offset:20992
    s_waitcnt lgkmcnt(10)
    v_mfma_f32_16x16x32_bf16 v[80:83], v[40:43], v[128:131], v[80:83]
    ds_read_b64_tr_b16 v[128:129], v10 offset:20480
    ds_read_b64_tr_b16 v[130:131], v10 offset:20992
    s_waitcnt lgkmcnt(10)
    v_mfma_f32_16x16x32_bf16 v[84:87], v[40:43], v[132:135], v[84:87]
    ds_read_b64_tr_b16 v[132:133], v11 offset:20480
    ds_read_b64_tr_b16 v[134:135], v11 offset:20992
    s_waitcnt lgkmcnt(10)
    v_mfma_f32_16x16x32_bf16 v[88:91], v[40:43], v[112:115], v[88:91]
    ds_read_b64_tr_b16 v[112:113], v8 offset:24576
    ds_read_b64_tr_b16 v[114:115], v8 offset:25088
    s_waitcnt lgkmcnt(10)
    v_mfma_f32_16x16x32_bf16 v[92:95], v[40:43], v[116:119], v[92:95]
    ds_read_b64_tr_b16 v[116:117], v9 offset:24576
    ds_read_b64_tr_b16 v[118:119], v9 offset:25088
    s_waitcnt lgkmcnt(10)
    v_mfma_f32_16x16x32_bf16 v[80:83], v[44:47], v[120:123], v[80:83]
    ds_read_b64_tr_b16 v[120:121], v10 offset:24576
    ds_read_b64_tr_b16 v[122:123], v10 offset:25088
    s_waitcnt lgkmcnt(10)
    v_mfma_f32_16x16x32_bf16 v[84:87], v[44:47], v[124:127], v[84:87]
    ds_read_b64_tr_b16 v[124:125], v11 offset:24576
    ds_read_b64_tr_b16 v[126:127], v11 offset:25088
    s_waitcnt lgkmcnt(10)
    v_mfma_f32_16x16x32_bf16 v[88:91], v[44:47], v[128:131], v[88:91]
    ds_read_b64_tr_b16 v[128:129], v8 offset:28672
    ds_read_b64_tr_b16 v[130:131], v8 offset:29184
    s_waitcnt lgkmcnt(10)
    v_mfma_f32_16x16x32_bf16 v[92:95], v[44:47], v[132:135], v[92:95]
    ds_read_b64_tr_b16 v[132:133], v9 offset:28672
    ds_read_b64_tr_b16 v[134:135], v9 offset:29184
    s_waitcnt lgkmcnt(10)
    v_mfma_f32_16x16x32_bf16 v[80:83], v[48:51], v[112:115], v[80:83]
    ds_read_b64_tr_b16 v[112:113], v10 offset:28672
    ds_read_b64_tr_b16 v[114:115], v10 offset:29184
    s_waitcnt lgkmcnt(10)
    v_mfma_f32_16x16x32_bf16 v[84:87], v[48:51], v[116:119], v[84:87]
    ds_read_b64_tr_b16 v[116:117], v11 offset:28672
    ds_read_b64_tr_b16 v[118:119], v11 offset:29184
    s_waitcnt lgkmcnt(10)
    v_mfma_f32_16x16x32_bf16 v[88:91], v[48:51], v[120:123], v[88:91]
    ds_read_b64_tr_b16 v[120:121], v8 offset:32768
    ds_read_b64_tr_b16 v[122:123], v8 offset:33280
    s_waitcnt lgkmcnt(10)
    v_mfma_f32_16x16x32_bf16 v[92:95], v[48:51], v[124:127], v[92:95]
    ds_read_b64_tr_b16 v[124:125], v9 offset:32768
    ds_read_b64_tr_b16 v[126:127], v9 offset:33280
    s_waitcnt lgkmcnt(10)
    v_mfma_f32_16x16x32_bf16 v[80:83], v[52:55], v[128:131], v[80:83]
    ds_read_b64_tr_b16 v[128:129], v10 offset:32768
    ds_read_b64_tr_b16 v[130:131], v10 offset:33280
    s_waitcnt lgkmcnt(10)
    v_mfma_f32_16x16x32_bf16 v[84:87], v[52:55], v[132:135], v[84:87]
    ds_read_b64_tr_b16 v[132:133], v11 offset:32768
    ds_read_b64_tr_b16 v[134:135], v11 offset:33280
    s_waitcnt lgkmcnt(10)
    v_mfma_f32_16x16x32_bf16 v[88:91], v[52:55], v[112:115], v[88:91]
    ds_read_b64_tr_b16 v[112:113], v12 offset:0
    ds_read_b64_tr_b16 v[114:115], v12 offset:512
    s_waitcnt lgkmcnt(10)
    v_mfma_f32_16x16x32_bf16 v[92:95], v[52:55], v[116:119], v[92:95]
    ds_read_b64_tr_b16 v[116:117], v13 offset:0
    ds_read_b64_tr_b16 v[118:119], v13 offset:512
    s_waitcnt lgkmcnt(10)
    v_mfma_f32_16x16x32_bf16 v[80:83], v[56:59], v[120:123], v[80:83]
    ds_read_b64_tr_b16 v[120:121], v14 offset:0
    ds_read_b64_tr_b16 v[122:123], v14 offset:512
    s_waitcnt lgkmcnt(10)
    v_mfma_f32_16x16x32_bf16 v[84:87], v[56:59], v[124:127], v[84:87]
    ds_read_b64_tr_b16 v[124:125], v15 offset:0
    ds_read_b64_tr_b16 v[126:127], v15 offset:512
    s_waitcnt lgkmcnt(10)
    v_mfma_f32_16x16x32_bf16 v[88:91], v[56:59], v[128:131], v[88:91]
    ds_read_b64_tr_b16 v[128:129], v12 offset:4096
    ds_read_b64_tr_b16 v[130:131], v12 offset:4608
    s_waitcnt lgkmcnt(10)
    v_mfma_f32_16x16x32_bf16 v[92:95], v[56:59], v[132:135], v[92:95]
    ds_read_b64_tr_b16 v[132:133], v13 offset:4096
    ds_read_b64_tr_b16 v[134:135], v13 offset:4608
    s_waitcnt lgkmcnt(10)
    v_mfma_f32_16x16x32_bf16 v[96:99], v[24:27], v[112:115], 0
    ds_read_b64_tr_b16 v[112:113], v14 offset:4096
    ds_read_b64_tr_b16 v[114:115], v14 offset:4608
    s_waitcnt lgkmcnt(10)
    v_mfma_f32_16x16x32_bf16 v[100:103], v[24:27], v[116:119], 0
    ds_read_b64_tr_b16 v[116:117], v15 offset:4096
    ds_read_b64_tr_b16 v[118:119], v15 offset:4608
    s_waitcnt lgkmcnt(10)
    v_mfma_f32_16x16x32_bf16 v[104:107], v[24:27], v[120:123], 0
    ds_read_b64_tr_b16 v[120:121], v12 offset:8192
    ds_read_b64_tr_b16 v[122:123], v12 offset:8704
    s_waitcnt lgkmcnt(10)
    v_mfma_f32_16x16x32_bf16 v[108:111], v[24:27], v[124:127], 0
    ds_read_b64_tr_b16 v[124:125], v13 offset:8192
    ds_read_b64_tr_b16 v[126:127], v13 offset:8704
    s_waitcnt lgkmcnt(10)
    v_mfma_f32_16x16x32_bf16 v[96:99], v[28:31], v[128:131], v[96:99]
    ds_read_b64_tr_b16 v[128:129], v14 offset:8192
    ds_read_b64_tr_b16 v[130:131], v14 offset:8704
    s_waitcnt lgkmcnt(10)
    v_mfma_f32_16x16x32_bf16 v[100:103], v[28:31], v[132:135], v[100:103]
    ds_read_b64_tr_b16 v[132:133], v15 offset:8192
    ds_read_b64_tr_b16 v[134:135], v15 offset:8704
    s_waitcnt lgkmcnt(10)
    v_mfma_f32_16x16x32_bf16 v[104:107], v[28:31], v[112:115], v[104:107]
    ds_read_b64_tr_b16 v[112:113], v12 offset:12288
    ds_read_b64_tr_b16 v[114:115], v12 offset:12800
    s_waitcnt lgkmcnt(10)
    v_mfma_f32_16x16x32_bf16 v[108:111], v[28:31], v[116:119], v[108:111]
    ds_read_b64_tr_b16 v[116:117], v13 offset:12288
    ds_read_b64_tr_b16 v[118:119], v13 offset:12800
    s_waitcnt lgkmcnt(10)
    v_mfma_f32_16x16x32_bf16 v[96:99], v[32:35], v[120:123], v[96:99]
    ds_read_b64_tr_b16 v[120:121], v14 offset:12288
    ds_read_b64_tr_b16 v[122:123], v14 offset:12800
    s_waitcnt lgkmcnt(10)
    v_mfma_f32_16x16x32_bf16 v[100:103], v[32:35], v[124:127], v[100:103]
    ds_read_b64_tr_b16 v[124:125], v15 offset:12288
    ds_read_b64_tr_b16 v[126:127], v15 offset:12800
    s_waitcnt lgkmcnt(10)
    v_mfma_f32_16x16x32_bf16 v[104:107], v[32:35], v[128:131], v[104:107]
    ds_read_b64_tr_b16 v[128:129], v12 offset:16384
    ds_read_b64_tr_b16 v[130:131], v12 offset:16896
    s_waitcnt lgkmcnt(10)
    v_mfma_f32_16x16x32_bf16 v[108:111], v[32:35], v[132:135], v[108:111]
    ds_read_b64_tr_b16 v[132:133], v13 offset:16384
    ds_read_b64_tr_b16 v[134:135], v13 offset:16896
    s_waitcnt lgkmcnt(10)
    v_mfma_f32_16x16x32_bf16 v[96:99], v[36:39], v[112:115], v[96:99]
    ds_read_b64_tr_b16 v[112:113], v14 offset:16384
    ds_read_b64_tr_b16 v[114:115], v14 offset:16896
    s_waitcnt lgkmcnt(10)
    v_mfma_f32_16x16x32_bf16 v[100:103], v[36:39], v[116:119], v[100:103]
    ds_read_b64_tr_b16 v[116:117], v15 offset:16384
    ds_read_b64_tr_b16 v[118:119], v15 offset:16896
    s_waitcnt lgkmcnt(10)
    v_mfma_f32_16x16x32_bf16 v[104:107], v[36:39], v[120:123], v[104:107]
    ds_read_b64_tr_b16 v[120:121], v12 offset:20480
    ds_read_b64_tr_b16 v[122:123], v12 offset:20992
    s_waitcnt lgkmcnt(10)
    v_mfma_f32_16x16x32_bf16 v[108:111], v[36:39], v[124:127], v[108:111]
    ds_read_b64_tr_b16 v[124:125], v13 offset:20480
    ds_read_b64_tr_b16 v[126:127], v13 offset:20992
    s_waitcnt lgkmcnt(10)
    v_mfma_f32_16x16x32_bf16 v[96:99], v[40:43], v[128:131], v[96:99]
    ds_read_b64_tr_b16 v[128:129], v14 offset:20480
    ds_read_b64_tr_b16 v[130:131], v14 offset:20992
    s_waitcnt lgkmcnt(10)
    v_mfma_f32_16x16x32_bf16 v[100:103], v[40:43], v[132:135], v[100:103]
    ds_read_b64_tr_b16 v[132:133], v15 offset:20480
    ds_read_b64_tr_b16 v[134:135], v15 offset:20992
    s_waitcnt lgkmcnt(10)
    v_mfma_f32_16x16x32_bf16 v[104:107], v[40:43], v[112:115], v[104:107]
    ds_read_b64_tr_b16 v[112:113], v12 offset:24576
    ds_read_b64_tr_b16 v[114:115], v12 offset:25088
    s_waitcnt lgkmcnt(10)
    v_mfma_f32_16x16x32_bf16 v[108:111], v[40:43], v[116:119], v[108:111]
    ds_read_b64_tr_b16 v[116:117], v13 offset:24576
    ds_read_b64_tr_b16 v[118:119], v13 offset:25088
    s_waitcnt lgkmcnt(10)
    v_mfma_f32_16x16x32_bf16 v[96:99], v[44:47], v[120:123], v[96:99]
    ds_read_b64_tr_b16 v[120:121], v14 offset:24576
    ds_read_b64_tr_b16 v[122:123], v14 offset:25088
    s_waitcnt lgkmcnt(10)
    v_mfma_f32_16x16x32_bf16 v[100:103], v[44:47], v[124:127], v[100:103]
    ds_read_b64_tr_b16 v[124:125], v15 offset:24576
    ds_read_b64_tr_b16 v[126:127], v15 offset:25088
    s_waitcnt lgkmcnt(10)
    v_mfma_f32_16x16x32_bf16 v[104:107], v[44:47], v[128:131], v[104:107]
    ds_read_b64_tr_b16 v[128:129], v12 offset:28672
    ds_read_b64_tr_b16 v[130:131], v12 offset:29184
    s_waitcnt lgkmcnt(10)
    v_mfma_f32_16x16x32_bf16 v[108:111], v[44:47], v[132:135], v[108:111]
    ds_read_b64_tr_b16 v[132:133], v13 offset:28672
    ds_read_b64_tr_b16 v[134:135], v13 offset:29184
    s_waitcnt lgkmcnt(10)
    v_mfma_f32_16x16x32_bf16 v[96:99], v[48:51], v[112:115], v[96:99]
    ds_read_b64_tr_b16 v[112:113], v14 offset:28672
    ds_read_b64_tr_b16 v[114:115], v14 offset:29184
    s_waitcnt lgkmcnt(10)
    v_mfma_f32_16x16x32_bf16 v[100:103], v[48:51], v[116:119], v[100:103]
    ds_read_b64_tr_b16 v[116:117], v15 offset:28672
    ds_read_b64_tr_b16 v[118:119], v15 offset:29184
    s_waitcnt lgkmcnt(10)
    v_mfma_f32_16x16x32_bf16 v[104:107], v[48:51], v[120:123], v[104:107]
    ds_read_b64_tr_b16 v[120:121], v12 offset:32768
    ds_read_b64_tr_b16 v[122:123], v12 offset:33280
    s_waitcnt lgkmcnt(10)
    v_mfma_f32_16x16x32_bf16 v[108:111], v[48:51], v[124:127], v[108:111]
    ds_read_b64_tr_b16 v[124:125], v13 offset:32768
    ds_read_b64_tr_b16 v[126:127], v13 offset:33280
    s_waitcnt lgkmcnt(10)
    v_mfma_f32_16x16x32_bf16 v[96:99], v[52:55], v[128:131], v[96:99]
    ds_read_b64_tr_b16 v[128:129], v14 offset:32768
    ds_read_b64_tr_b16 v[130:131], v14 offset:33280
    s_waitcnt lgkmcnt(10)
    v_mfma_f32_16x16x32_bf16 v[100:103], v[52:55], v[132:135], v[100:103]
    ds_read_b64_tr_b16 v[132:133], v15 offset:32768
    ds_read_b64_tr_b16 v[134:135], v15 offset:33280
    s_waitcnt lgkmcnt(10)
    v_mfma_f32_16x16x32_bf16 v[104:107], v[52:55], v[112:115], v[104:107]
    s_waitcnt lgkmcnt(8)
    v_mfma_f32_16x16x32_bf16 v[108:111], v[52:55], v[116:119], v[108:111]
    s_waitcnt lgkmcnt(6)
    v_mfma_f32_16x16x32_bf16 v[96:99], v[56:59], v[120:123], v[96:99]
    s_waitcnt lgkmcnt(4)
    v_mfma_f32_16x16x32_bf16 v[100:103], v[56:59], v[124:127], v[100:103]
    s_waitcnt lgkmcnt(2)
    v_mfma_f32_16x16x32_bf16 v[104:107], v[56:59], v[128:131], v[104:107]
    s_waitcnt lgkmcnt(0)
    v_mfma_f32_16x16x32_bf16 v[108:111], v[56:59], v[132:135], v[108:111]
    s_nop 1
    v_fmac_f32 v80, s21, v96
    v_fmac_f32 v81, s21, v97
    v_fmac_f32 v82, s21, v98
    v_fmac_f32 v83, s21, v99
    v_fmac_f32 v84, s21, v100
    v_fmac_f32 v85, s21, v101
    v_fmac_f32 v86, s21, v102
    v_fmac_f32 v87, s21, v103
    v_fmac_f32 v88, s21, v104
    v_fmac_f32 v89, s21, v105
    v_fmac_f32 v90, s21, v106
    v_fmac_f32 v91, s21, v107
    v_fmac_f32 v92, s21, v108
    v_fmac_f32 v93, s21, v109
    v_fmac_f32 v94, s21, v110
    v_fmac_f32 v95, s21, v111
    v_cvt_pk_bf16_f32 v8, v80, v81
    v_cvt_pk_bf16_f32 v9, v82, v83
    v_cvt_pk_bf16_f32 v10, v84, v85
    v_cvt_pk_bf16_f32 v11, v86, v87
    s_nop 0
    v_permlane16_swap_b32 v8, v10
    v_permlane16_swap_b32 v9, v11
    v_cvt_pk_bf16_f32 v12, v88, v89
    v_cvt_pk_bf16_f32 v13, v90, v91
    v_cvt_pk_bf16_f32 v14, v92, v93
    v_cvt_pk_bf16_f32 v15, v94, v95
    s_nop 0
    v_permlane16_swap_b32 v12, v14
    v_permlane16_swap_b32 v13, v15
    buffer_store_dwordx4 v[8:11], v5, s[12:15], s19 offen sc1
    buffer_store_dwordx4 v[12:15], v5, s[12:15], s20 offen sc1
    s_branch P2_done
Lidle_32:
    s_waitcnt vmcnt(0)
    s_barrier
P2_done:
    s_waitcnt vmcnt(0)
    s_barrier
    s_cmp_lg_u32 s3, 0
    s_cbranch_scc1 Lp_33
    v_mov_b32 v8, 1
    v_mul_u32_u24 v9, 32768, v0
    s_mov_b64 exec, 0xff
    buffer_store_dword v8, v9, s[12:15], s35 offen sc1
    s_mov_b64 exec, -1
Lp_33:
PA_entry:
    s_and_b32 s16, s2, 7
    s_lshl_b32 s16, s16, 2
    s_bfe_u32 s17, s2, 0x20003
    s_add_u32 s16, s16, s17
    s_lshr_b32 s17, s2, 5
    s_mul_i32 s18, s16, 73728
    v_lshlrev_b32 v3, 4, v0
    v_add_u32 v4, 36864, v3
    v_lshrrev_b32 v7, 5, v0
    v_lshlrev_b32 v7, 14, v7
    v_and_b32 v166, 31, v0
    v_lshl_add_u32 v166, v166, 4, v7
    s_mul_i32 s20, s3, 196608
    s_lshl_b32 s21, s16, 9
    s_add_u32 s20, s20, s21
    s_add_u32 s20, s20, 0x6c0000
    s_mul_i32 s21, s3, 6144
    v_lshrrev_b32 v7, 4, v0
    v_lshlrev_b32 v164, 10, v7
    v_and_b32 v7, 15, v0
    v_lshl_add_u32 v164, v7, 4, v164
    v_add_u32 v165, 36864, v164
    s_cmp_ge_u32 s3, 6
    s_cselect_b32 s36, 1, 0
    s_mul_i32 s37, s36, 6
    s_sub_u32 s37, s3, s37
    s_mul_i32 s38, s17, 3
    s_add_u32 s38, s38, s37
    s_cmp_ge_u32 s37, 3
    s_cselect_b32 s39, 15, 0
    s_add_u32 s38, s38, s39
    s_mul_i32 s39, s38, 18432
    s_mul_i32 s40, s36, 9216
    s_add_u32 s39, s39, s40
    s_add_u32 s39, s39, 0x1062000
    s_and_b32 s19, s3, 10
    s_cmp_eq_u32 s19, 0
    s_cbranch_scc1 K3_ks
    s_cmp_lt_u32 s3, 4
    s_cbranch_scc1 K3_B
    s_cmp_lt_u32 s3, 8
    s_cbranch_scc1 K3_stat
    s_cmp_eq_u32 s3, 9
    s_cbranch_scc1 K3_stat
    s_sub_u32 s19, s3, 9
    s_max_i32 s19, s19, 0
    s_mul_i32 s22, s17, 3
    s_add_u32 s22, s22, s19
    s_lshl_b32 s25, s22, 4
    v_and_b32 v6, 15, v0
    v_add_u32 v6, s25, v6
    v_cvt_f32_u32 v144, v6
    v_mul_f32 v144, 0x3ae38e39, v144
    v_lshrrev_b32 v6, 4, v0
    v_cmp_eq_u32 vcc, 3, v6
    v_lshlrev_b32 v6, 3, v6
    v_add_u32 v6, 1, v6
    v_cvt_f32_u32 v6, v6
    v_mov_b32 v152, 1.0
    v_mov_b32 v153, 0x3f3504f3
    v_cndmask_b32 v152, v152, v153, vcc
    v_mul_f32 v146, v144, v6
    v_add_f32 v148, v146, v144
    v_mov_b32 v150, 0x3d715bef
    v_add_f32 v149, 0x3e800000, v148
    s_mov_b32 s26, 0x00000000
    s_mov_b32 s27, 0x00000000
    v_pk_fma_f32 v[128:129], v[144:145], s[26:27], v[148:149] op_sel_hi:[0,1,1]
    s_mov_b32 s26, 0x40000000
    s_mov_b32 s27, 0x40000000
    v_pk_fma_f32 v[130:131], v[144:145], s[26:27], v[148:149] op_sel_hi:[0,1,1]
    s_mov_b32 s26, 0x40800000
    s_mov_b32 s27, 0x40800000
    v_pk_fma_f32 v[132:133], v[144:145], s[26:27], v[148:149] op_sel_hi:[0,1,1]
    s_mov_b32 s26, 0x40c00000
    s_mov_b32 s27, 0x40c00000
    v_pk_fma_f32 v[134:135], v[144:145], s[26:27], v[148:149] op_sel_hi:[0,1,1]
    v_mul_f32 v154, 0x42000000, v144
    v_pk_add_f32 v[136:137], v[128:129], v[154:155] op_sel_hi:[1,0]
    v_pk_add_f32 v[138:139], v[130:131], v[154:155] op_sel_hi:[1,0]
    v_pk_add_f32 v[140:141], v[132:133], v[154:155] op_sel_hi:[1,0]
    v_pk_add_f32 v[142:143], v[134:135], v[154:155] op_sel_hi:[1,0]
    v_cos_f32 v154, v154
    v_cos_f32 v128, v128
    v_cos_f32 v129, v129
    v_cos_f32 v130, v130
    v_cos_f32 v131, v131
    v_cos_f32 v132, v132
    v_cos_f32 v133, v133
    v_cos_f32 v134, v134
    v_cos_f32 v135, v135
    v_cos_f32 v136, v136
    v_cos_f32 v137, v137
    v_cos_f32 v138, v138
    v_cos_f32 v139, v139
    v_cos_f32 v140, v140
    v_cos_f32 v141, v141
    v_cos_f32 v142, v142
    v_cos_f32 v143, v143
    v_add_f32 v154, v154, v154
    v_pk_mul_f32 v[128:129], v[128:129], v[150:151] op_sel_hi:[1,0]
    v_pk_mul_f32 v[130:131], v[130:131], v[150:151] op_sel_hi:[1,0]
    v_pk_mul_f32 v[132:133], v[132:133], v[150:151] op_sel_hi:[1,0]
    v_pk_mul_f32 v[134:135], v[134:135], v[150:151] op_sel_hi:[1,0]
    v_pk_mul_f32 v[136:137], v[136:137], v[150:151] op_sel_hi:[1,0]
    v_pk_mul_f32 v[138:139], v[138:139], v[150:151] op_sel_hi:[1,0]
    v_pk_mul_f32 v[140:141], v[140:141], v[150:151] op_sel_hi:[1,0]
    v_pk_mul_f32 v[142:143], v[142:143], v[150:151] op_sel_hi:[1,0]
    v_cvt_pk_bf16_f32 v24, v128, v129
    v_cvt_pk_bf16_f32 v25, v130, v131
    v_cvt_pk_bf16_f32 v26, v132, v133
    v_cvt_pk_bf16_f32 v27, v134, v135
    v_cvt_pk_bf16_f32 v28, v136, v137
    v_cvt_pk_bf16_f32 v29, v138, v139
    v_cvt_pk_bf16_f32 v30, v140, v141
    v_cvt_pk_bf16_f32 v31, v142, v143
    v_pk_fma_f32 v[128:129], v[136:137], v[154:155], v[128:129] op_sel_hi:[1,0,1] neg_lo:[0,0,1] neg_hi:[0,0,1]
    v_pk_fma_f32 v[130:131], v[138:139], v[154:155], v[130:131] op_sel_hi:[1,0,1] neg_lo:[0,0,1] neg_hi:[0,0,1]
    v_pk_fma_f32 v[132:133], v[140:141], v[154:155], v[132:133] op_sel_hi:[1,0,1] neg_lo:[0,0,1] neg_hi:[0,0,1]
    v_pk_fma_f32 v[134:135], v[142:143], v[154:155], v[134:135] op_sel_hi:[1,0,1] neg_lo:[0,0,1] neg_hi:[0,0,1]
    v_cvt_pk_bf16_f32 v32, v128, v129
    v_cvt_pk_bf16_f32 v33, v130, v131
    v_cvt_pk_bf16_f32 v34, v132, v133
    v_cvt_pk_bf16_f32 v35, v134, v135
    v_pk_fma_f32 v[136:137], v[128:129], v[154:155], v[136:137] op_sel_hi:[1,0,1] neg_lo:[0,0,1] neg_hi:[0,0,1]
    v_pk_fma_f32 v[138:139], v[130:131], v[154:155], v[138:139] op_sel_hi:[1,0,1] neg_lo:[0,0,1] neg_hi:[0,0,1]
    v_pk_fma_f32 v[140:141], v[132:133], v[154:155], v[140:141] op_sel_hi:[1,0,1] neg_lo:[0,0,1] neg_hi:[0,0,1]
    v_pk_fma_f32 v[142:143], v[134:135], v[154:155], v[142:143] op_sel_hi:[1,0,1] neg_lo:[0,0,1] neg_hi:[0,0,1]
    v_cvt_pk_bf16_f32 v36, v136, v137
    v_cvt_pk_bf16_f32 v37, v138, v139
    v_cvt_pk_bf16_f32 v38, v140, v141
    v_cvt_pk_bf16_f32 v39, v142, v143
    v_pk_fma_f32 v[128:129], v[136:137], v[154:155], v[128:129] op_sel_hi:[1,0,1] neg_lo:[0,0,1] neg_hi:[0,0,1]
    v_pk_fma_f32 v[130:131], v[138:139], v[154:155], v[130:131] op_sel_hi:[1,0,1] neg_lo:[0,0,1] neg_hi:[0,0,1]
    v_pk_fma_f32 v[132:133], v[140:141], v[154:155], v[132:133] op_sel_hi:[1,0,1] neg_lo:[0,0,1] neg_hi:[0,0,1]
    v_pk_fma_f32 v[134:135], v[142:143], v[154:155], v[134:135] op_sel_hi:[1,0,1] neg_lo:[0,0,1] neg_hi:[0,0,1]
    v_cvt_pk_bf16_f32 v40, v128, v129
    v_cvt_pk_bf16_f32 v41, v130, v131
    v_cvt_pk_bf16_f32 v42, v132, v133
    v_cvt_pk_bf16_f32 v43, v134, v135
    v_pk_fma_f32 v[136:137], v[128:129], v[154:155], v[136:137] op_sel_hi:[1,0,1] neg_lo:[0,0,1] neg_hi:[0,0,1]
    v_pk_fma_f32 v[138:139], v[130:131], v[154:155], v[138:139] op_sel_hi:[1,0,1] neg_lo:[0,0,1] neg_hi:[0,0,1]
    v_pk_fma_f32 v[140:141], v[132:133], v[154:155], v[140:141] op_sel_hi:[1,0,1] neg_lo:[0,0,1] neg_hi:[0,0,1]
    v_pk_fma_f32 v[142:143], v[134:135], v[154:155], v[142:143] op_sel_hi:[1,0,1] neg_lo:[0,0,1] neg_hi:[0,0,1]
    v_cvt_pk_bf16_f32 v44, v136, v137
    v_cvt_pk_bf16_f32 v45, v138, v139
    v_cvt_pk_bf16_f32 v46, v140, v141
    v_cvt_pk_bf16_f32 v47, v142, v143
    v_pk_fma_f32 v[128:129], v[136:137], v[154:155], v[128:129] op_sel_hi:[1,0,1] neg_lo:[0,0,1] neg_hi:[0,0,1]
    v_pk_fma_f32 v[130:131], v[138:139], v[154:155], v[130:131] op_sel_hi:[1,0,1] neg_lo:[0,0,1] neg_hi:[0,0,1]
    v_pk_fma_f32 v[132:133], v[140:141], v[154:155], v[132:133] op_sel_hi:[1,0,1] neg_lo:[0,0,1] neg_hi:[0,0,1]
    v_pk_fma_f32 v[134:135], v[142:143], v[154:155], v[134:135] op_sel_hi:[1,0,1] neg_lo:[0,0,1] neg_hi:[0,0,1]
    v_cvt_pk_bf16_f32 v48, v128, v129
    v_cvt_pk_bf16_f32 v49, v130, v131
    v_cvt_pk_bf16_f32 v50, v132, v133
    v_cvt_pk_bf16_f32 v51, v134, v135
    v_pk_fma_f32 v[136:137], v[128:129], v[154:155], v[136:137] op_sel_hi:[1,0,1] neg_lo:[0,0,1] neg_hi:[0,0,1]
    v_pk_fma_f32 v[138:139], v[130:131], v[154:155], v[138:139] op_sel_hi:[1,0,1] neg_lo:[0,0,1] neg_hi:[0,0,1]
    v_pk_fma_f32 v[140:141], v[132:133], v[154:155], v[140:141] op_sel_hi:[1,0,1] neg_lo:[0,0,1] neg_hi:[0,0,1]
    v_pk_fma_f32 v[142:143], v[134:135], v[154:155], v[142:143] op_sel_hi:[1,0,1] neg_lo:[0,0,1] neg_hi:[0,0,1]
    v_cvt_pk_bf16_f32 v52, v136, v137
    v_cvt_pk_bf16_f32 v53, v138, v139
    v_cvt_pk_bf16_f32 v54, v140, v141
    v_cvt_pk_bf16_f32 v55, v142, v143
    v_pk_fma_f32 v[128:129], v[136:137], v[154:155], v[128:129] op_sel_hi:[1,0,1] neg_lo:[0,0,1] neg_hi:[0,0,1]
    v_pk_fma_f32 v[130:131], v[138:139], v[154:155], v[130:131] op_sel_hi:[1,0,1] neg_lo:[0,0,1] neg_hi:[0,0,1]
    v_pk_fma_f32 v[132:133], v[140:141], v[154:155], v[132:133] op_sel_hi:[1,0,1] neg_lo:[0,0,1] neg_hi:[0,0,1]
    v_pk_fma_f32 v[134:135], v[142:143], v[154:155], v[134:135] op_sel_hi:[1,0,1] neg_lo:[0,0,1] neg_hi:[0,0,1]
    v_pk_mul_f32 v[156:157], v[134:135], v[152:153] op_sel_hi:[1,0]
    v_cvt_pk_bf16_f32 v56, v128, v129
    v_cvt_pk_bf16_f32 v57, v130, v131
    v_cvt_pk_bf16_f32 v58, v132, v133
    v_cvt_pk_bf16_f32 v59, v156, v157
    v_add_f32 v147, 0x3e800000, v146
    s_mov_b32 s26, 0x00000000
    s_mov_b32 s27, 0x00000000
    v_pk_fma_f32 v[128:129], v[144:145], s[26:27], v[146:147] op_sel_hi:[0,1,1]
    s_mov_b32 s26, 0x40000000
    s_mov_b32 s27, 0x40000000
    v_pk_fma_f32 v[130:131], v[144:145], s[26:27], v[146:147] op_sel_hi:[0,1,1]
    s_mov_b32 s26, 0x40800000
    s_mov_b32 s27, 0x40800000
    v_pk_fma_f32 v[132:133], v[144:145], s[26:27], v[146:147] op_sel_hi:[0,1,1]
    s_mov_b32 s26, 0x40c00000
    s_mov_b32 s27, 0x40c00000
    v_pk_fma_f32 v[134:135], v[144:145], s[26:27], v[146:147] op_sel_hi:[0,1,1]
    v_mul_f32 v154, 0x42000000, v144
    v_pk_add_f32 v[136:137], v[128:129], v[154:155] op_sel_hi:[1,0]
    v_pk_add_f32 v[138:139], v[130:131], v[154:155] op_sel_hi:[1,0]
    v_pk_add_f32 v[140:141], v[132:133], v[154:155] op_sel_hi:[1,0]
    v_pk_add_f32 v[142:143], v[134:135], v[154:155] op_sel_hi:[1,0]
    v_cos_f32 v154, v154
    v_cos_f32 v128, v128
    v_cos_f32 v129, v129
    v_cos_f32 v130, v130
    v_cos_f32 v131, v131
    v_cos_f32 v132, v132
    v_cos_f32 v133, v133
    v_cos_f32 v134, v134
    v_cos_f32 v135, v135
    v_cos_f32 v136, v136
    v_cos_f32 v137, v137
    v_cos_f32 v138, v138
    v_cos_f32 v139, v139
    v_cos_f32 v140, v140
    v_cos_f32 v141, v141
    v_cos_f32 v142, v142
    v_cos_f32 v143, v143
    v_add_f32 v154, v154, v154
    v_pk_mul_f32 v[128:129], v[128:129], v[150:151] op_sel_hi:[1,0]
    v_pk_mul_f32 v[130:131], v[130:131], v[150:151] op_sel_hi:[1,0]
    v_pk_mul_f32 v[132:133], v[132:133], v[150:151] op_sel_hi:[1,0]
    v_pk_mul_f32 v[134:135], v[134:135], v[150:151] op_sel_hi:[1,0]
    v_pk_mul_f32 v[136:137], v[136:137], v[150:151] op_sel_hi:[1,0]
    v_pk_mul_f32 v[138:139], v[138:139], v[150:151] op_sel_hi:[1,0]
    v_pk_mul_f32 v[140:141], v[140:141], v[150:151] op_sel_hi:[1,0]
    v_pk_mul_f32 v[142:143], v[142:143], v[150:151] op_sel_hi:[1,0]
    v_cvt_pk_bf16_f32 v60, v128, v129
    v_cvt_pk_bf16_f32 v61, v130, v131
    v_cvt_pk_bf16_f32 v62, v132, v133
    v_cvt_pk_bf16_f32 v63, v134, v135
    v_cvt_pk_bf16_f32 v64, v136, v137
    v_cvt_pk_bf16_f32 v65, v138, v139
    v_cvt_pk_bf16_f32 v66, v140, v141
    v_cvt_pk_bf16_f32 v67, v142, v143
    v_pk_fma_f32 v[128:129], v[136:137], v[154:155], v[128:129] op_sel_hi:[1,0,1] neg_lo:[0,0,1] neg_hi:[0,0,1]
    v_pk_fma_f32 v[130:131], v[138:139], v[154:155], v[130:131] op_sel_hi:[1,0,1] neg_lo:[0,0,1] neg_hi:[0,0,1]
    v_pk_fma_f32 v[132:133], v[140:141], v[154:155], v[132:133] op_sel_hi:[1,0,1] neg_lo:[0,0,1] neg_hi:[0,0,1]
    v_pk_fma_f32 v[134:135], v[142:143], v[154:155], v[134:135] op_sel_hi:[1,0,1] neg_lo:[0,0,1] neg_hi:[0,0,1]
    v_cvt_pk_bf16_f32 v68, v128, v129
    v_cvt_pk_bf16_f32 v69, v130, v131
    v_cvt_pk_bf16_f32 v70, v132, v133
    v_cvt_pk_bf16_f32 v71, v134, v135
    v_pk_fma_f32 v[136:137], v[128:129], v[154:155], v[136:137] op_sel_hi:[1,0,1] neg_lo:[0,0,1] neg_hi:[0,0,1]
    v_pk_fma_f32 v[138:139], v[130:131], v[154:155], v[138:139] op_sel_hi:[1,0,1] neg_lo:[0,0,1] neg_hi:[0,0,1]
    v_pk_fma_f32 v[140:141], v[132:133], v[154:155], v[140:141] op_sel_hi:[1,0,1] neg_lo:[0,0,1] neg_hi:[0,0,1]
    v_pk_fma_f32 v[142:143], v[134:135], v[154:155], v[142:143] op_sel_hi:[1,0,1] neg_lo:[0,0,1] neg_hi:[0,0,1]
    v_cvt_pk_bf16_f32 v72, v136, v137
    v_cvt_pk_bf16_f32 v73, v138, v139
    v_cvt_pk_bf16_f32 v74, v140, v141
    v_cvt_pk_bf16_f32 v75, v142, v143
    v_pk_fma_f32 v[128:129], v[136:137], v[154:155], v[128:129] op_sel_hi:[1,0,1] neg_lo:[0,0,1] neg_hi:[0,0,1]
    v_pk_fma_f32 v[130:131], v[138:139], v[154:155], v[130:131] op_sel_hi:[1,0,1] neg_lo:[0,0,1] neg_hi:[0,0,1]
    v_pk_fma_f32 v[132:133], v[140:141], v[154:155], v[132:133] op_sel_hi:[1,0,1] neg_lo:[0,0,1] neg_hi:[0,0,1]
    v_pk_fma_f32 v[134:135], v[142:143], v[154:155], v[134:135] op_sel_hi:[1,0,1] neg_lo:[0,0,1] neg_hi:[0,0,1]
    v_cvt_pk_bf16_f32 v76, v128, v129
    v_cvt_pk_bf16_f32 v77, v130, v131
    v_cvt_pk_bf16_f32 v78, v132, v133
    v_cvt_pk_bf16_f32 v79, v134, v135
    v_pk_fma_f32 v[136:137], v[128:129], v[154:155], v[136:137] op_sel_hi:[1,0,1] neg_lo:[0,0,1] neg_hi:[0,0,1]
    v_pk_fma_f32 v[138:139], v[130:131], v[154:155], v[138:139] op_sel_hi:[1,0,1] neg_lo:[0,0,1] neg_hi:[0,0,1]
    v_pk_fma_f32 v[140:141], v[132:133], v[154:155], v[140:141] op_sel_hi:[1,0,1] neg_lo:[0,0,1] neg_hi:[0,0,1]
    v_pk_fma_f32 v[142:143], v[134:135], v[154:155], v[142:143] op_sel_hi:[1,0,1] neg_lo:[0,0,1] neg_hi:[0,0,1]
    v_cvt_pk_bf16_f32 v80, v136, v137
    v_cvt_pk_bf16_f32 v81, v138, v139
    v_cvt_pk_bf16_f32 v82, v140, v141
    v_cvt_pk_bf16_f32 v83, v142, v143
    v_pk_fma_f32 v[128:129], v[136:137], v[154:155], v[128:129] op_sel_hi:[1,0,1] neg_lo:[0,0,1] neg_hi:[0,0,1]
    v_pk_fma_f32 v[130:131], v[138:139], v[154:155], v[130:131] op_sel_hi:[1,0,1] neg_lo:[0,0,1] neg_hi:[0,0,1]
    v_pk_fma_f32 v[132:133], v[140:141], v[154:155], v[132:133] op_sel_hi:[1,0,1] neg_lo:[0,0,1] neg_hi:[0,0,1]
    v_pk_fma_f32 v[134:135], v[142:143], v[154:155], v[134:135] op_sel_hi:[1,0,1] neg_lo:[0,0,1] neg_hi:[0,0,1]
    v_cvt_pk_bf16_f32 v84, v128, v129
    v_cvt_pk_bf16_f32 v85, v130, v131
    v_cvt_pk_bf16_f32 v86, v132, v133
    v_cvt_pk_bf16_f32 v87, v134, v135
    v_pk_fma_f32 v[136:137], v[128:129], v[154:155], v[136:137] op_sel_hi:[1,0,1] neg_lo:[0,0,1] neg_hi:[0,0,1]
    v_pk_fma_f32 v[138:139], v[130:131], v[154:155], v[138:139] op_sel_hi:[1,0,1] neg_lo:[0,0,1] neg_hi:[0,0,1]
    v_pk_fma_f32 v[140:141], v[132:133], v[154:155], v[140:141] op_sel_hi:[1,0,1] neg_lo:[0,0,1] neg_hi:[0,0,1]
    v_pk_fma_f32 v[142:143], v[134:135], v[154:155], v[142:143] op_sel_hi:[1,0,1] neg_lo:[0,0,1] neg_hi:[0,0,1]
    v_cvt_pk_bf16_f32 v88, v136, v137
    v_cvt_pk_bf16_f32 v89, v138, v139
    v_cvt_pk_bf16_f32 v90, v140, v141
    v_cvt_pk_bf16_f32 v91, v142, v143
    v_pk_fma_f32 v[128:129], v[136:137], v[154:155], v[128:129] op_sel_hi:[1,0,1] neg_lo:[0,0,1] neg_hi:[0,0,1]
    v_pk_fma_f32 v[130:131], v[138:139], v[154:155], v[130:131] op_sel_hi:[1,0,1] neg_lo:[0,0,1] neg_hi:[0,0,1]
    v_pk_fma_f32 v[132:133], v[140:141], v[154:155], v[132:133] op_sel_hi:[1,0,1] neg_lo:[0,0,1] neg_hi:[0,0,1]
    v_pk_fma_f32 v[134:135], v[142:143], v[154:155], v[134:135] op_sel_hi:[1,0,1] neg_lo:[0,0,1] neg_hi:[0,0,1]
    v_cvt_pk_bf16_f32 v92, v128, v129
    v_cvt_pk_bf16_f32 v93, v130, v131
    v_cvt_pk_bf16_f32 v94, v132, v133
    v_cvt_pk_bf16_f32 v95, v134, v135
    v_lshrrev_b32 v5, 5, v0
    v_lshlrev_b32 v5, 9, v5
    v_and_b32 v6, 15, v0
    v_lshl_add_u32 v5, v6, 5, v5
    v_bfe_u32 v6, v0, 4, 1
    v_lshl_add_u32 v5, v6, 4, v5
    s_lshl_b32 s23, s19, 11
    s_add_u32 s23, s23, 75264
    v_add_u32 v5, s23, v5
    s_barrier
    s_add_u32 m0, s21, 0
    s_nop 0
    buffer_load_dwordx4 v166, s[12:15], s20 offen sc1 lds
    s_add_u32 s20, s20, 32768
    s_add_u32 m0, s21, 1024
    s_nop 0
    buffer_load_dwordx4 v166, s[12:15], s20 offen sc1 lds
    s_add_u32 s20, s20, 32768
    s_add_u32 m0, s21, 2048
    s_nop 0
    buffer_load_dwordx4 v166, s[12:15], s20 offen sc1 lds
    s_add_u32 s20, s20, 32768
    s_add_u32 m0, s21, 3072
    s_nop 0
    buffer_load_dwordx4 v166, s[12:15], s20 offen sc1 lds
    s_add_u32 s20, s20, 32768
    s_add_u32 m0, s21, 4096
    s_nop 0
    buffer_load_dwordx4 v166, s[12:15], s20 offen sc1 lds
    s_add_u32 s20, s20, 32768
    s_add_u32 m0, s21, 5120
    s_nop 0
    buffer_load_dwordx4 v166, s[12:15], s20 offen sc1 lds
    s_barrier
    s_waitcnt vmcnt(0)
    s_barrier
    ds_read_b128 v[128:131], v164 offset:0
    ds_read_b128 v[136:139], v164 offset:512
    ds_read_b128 v[140:143], v164 offset:256
    ds_read_b128 v[148:151], v164 offset:768
    ds_read_b128 v[152:155], v164 offset:4096
    ds_read_b128 v[160:163], v164 offset:4608
    s_waitcnt lgkmcnt(4)
    v_mov_b64 v[134:135], v[128:129]
    v_mov_b64 v[132:133], v[138:139]
    ds_read_b128 v[8:11], v164 offset:4352
    ds_read_b128 v[16:19], v164 offset:4864
    v_mfma_f32_16x16x32_bf16 v[96:99], v[24:27], v[134:137], 0
    v_mfma_f32_16x16x32_bf16 v[100:103], v[24:27], v[130:133], 0
    s_waitcnt lgkmcnt(4)
    v_mov_b64 v[146:147], v[140:141]
    v_mov_b64 v[144:145], v[150:151]
    ds_read_b128 v[128:131], v164 offset:8192
    ds_read_b128 v[136:139], v164 offset:8704
    v_mfma_f32_16x16x32_bf16 v[104:107], v[24:27], v[146:149], 0
    v_mfma_f32_16x16x32_bf16 v[108:111], v[24:27], v[142:145], 0
    s_waitcnt lgkmcnt(4)
    v_mov_b64 v[158:159], v[152:153]
    v_mov_b64 v[156:157], v[162:163]
    ds_read_b128 v[140:143], v164 offset:8448
    ds_read_b128 v[148:151], v164 offset:8960
    v_mfma_f32_16x16x32_bf16 v[96:99], v[28:31], v[158:161], v[96:99]
    v_mfma_f32_16x16x32_bf16 v[100:103], v[28:31], v[154:157], v[100:103]
    s_waitcnt lgkmcnt(4)
    v_mov_b64 v[14:15], v[8:9]
    v_mov_b64 v[12:13], v[18:19]
    ds_read_b128 v[152:155], v164 offset:12288
    ds_read_b128 v[160:163], v164 offset:12800
    v_mfma_f32_16x16x32_bf16 v[104:107], v[28:31], v[14:17], v[104:107]
    v_mfma_f32_16x16x32_bf16 v[108:111], v[28:31], v[10:13], v[108:111]
    s_waitcnt lgkmcnt(4)
    v_mov_b64 v[134:135], v[128:129]
    v_mov_b64 v[132:133], v[138:139]
    ds_read_b128 v[8:11], v164 offset:12544
    ds_read_b128 v[16:19], v164 offset:13056
    v_mfma_f32_16x16x32_bf16 v[96:99], v[32:35], v[134:137], v[96:99]
    v_mfma_f32_16x16x32_bf16 v[100:103], v[32:35], v[130:133], v[100:103]
    s_waitcnt lgkmcnt(4)
    v_mov_b64 v[146:147], v[140:141]
    v_mov_b64 v[144:145], v[150:151]
    ds_read_b128 v[128:131], v164 offset:16384
    ds_read_b128 v[136:139], v164 offset:16896
    v_mfma_f32_16x16x32_bf16 v[104:107], v[32:35], v[146:149], v[104:107]
    v_mfma_f32_16x16x32_bf16 v[108:111], v[32:35], v[142:145], v[108:111]
    s_waitcnt lgkmcnt(4)
    v_mov_b64 v[158:159], v[152:153]
    v_mov_b64 v[156:157], v[162:163]
    ds_read_b128 v[140:143], v164 offset:16640
    ds_read_b128 v[148:151], v164 offset:17152
    v_mfma_f32_16x16x32_bf16 v[96:99], v[36:39], v[158:161], v[96:99]
    v_mfma_f32_16x16x32_bf16 v[100:103], v[36:39], v[154:157], v[100:103]
    s_waitcnt lgkmcnt(4)
    v_mov_b64 v[14:15], v[8:9]
    v_mov_b64 v[12:13], v[18:19]
    ds_read_b128 v[152:155], v164 offset:20480
    ds_read_b128 v[160:163], v164 offset:20992
    v_mfma_f32_16x16x32_bf16 v[104:107], v[36:39], v[14:17], v[104:107]
    v_mfma_f32_16x16x32_bf16 v[108:111], v[36:39], v[10:13], v[108:111]
    s_waitcnt lgkmcnt(4)
    v_mov_b64 v[134:135], v[128:129]
    v_mov_b64 v[132:133], v[138:139]
    ds_read_b128 v[8:11], v164 offset:20736
    ds_read_b128 v[16:19], v164 offset:21248
    v_mfma_f32_16x16x32_bf16 v[96:99], v[40:43], v[134:137], v[96:99]
    v_mfma_f32_16x16x32_bf16 v[100:103], v[40:43], v[130:133], v[100:103]
    s_waitcnt lgkmcnt(4)
    v_mov_b64 v[146:147], v[140:141]
    v_mov_b64 v[144:145], v[150:151]
    ds_read_b128 v[128:131], v164 offset:24576
    ds_read_b128 v[136:139], v164 offset:25088
    v_mfma_f32_16x16x32_bf16 v[104:107], v[40:43], v[146:149], v[104:107]
    v_mfma_f32_16x16x32_bf16 v[108:111], v[40:43], v[142:145], v[108:111]
    s_waitcnt lgkmcnt(4)
    v_mov_b64 v[158:159], v[152:153]
    v_mov_b64 v[156:157], v[162:163]
    ds_read_b128 v[140:143], v164 offset:24832
    ds_read_b128 v[148:151], v164 offset:25344
    v_mfma_f32_16x16x32_bf16 v[96:99], v[44:47], v[158:161], v[96:99]
    v_mfma_f32_16x16x32_bf16 v[100:103], v[44:47], v[154:157], v[100:103]
    s_waitcnt lgkmcnt(4)
    v_mov_b64 v[14:15], v[8:9]
    v_mov_b64 v[12:13], v[18:19]
    ds_read_b128 v[152:155], v164 offset:28672
    ds_read_b128 v[160:163], v164 offset:29184
    v_mfma_f32_16x16x32_bf16 v[104:107], v[44:47], v[14:17], v[104:107]
    v_mfma_f32_16x16x32_bf16 v[108:111], v[44:47], v[10:13], v[108:111]
    s_waitcnt lgkmcnt(4)
    v_mov_b64 v[134:135], v[128:129]
    v_mov_b64 v[132:133], v[138:139]
    ds_read_b128 v[8:11], v164 offset:28928
    ds_read_b128 v[16:19], v164 offset:29440
    v_mfma_f32_16x16x32_bf16 v[96:99], v[48:51], v[134:137], v[96:99]
    v_mfma_f32_16x16x32_bf16 v[100:103], v[48:51], v[130:133], v[100:103]
    s_waitcnt lgkmcnt(4)
    v_mov_b64 v[146:147], v[140:141]
    v_mov_b64 v[144:145], v[150:151]
    ds_read_b128 v[128:131], v164 offset:32768
    ds_read_b128 v[136:139], v164 offset:33280
    v_mfma_f32_16x16x32_bf16 v[104:107], v[48:51], v[146:149], v[104:107]
    v_mfma_f32_16x16x32_bf16 v[108:111], v[48:51], v[142:145], v[108:111]
    s_waitcnt lgkmcnt(4)
    v_mov_b64 v[158:159], v[152:153]
    v_mov_b64 v[156:157], v[162:163]
    ds_read_b128 v[140:143], v164 offset:33024
    ds_read_b128 v[148:151], v164 offset:33536
    v_mfma_f32_16x16x32_bf16 v[96:99], v[52:55], v[158:161], v[96:99]
    v_mfma_f32_16x16x32_bf16 v[100:103], v[52:55], v[154:157], v[100:103]
    s_waitcnt lgkmcnt(4)
    v_mov_b64 v[14:15], v[8:9]
    v_mov_b64 v[12:13], v[18:19]
    ds_read_b128 v[152:155], v165 offset:0
    ds_read_b128 v[160:163], v165 offset:512
    v_mfma_f32_16x16x32_bf16 v[104:107], v[52:55], v[14:17], v[104:107]
    v_mfma_f32_16x16x32_bf16 v[108:111], v[52:55], v[10:13], v[108:111]
    s_waitcnt lgkmcnt(4)
    v_mov_b64 v[134:135], v[128:129]
    v_mov_b64 v[132:133], v[138:139]
    ds_read_b128 v[8:11], v165 offset:256
    ds_read_b128 v[16:19], v165 offset:768
    v_mfma_f32_16x16x32_bf16 v[96:99], v[56:59], v[134:137], v[96:99]
    v_mfma_f32_16x16x32_bf16 v[100:103], v[56:59], v[130:133], v[100:103]
    s_waitcnt lgkmcnt(4)
    v_mov_b64 v[146:147], v[140:141]
    v_mov_b64 v[144:145], v[150:151]
    ds_read_b128 v[128:131], v165 offset:4096
    ds_read_b128 v[136:139], v165 offset:4608
    v_mfma_f32_16x16x32_bf16 v[104:107], v[56:59], v[146:149], v[104:107]
    v_mfma_f32_16x16x32_bf16 v[108:111], v[56:59], v[142:145], v[108:111]
    s_waitcnt lgkmcnt(4)
    v_mov_b64 v[158:159], v[152:153]
    v_mov_b64 v[156:157], v[162:163]
    ds_read_b128 v[140:143], v165 offset:4352
    ds_read_b128 v[148:151], v165 offset:4864
    v_mfma_f32_16x16x32_bf16 v[112:115], v[60:63], v[158:161], 0
    v_mfma_f32_16x16x32_bf16 v[116:119], v[60:63], v[154:157], 0
    s_waitcnt lgkmcnt(4)
    v_mov_b64 v[14:15], v[8:9]
    v_mov_b64 v[12:13], v[18:19]
    ds_read_b128 v[152:155], v165 offset:8192
    ds_read_b128 v[160:163], v165 offset:8704
    v_mfma_f32_16x16x32_bf16 v[120:123], v[60:63], v[14:17], 0
    v_mfma_f32_16x16x32_bf16 v[124:127], v[60:63], v[10:13], 0
    s_waitcnt lgkmcnt(4)
    v_mov_b64 v[134:135], v[128:129]
    v_mov_b64 v[132:133], v[138:139]
    ds_read_b128 v[8:11], v165 offset:8448
    ds_read_b128 v[16:19], v165 offset:8960
    v_mfma_f32_16x16x32_bf16 v[112:115], v[64:67], v[134:137], v[112:115]
    v_mfma_f32_16x16x32_bf16 v[116:119], v[64:67], v[130:133], v[116:119]
    s_waitcnt lgkmcnt(4)
    v_mov_b64 v[146:147], v[140:141]
    v_mov_b64 v[144:145], v[150:151]
    ds_read_b128 v[128:131], v165 offset:12288
    ds_read_b128 v[136:139], v165 offset:12800
    v_mfma_f32_16x16x32_bf16 v[120:123], v[64:67], v[146:149], v[120:123]
    v_mfma_f32_16x16x32_bf16 v[124:127], v[64:67], v[142:145], v[124:127]
    s_waitcnt lgkmcnt(4)
    v_mov_b64 v[158:159], v[152:153]
    v_mov_b64 v[156:157], v[162:163]
    ds_read_b128 v[140:143], v165 offset:12544
    ds_read_b128 v[148:151], v165 offset:13056
    v_mfma_f32_16x16x32_bf16 v[112:115], v[68:71], v[158:161], v[112:115]
    v_mfma_f32_16x16x32_bf16 v[116:119], v[68:71], v[154:157], v[116:119]
    s_waitcnt lgkmcnt(4)
    v_mov_b64 v[14:15], v[8:9]
    v_mov_b64 v[12:13], v[18:19]
    ds_read_b128 v[152:155], v165 offset:16384
    ds_read_b128 v[160:163], v165 offset:16896
    v_mfma_f32_16x16x32_bf16 v[120:123], v[68:71], v[14:17], v[120:123]
    v_mfma_f32_16x16x32_bf16 v[124:127], v[68:71], v[10:13], v[124:127]
    s_waitcnt lgkmcnt(4)
    v_mov_b64 v[134:135], v[128:129]
    v_mov_b64 v[132:133], v[138:139]
    ds_read_b128 v[8:11], v165 offset:16640
    ds_read_b128 v[16:19], v165 offset:17152
    v_mfma_f32_16x16x32_bf16 v[112:115], v[72:75], v[134:137], v[112:115]
    v_mfma_f32_16x16x32_bf16 v[116:119], v[72:75], v[130:133], v[116:119]
    s_waitcnt lgkmcnt(4)
    v_mov_b64 v[146:147], v[140:141]
    v_mov_b64 v[144:145], v[150:151]
    ds_read_b128 v[128:131], v165 offset:20480
    ds_read_b128 v[136:139], v165 offset:20992
    v_mfma_f32_16x16x32_bf16 v[120:123], v[72:75], v[146:149], v[120:123]
    v_mfma_f32_16x16x32_bf16 v[124:127], v[72:75], v[142:145], v[124:127]
    s_waitcnt lgkmcnt(4)
    v_mov_b64 v[158:159], v[152:153]
    v_mov_b64 v[156:157], v[162:163]
    ds_read_b128 v[140:143], v165 offset:20736
    ds_read_b128 v[148:151], v165 offset:21248
    v_mfma_f32_16x16x32_bf16 v[112:115], v[76:79], v[158:161], v[112:115]
    v_mfma_f32_16x16x32_bf16 v[116:119], v[76:79], v[154:157], v[116:119]
    s_waitcnt lgkmcnt(4)
    v_mov_b64 v[14:15], v[8:9]
    v_mov_b64 v[12:13], v[18:19]
    ds_read_b128 v[152:155], v165 offset:24576
    ds_read_b128 v[160:163], v165 offset:25088
    v_mfma_f32_16x16x32_bf16 v[120:123], v[76:79], v[14:17], v[120:123]
    v_mfma_f32_16x16x32_bf16 v[124:127], v[76:79], v[10:13], v[124:127]
    s_waitcnt lgkmcnt(4)
    v_mov_b64 v[134:135], v[128:129]
    v_mov_b64 v[132:133], v[138:139]
    ds_read_b128 v[8:11], v165 offset:24832
    ds_read_b128 v[16:19], v165 offset:25344
    v_mfma_f32_16x16x32_bf16 v[112:115], v[80:83], v[134:137], v[112:115]
    v_mfma_f32_16x16x32_bf16 v[116:119], v[80:83], v[130:133], v[116:119]
    s_waitcnt lgkmcnt(4)
    v_mov_b64 v[146:147], v[140:141]
    v_mov_b64 v[144:145], v[150:151]
    ds_read_b128 v[128:131], v165 offset:28672
    ds_read_b128 v[136:139], v165 offset:29184
    v_mfma_f32_16x16x32_bf16 v[120:123], v[80:83], v[146:149], v[120:123]
    v_mfma_f32_16x16x32_bf16 v[124:127], v[80:83], v[142:145], v[124:127]
    s_waitcnt lgkmcnt(4)
    v_mov_b64 v[158:159], v[152:153]
    v_mov_b64 v[156:157], v[162:163]
    ds_read_b128 v[140:143], v165 offset:28928
    ds_read_b128 v[148:151], v165 offset:29440
    v_mfma_f32_16x16x32_bf16 v[112:115], v[84:87], v[158:161], v[112:115]
    v_mfma_f32_16x16x32_bf16 v[116:119], v[84:87], v[154:157], v[116:119]
    s_waitcnt lgkmcnt(4)
    v_mov_b64 v[14:15], v[8:9]
    v_mov_b64 v[12:13], v[18:19]
    ds_read_b128 v[152:155], v165 offset:32768
    ds_read_b128 v[160:163], v165 offset:33280
    v_mfma_f32_16x16x32_bf16 v[120:123], v[84:87], v[14:17], v[120:123]
    v_mfma_f32_16x16x32_bf16 v[124:127], v[84:87], v[10:13], v[124:127]
    s_waitcnt lgkmcnt(4)
    v_mov_b64 v[134:135], v[128:129]
    v_mov_b64 v[132:133], v[138:139]
    ds_read_b128 v[8:11], v165 offset:33024
    ds_read_b128 v[16:19], v165 offset:33536
    v_mfma_f32_16x16x32_bf16 v[112:115], v[88:91], v[134:137], v[112:115]
    v_mfma_f32_16x16x32_bf16 v[116:119], v[88:91], v[130:133], v[116:119]
    s_waitcnt lgkmcnt(4)
    v_mov_b64 v[146:147], v[140:141]
    v_mov_b64 v[144:145], v[150:151]
    s_nop 0
    v_mfma_f32_16x16x32_bf16 v[120:123], v[88:91], v[146:149], v[120:123]
    v_mfma_f32_16x16x32_bf16 v[124:127], v[88:91], v[142:145], v[124:127]
    s_waitcnt lgkmcnt(2)
    v_mov_b64 v[158:159], v[152:153]
    v_mov_b64 v[156:157], v[162:163]
    s_nop 0
    v_mfma_f32_16x16x32_bf16 v[112:115], v[92:95], v[158:161], v[112:115]
    v_mfma_f32_16x16x32_bf16 v[116:119], v[92:95], v[154:157], v[116:119]
    s_waitcnt lgkmcnt(0)
    v_mov_b64 v[14:15], v[8:9]
    v_mov_b64 v[12:13], v[18:19]
    s_nop 0
    v_mfma_f32_16x16x32_bf16 v[120:123], v[92:95], v[14:17], v[120:123]
    v_mfma_f32_16x16x32_bf16 v[124:127], v[92:95], v[10:13], v[124:127]
    s_nop 0
    v_sub_f32 v128, v96, v112
    v_sub_f32 v129, v97, v113
    v_sub_f32 v130, v98, v114
    v_sub_f32 v131, v99, v115
    v_sub_f32 v132, v100, v116
    v_sub_f32 v133, v101, v117
    v_sub_f32 v134, v102, v118
    v_sub_f32 v135, v103, v119
    v_sub_f32 v136, v104, v120
    v_sub_f32 v137, v105, v121
    v_sub_f32 v138, v106, v122
    v_sub_f32 v139, v107, v123
    v_sub_f32 v140, v108, v124
    v_sub_f32 v141, v109, v125
    v_sub_f32 v142, v110, v126
    v_sub_f32 v143, v111, v127
    v_add_f32 v96, v96, v112
    v_add_f32 v97, v97, v113
    v_add_f32 v98, v98, v114
    v_add_f32 v99, v99, v115
    v_add_f32 v100, v100, v116
    v_add_f32 v101, v101, v117
    v_add_f32 v102, v102, v118
    v_add_f32 v103, v103, v119
    v_add_f32 v104, v104, v120
    v_add_f32 v105, v105, v121
    v_add_f32 v106, v106, v122
    v_add_f32 v107, v107, v123
    v_add_f32 v108, v108, v124
    v_add_f32 v109, v109, v125
    v_add_f32 v110, v110, v126
    v_add_f32 v111, v111, v127
    v_cvt_pk_bf16_f32 v8, v96, v97
    v_cvt_pk_bf16_f32 v9, v98, v99
    v_cvt_pk_bf16_f32 v10, v100, v101
    v_cvt_pk_bf16_f32 v11, v102, v103
    s_nop 0
    v_permlane16_swap_b32 v8, v10
    v_permlane16_swap_b32 v9, v11
    ds_write_b128 v5, v[8:11] offset:0
    v_cvt_pk_bf16_f32 v12, v104, v105
    v_cvt_pk_bf16_f32 v13, v106, v107
    v_cvt_pk_bf16_f32 v14, v108, v109
    v_cvt_pk_bf16_f32 v15, v110, v111
    s_nop 0
    v_permlane16_swap_b32 v12, v14
    v_permlane16_swap_b32 v13, v15
    ds_write_b128 v5, v[12:15] offset:1024
    v_cvt_pk_bf16_f32 v16, v128, v129
    v_cvt_pk_bf16_f32 v17, v130, v131
    v_cvt_pk_bf16_f32 v18, v132, v133
    v_cvt_pk_bf16_f32 v19, v134, v135
    s_nop 0
    v_permlane16_swap_b32 v16, v18
    v_permlane16_swap_b32 v17, v19
    ds_write_b128 v5, v[16:19] offset:6144
    v_cvt_pk_bf16_f32 v20, v136, v137
    v_cvt_pk_bf16_f32 v21, v138, v139
    v_cvt_pk_bf16_f32 v22, v140, v141
    v_cvt_pk_bf16_f32 v23, v142, v143
    s_nop 0
    v_permlane16_swap_b32 v20, v22
    v_permlane16_swap_b32 v21, v23
    ds_write_b128 v5, v[20:23] offset:7168
    buffer_load_dwordx4 v[24:27], v3, s[12:15], s39 offen offset:0 sc1
    buffer_load_dwordx4 v[28:31], v3, s[12:15], s39 offen offset:1024 sc1
    buffer_load_dwordx4 v[32:35], v3, s[12:15], s39 offen offset:2048 sc1
    buffer_load_dwordx4 v[36:39], v3, s[12:15], s39 offen offset:3072 sc1
    s_add_u32 s39, s39, 4096
    buffer_load_dwordx4 v[40:43], v3, s[12:15], s39 offen offset:0 sc1
    buffer_load_dwordx4 v[44:47], v3, s[12:15], s39 offen offset:1024 sc1
    buffer_load_dwordx4 v[48:51], v3, s[12:15], s39 offen offset:2048 sc1
    buffer_load_dwordx4 v[52:55], v3, s[12:15], s39 offen offset:3072 sc1
    s_add_u32 s39, s39, 4096
    buffer_load_dwordx4 v[56:59], v3, s[12:15], s39 offen offset:0 sc1
    s_branch K3_join
K3_B:
    s_add_u32 s19, s3, 2
    s_mul_i32 s22, s17, 6
    s_add_u32 s22, s22, s19
    s_mul_i32 s23, s22, 18432
    s_add_u32 s23, s23, 0x1104000
    s_barrier
    s_add_u32 m0, s21, 0
    s_nop 0
    buffer_load_dwordx4 v166, s[12:15], s20 offen sc1 lds
    s_add_u32 s20, s20, 32768
    s_add_u32 m0, s21, 1024
    s_nop 0
    buffer_load_dwordx4 v166, s[12:15], s20 offen sc1 lds
    s_add_u32 s20, s20, 32768
    s_add_u32 m0, s21, 2048
    s_nop 0
    buffer_load_dwordx4 v166, s[12:15], s20 offen sc1 lds
    s_add_u32 s20, s20, 32768
    s_add_u32 m0, s21, 3072
    s_nop 0
    buffer_load_dwordx4 v166, s[12:15], s20 offen sc1 lds
    s_add_u32 s20, s20, 32768
    s_add_u32 m0, s21, 4096
    s_nop 0
    buffer_load_dwordx4 v166, s[12:15], s20 offen sc1 lds
    s_add_u32 s20, s20, 32768
    s_add_u32 m0, s21, 5120
    s_nop 0
    buffer_load_dwordx4 v166, s[12:15], s20 offen sc1 lds
    s_barrier
    buffer_load_dwordx4 v[24:27], v3, s[12:15], s23 offen offset:0 sc1
    buffer_load_dwordx4 v[28:31], v3, s[12:15], s23 offen offset:1024 sc1
    buffer_load_dwordx4 v[32:35], v3, s[12:15], s23 offen offset:2048 sc1
    buffer_load_dwordx4 v[36:39], v3, s[12:15], s23 offen offset:3072 sc1
    s_add_u32 s23, s23, 4096
    buffer_load_dwordx4 v[40:43], v3, s[12:15], s23 offen offset:0 sc1
    buffer_load_dwordx4 v[44:47], v3, s[12:15], s23 offen offset:1024 sc1
    buffer_load_dwordx4 v[48:51], v3, s[12:15], s23 offen offset:2048 sc1
    buffer_load_dwordx4 v[52:55], v3, s[12:15], s23 offen offset:3072 sc1
    s_add_u32 s23, s23, 4096
    buffer_load_dwordx4 v[56:59], v3, s[12:15], s23 offen offset:0 sc1
    buffer_load_dwordx4 v[60:63], v3, s[12:15], s23 offen offset:1024 sc1
    v_bfe_u32 v6, v0, 3, 1
    v_mul_u32_u24 v5, 18432, v6
    v_and_b32 v6, 7, v0
    v_lshl_add_u32 v5, v6, 5, v5
    v_bfe_u32 v6, v0, 4, 1
    v_lshl_add_u32 v5, v6, 4, v5
    v_lshrrev_b32 v6, 5, v0
    v_lshl_add_u32 v5, v6, 8, v5
    v_and_b32 v6, 15, v0
    v_lshlrev_b32 v6, 4, v6
    v_add_u32 v6, 73728, v6
    v_mov_b32 v7, 73984
    v_mov_b32 v9, 0xbdd2d3e8
    v_mov_b32 v10, 1
    v_mov_b32 v11, 0
    s_lshl_b32 s24, s22, 9
    s_add_u32 s24, s24, s18
    s_add_u32 s24, s24, 0xb40000
    s_add_u32 s26, s24, 36864
    s_lshl_b32 s28, s16, 7
    s_lshl_b32 s29, s17, 4
    s_add_u32 s28, s28, s29
    s_add_u32 s28, s28, 0x2dd6000
    s_waitcnt vmcnt(10)
    s_barrier
    ds_read_b128 v[128:131], v164 offset:0
    ds_read_b128 v[136:139], v164 offset:512
    ds_read_b128 v[140:143], v164 offset:256
    ds_read_b128 v[148:151], v164 offset:768
    ds_read_b128 v[152:155], v164 offset:4096
    ds_read_b128 v[160:163], v164 offset:4608
    ds_read_b128 v[112:115], v164 offset:4352
    ds_read_b128 v[120:123], v164 offset:4864
    buffer_load_dwordx4 v[64:67], v3, s[12:15], s23 offen offset:2048 sc1
    s_waitcnt vmcnt(10)
    s_waitcnt lgkmcnt(6)
    v_mov_b64 v[134:135], v[128:129]
    v_mov_b64 v[132:133], v[138:139]
    ds_read_b128 v[12:15], v164 offset:8192
    ds_read_b128 v[20:23], v164 offset:8704
    v_mfma_f32_16x16x32_bf16 v[96:99], v[24:27], v[134:137], 0
    v_mfma_f32_16x16x32_bf16 v[100:103], v[24:27], v[130:133], 0
    s_waitcnt lgkmcnt(6)
    v_mov_b64 v[146:147], v[140:141]
    v_mov_b64 v[144:145], v[150:151]
    ds_read_b128 v[128:131], v164 offset:8448
    ds_read_b128 v[136:139], v164 offset:8960
    v_mfma_f32_16x16x32_bf16 v[104:107], v[24:27], v[146:149], 0
    v_mfma_f32_16x16x32_bf16 v[108:111], v[24:27], v[142:145], 0
    buffer_load_dwordx4 v[68:71], v3, s[12:15], s23 offen offset:3072 sc1
    s_waitcnt vmcnt(10)
    s_waitcnt lgkmcnt(6)
    v_mov_b64 v[158:159], v[152:153]
    v_mov_b64 v[156:157], v[162:163]
    ds_read_b128 v[140:143], v164 offset:12288
    ds_read_b128 v[148:151], v164 offset:12800
    v_mfma_f32_16x16x32_bf16 v[96:99], v[28:31], v[158:161], v[96:99]
    v_mfma_f32_16x16x32_bf16 v[100:103], v[28:31], v[154:157], v[100:103]
    s_waitcnt lgkmcnt(6)
    v_mov_b64 v[118:119], v[112:113]
    v_mov_b64 v[116:117], v[122:123]
    ds_read_b128 v[152:155], v164 offset:12544
    ds_read_b128 v[160:163], v164 offset:13056
    v_mfma_f32_16x16x32_bf16 v[104:107], v[28:31], v[118:121], v[104:107]
    v_mfma_f32_16x16x32_bf16 v[108:111], v[28:31], v[114:117], v[108:111]
    s_add_u32 s23, s23, 4096
    buffer_load_dwordx4 v[72:75], v3, s[12:15], s23 offen offset:0 sc1
    s_waitcnt vmcnt(10)
    s_waitcnt lgkmcnt(6)
    v_mov_b64 v[18:19], v[12:13]
    v_mov_b64 v[16:17], v[22:23]
    ds_read_b128 v[112:115], v164 offset:16384
    ds_read_b128 v[120:123], v164 offset:16896
    v_mfma_f32_16x16x32_bf16 v[96:99], v[32:35], v[18:21], v[96:99]
    v_mfma_f32_16x16x32_bf16 v[100:103], v[32:35], v[14:17], v[100:103]
    s_waitcnt lgkmcnt(6)
    v_mov_b64 v[134:135], v[128:129]
    v_mov_b64 v[132:133], v[138:139]
    ds_read_b128 v[12:15], v164 offset:16640
    ds_read_b128 v[20:23], v164 offset:17152
    v_mfma_f32_16x16x32_bf16 v[104:107], v[32:35], v[134:137], v[104:107]
    v_mfma_f32_16x16x32_bf16 v[108:111], v[32:35], v[130:133], v[108:111]
    buffer_load_dwordx4 v[76:79], v3, s[12:15], s23 offen offset:1024 sc1
    s_waitcnt vmcnt(10)
    s_waitcnt lgkmcnt(6)
    v_mov_b64 v[146:147], v[140:141]
    v_mov_b64 v[144:145], v[150:151]
    ds_read_b128 v[128:131], v164 offset:20480
    ds_read_b128 v[136:139], v164 offset:20992
    v_mfma_f32_16x16x32_bf16 v[96:99], v[36:39], v[146:149], v[96:99]
    v_mfma_f32_16x16x32_bf16 v[100:103], v[36:39], v[142:145], v[100:103]
    s_waitcnt lgkmcnt(6)
    v_mov_b64 v[158:159], v[152:153]
    v_mov_b64 v[156:157], v[162:163]
    ds_read_b128 v[140:143], v164 offset:20736
    ds_read_b128 v[148:151], v164 offset:21248
    v_mfma_f32_16x16x32_bf16 v[104:107], v[36:39], v[158:161], v[104:107]
    v_mfma_f32_16x16x32_bf16 v[108:111], v[36:39], v[154:157], v[108:111]
    buffer_load_dwordx4 v[80:83], v3, s[12:15], s23 offen offset:2048 sc1
    s_waitcnt vmcnt(10)
    s_waitcnt lgkmcnt(6)
    v_mov_b64 v[118:119], v[112:113]
    v_mov_b64 v[116:117], v[122:123]
    ds_read_b128 v[152:155], v164 offset:24576
    ds_read_b128 v[160:163], v164 offset:25088
    v_mfma_f32_16x16x32_bf16 v[96:99], v[40:43], v[118:121], v[96:99]
    v_mfma_f32_16x16x32_bf16 v[100:103], v[40:43], v[114:117], v[100:103]
    s_waitcnt lgkmcnt(6)
    v_mov_b64 v[18:19], v[12:13]
    v_mov_b64 v[16:17], v[22:23]
    ds_read_b128 v[112:115], v164 offset:24832
    ds_read_b128 v[120:123], v164 offset:25344
    v_mfma_f32_16x16x32_bf16 v[104:107], v[40:43], v[18:21], v[104:107]
    v_mfma_f32_16x16x32_bf16 v[108:111], v[40:43], v[14:17], v[108:111]
    buffer_load_dwordx4 v[84:87], v3, s[12:15], s23 offen offset:3072 sc1
    s_waitcnt vmcnt(10)
    s_waitcnt lgkmcnt(6)
    v_mov_b64 v[134:135], v[128:129]
    v_mov_b64 v[132:133], v[138:139]
    ds_read_b128 v[12:15], v164 offset:28672
    ds_read_b128 v[20:23], v164 offset:29184
    v_mfma_f32_16x16x32_bf16 v[96:99], v[44:47], v[134:137], v[96:99]
    v_mfma_f32_16x16x32_bf16 v[100:103], v[44:47], v[130:133], v[100:103]
    s_waitcnt lgkmcnt(6)
    v_mov_b64 v[146:147], v[140:141]
    v_mov_b64 v[144:145], v[150:151]
    ds_read_b128 v[128:131], v164 offset:28928
    ds_read_b128 v[136:139], v164 offset:29440
    v_mfma_f32_16x16x32_bf16 v[104:107], v[44:47], v[146:149], v[104:107]
    v_mfma_f32_16x16x32_bf16 v[108:111], v[44:47], v[142:145], v[108:111]
    s_add_u32 s23, s23, 4096
    buffer_load_dwordx4 v[88:91], v3, s[12:15], s23 offen offset:0 sc1
    s_waitcnt vmcnt(10)
    s_waitcnt lgkmcnt(6)
    v_mov_b64 v[158:159], v[152:153]
    v_mov_b64 v[156:157], v[162:163]
    ds_read_b128 v[140:143], v164 offset:32768
    ds_read_b128 v[148:151], v164 offset:33280
    v_mfma_f32_16x16x32_bf16 v[96:99], v[48:51], v[158:161], v[96:99]
    v_mfma_f32_16x16x32_bf16 v[100:103], v[48:51], v[154:157], v[100:103]
    s_waitcnt lgkmcnt(6)
    v_mov_b64 v[118:119], v[112:113]
    v_mov_b64 v[116:117], v[122:123]
    ds_read_b128 v[152:155], v164 offset:33024
    ds_read_b128 v[160:163], v164 offset:33536
    v_mfma_f32_16x16x32_bf16 v[104:107], v[48:51], v[118:121], v[104:107]
    v_mfma_f32_16x16x32_bf16 v[108:111], v[48:51], v[114:117], v[108:111]
    buffer_load_dwordx4 v[92:95], v3, s[12:15], s23 offen offset:1024 sc1
    s_waitcnt vmcnt(10)
    s_waitcnt lgkmcnt(6)
    v_mov_b64 v[18:19], v[12:13]
    v_mov_b64 v[16:17], v[22:23]
    ds_read_b128 v[112:115], v165 offset:0
    ds_read_b128 v[120:123], v165 offset:512
    v_mfma_f32_16x16x32_bf16 v[96:99], v[52:55], v[18:21], v[96:99]
    v_mfma_f32_16x16x32_bf16 v[100:103], v[52:55], v[14:17], v[100:103]
    s_waitcnt lgkmcnt(6)
    v_mov_b64 v[134:135], v[128:129]
    v_mov_b64 v[132:133], v[138:139]
    ds_read_b128 v[12:15], v165 offset:256
    ds_read_b128 v[20:23], v165 offset:768
    v_mfma_f32_16x16x32_bf16 v[104:107], v[52:55], v[134:137], v[104:107]
    v_mfma_f32_16x16x32_bf16 v[108:111], v[52:55], v[130:133], v[108:111]
    s_waitcnt vmcnt(9)
    s_waitcnt lgkmcnt(6)
    v_mov_b64 v[146:147], v[140:141]
    v_mov_b64 v[144:145], v[150:151]
    ds_read_b128 v[128:131], v165 offset:4096
    ds_read_b128 v[136:139], v165 offset:4608
    v_mfma_f32_16x16x32_bf16 v[96:99], v[56:59], v[146:149], v[96:99]
    v_mfma_f32_16x16x32_bf16 v[100:103], v[56:59], v[142:145], v[100:103]
    s_waitcnt lgkmcnt(6)
    v_mov_b64 v[158:159], v[152:153]
    v_mov_b64 v[156:157], v[162:163]
    ds_read_b128 v[140:143], v165 offset:4352
    ds_read_b128 v[148:151], v165 offset:4864
    v_mfma_f32_16x16x32_bf16 v[104:107], v[56:59], v[158:161], v[104:107]
    v_mfma_f32_16x16x32_bf16 v[108:111], v[56:59], v[154:157], v[108:111]
    s_waitcnt vmcnt(8)
    s_waitcnt lgkmcnt(6)
    v_mov_b64 v[118:119], v[112:113]
    v_mov_b64 v[116:117], v[122:123]
    ds_read_b128 v[152:155], v165 offset:8192
    ds_read_b128 v[160:163], v165 offset:8704
    v_mfma_f32_16x16x32_bf16 v[96:99], v[60:63], v[118:121], v[96:99]
    v_mfma_f32_16x16x32_bf16 v[100:103], v[60:63], v[114:117], v[100:103]
    s_waitcnt lgkmcnt(6)
    v_mov_b64 v[18:19], v[12:13]
    v_mov_b64 v[16:17], v[22:23]
    ds_read_b128 v[112:115], v165 offset:8448
    ds_read_b128 v[120:123], v165 offset:8960
    v_mfma_f32_16x16x32_bf16 v[104:107], v[60:63], v[18:21], v[104:107]
    v_mfma_f32_16x16x32_bf16 v[108:111], v[60:63], v[14:17], v[108:111]
    s_waitcnt vmcnt(7)
    s_waitcnt lgkmcnt(6)
    v_mov_b64 v[134:135], v[128:129]
    v_mov_b64 v[132:133], v[138:139]
    ds_read_b128 v[12:15], v165 offset:12288
    ds_read_b128 v[20:23], v165 offset:12800
    v_mfma_f32_16x16x32_bf16 v[96:99], v[64:67], v[134:137], v[96:99]
    v_mfma_f32_16x16x32_bf16 v[100:103], v[64:67], v[130:133], v[100:103]
    s_waitcnt lgkmcnt(6)
    v_mov_b64 v[146:147], v[140:141]
    v_mov_b64 v[144:145], v[150:151]
    ds_read_b128 v[128:131], v165 offset:12544
    ds_read_b128 v[136:139], v165 offset:13056
    v_mfma_f32_16x16x32_bf16 v[104:107], v[64:67], v[146:149], v[104:107]
    v_mfma_f32_16x16x32_bf16 v[108:111], v[64:67], v[142:145], v[108:111]
    s_waitcnt vmcnt(6)
    s_waitcnt lgkmcnt(6)
    v_mov_b64 v[158:159], v[152:153]
    v_mov_b64 v[156:157], v[162:163]
    ds_read_b128 v[140:143], v165 offset:16384
    ds_read_b128 v[148:151], v165 offset:16896
    v_mfma_f32_16x16x32_bf16 v[96:99], v[68:71], v[158:161], v[96:99]
    v_mfma_f32_16x16x32_bf16 v[100:103], v[68:71], v[154:157], v[100:103]
    s_waitcnt lgkmcnt(6)
    v_mov_b64 v[118:119], v[112:113]
    v_mov_b64 v[116:117], v[122:123]
    ds_read_b128 v[152:155], v165 offset:16640
    ds_read_b128 v[160:163], v165 offset:17152
    v_mfma_f32_16x16x32_bf16 v[104:107], v[68:71], v[118:121], v[104:107]
    v_mfma_f32_16x16x32_bf16 v[108:111], v[68:71], v[114:117], v[108:111]
    s_waitcnt vmcnt(5)
    s_waitcnt lgkmcnt(6)
    v_mov_b64 v[18:19], v[12:13]
    v_mov_b64 v[16:17], v[22:23]
    ds_read_b128 v[112:115], v165 offset:20480
    ds_read_b128 v[120:123], v165 offset:20992
    v_mfma_f32_16x16x32_bf16 v[96:99], v[72:75], v[18:21], v[96:99]
    v_mfma_f32_16x16x32_bf16 v[100:103], v[72:75], v[14:17], v[100:103]
    s_waitcnt lgkmcnt(6)
    v_mov_b64 v[134:135], v[128:129]
    v_mov_b64 v[132:133], v[138:139]
    ds_read_b128 v[12:15], v165 offset:20736
    ds_read_b128 v[20:23], v165 offset:21248
    v_mfma_f32_16x16x32_bf16 v[104:107], v[72:75], v[134:137], v[104:107]
    v_mfma_f32_16x16x32_bf16 v[108:111], v[72:75], v[130:133], v[108:111]
    s_waitcnt vmcnt(4)
    s_waitcnt lgkmcnt(6)
    v_mov_b64 v[146:147], v[140:141]
    v_mov_b64 v[144:145], v[150:151]
    ds_read_b128 v[128:131], v165 offset:24576
    ds_read_b128 v[136:139], v165 offset:25088
    v_mfma_f32_16x16x32_bf16 v[96:99], v[76:79], v[146:149], v[96:99]
    v_mfma_f32_16x16x32_bf16 v[100:103], v[76:79], v[142:145], v[100:103]
    s_waitcnt lgkmcnt(6)
    v_mov_b64 v[158:159], v[152:153]
    v_mov_b64 v[156:157], v[162:163]
    ds_read_b128 v[140:143], v165 offset:24832
    ds_read_b128 v[148:151], v165 offset:25344
    v_mfma_f32_16x16x32_bf16 v[104:107], v[76:79], v[158:161], v[104:107]
    v_mfma_f32_16x16x32_bf16 v[108:111], v[76:79], v[154:157], v[108:111]
    s_waitcnt vmcnt(3)
    s_waitcnt lgkmcnt(6)
    v_mov_b64 v[118:119], v[112:113]
    v_mov_b64 v[116:117], v[122:123]
    ds_read_b128 v[152:155], v165 offset:28672
    ds_read_b128 v[160:163], v165 offset:29184
    v_mfma_f32_16x16x32_bf16 v[96:99], v[80:83], v[118:121], v[96:99]
    v_mfma_f32_16x16x32_bf16 v[100:103], v[80:83], v[114:117], v[100:103]
    s_waitcnt lgkmcnt(6)
    v_mov_b64 v[18:19], v[12:13]
    v_mov_b64 v[16:17], v[22:23]
    ds_read_b128 v[112:115], v165 offset:28928
    ds_read_b128 v[120:123], v165 offset:29440
    v_mfma_f32_16x16x32_bf16 v[104:107], v[80:83], v[18:21], v[104:107]
    v_mfma_f32_16x16x32_bf16 v[108:111], v[80:83], v[14:17], v[108:111]
    s_waitcnt vmcnt(2)
    s_waitcnt lgkmcnt(6)
    v_mov_b64 v[134:135], v[128:129]
    v_mov_b64 v[132:133], v[138:139]
    ds_read_b128 v[12:15], v165 offset:32768
    ds_read_b128 v[20:23], v165 offset:33280
    v_mfma_f32_16x16x32_bf16 v[96:99], v[84:87], v[134:137], v[96:99]
    v_mfma_f32_16x16x32_bf16 v[100:103], v[84:87], v[130:133], v[100:103]
    s_waitcnt lgkmcnt(6)
    v_mov_b64 v[146:147], v[140:141]
    v_mov_b64 v[144:145], v[150:151]
    ds_read_b128 v[128:131], v165 offset:33024
    ds_read_b128 v[136:139], v165 offset:33536
    v_mfma_f32_16x16x32_bf16 v[104:107], v[84:87], v[146:149], v[104:107]
    v_mfma_f32_16x16x32_bf16 v[108:111], v[84:87], v[142:145], v[108:111]
    s_waitcnt vmcnt(1)
    s_waitcnt lgkmcnt(6)
    v_mov_b64 v[158:159], v[152:153]
    v_mov_b64 v[156:157], v[162:163]
    s_nop 0
    v_mfma_f32_16x16x32_bf16 v[96:99], v[88:91], v[158:161], v[96:99]
    v_mfma_f32_16x16x32_bf16 v[100:103], v[88:91], v[154:157], v[100:103]
    s_waitcnt lgkmcnt(4)
    v_mov_b64 v[118:119], v[112:113]
    v_mov_b64 v[116:117], v[122:123]
    s_nop 0
    v_mfma_f32_16x16x32_bf16 v[104:107], v[88:91], v[118:121], v[104:107]
    v_mfma_f32_16x16x32_bf16 v[108:111], v[88:91], v[114:117], v[108:111]
    s_waitcnt vmcnt(0)
    s_waitcnt lgkmcnt(2)
    v_mov_b64 v[18:19], v[12:13]
    v_mov_b64 v[16:17], v[22:23]
    s_nop 0
    v_mfma_f32_16x16x32_bf16 v[96:99], v[92:95], v[18:21], v[96:99]
    v_mfma_f32_16x16x32_bf16 v[100:103], v[92:95], v[14:17], v[100:103]
    s_waitcnt lgkmcnt(0)
    v_mov_b64 v[134:135], v[128:129]
    v_mov_b64 v[132:133], v[138:139]
    s_nop 0
    v_mfma_f32_16x16x32_bf16 v[104:107], v[92:95], v[134:137], v[104:107]
    v_mfma_f32_16x16x32_bf16 v[108:111], v[92:95], v[130:133], v[108:111]
    buffer_load_dwordx4 v[24:27], v3, s[12:15], s39 offen offset:0 sc1
    buffer_load_dwordx4 v[28:31], v3, s[12:15], s39 offen offset:1024 sc1
    buffer_load_dwordx4 v[32:35], v3, s[12:15], s39 offen offset:2048 sc1
    buffer_load_dwordx4 v[36:39], v3, s[12:15], s39 offen offset:3072 sc1
    s_add_u32 s39, s39, 4096
    buffer_load_dwordx4 v[40:43], v3, s[12:15], s39 offen offset:0 sc1
    buffer_load_dwordx4 v[44:47], v3, s[12:15], s39 offen offset:1024 sc1
    buffer_load_dwordx4 v[48:51], v3, s[12:15], s39 offen offset:2048 sc1
    buffer_load_dwordx4 v[52:55], v3, s[12:15], s39 offen offset:3072 sc1
    s_add_u32 s39, s39, 4096
    buffer_load_dwordx4 v[56:59], v3, s[12:15], s39 offen offset:0 sc1
    s_mov_b32 s93, 0x800000
Lgw_34:
    ds_read_b32 v8, v7 offset:0
    s_waitcnt lgkmcnt(0)
    v_readfirstlane_b32 s27, v8
    s_nop 0
    s_cmp_ge_u32 s27, 2
    s_cbranch_scc1 Lgd_35
    s_sleep 1
    s_sub_u32 s93, s93, 1
    s_cbranch_scc0 Lgw_34
Lgd_35:
    ds_read_b128 v[12:15], v6
    s_waitcnt lgkmcnt(0)
    v_mul_f32 v96, v96, v12
    v_mul_f32 v97, v97, v12
    v_mul_f32 v98, v98, v12
    v_mul_f32 v99, v99, v12
    v_mul_f32 v100, v100, v13
    v_mul_f32 v101, v101, v13
    v_mul_f32 v102, v102, v13
    v_mul_f32 v103, v103, v13
    v_mul_f32 v104, v104, v14
    v_mul_f32 v105, v105, v14
    v_mul_f32 v106, v106, v14
    v_mul_f32 v107, v107, v14
    v_mul_f32 v108, v108, v15
    v_mul_f32 v109, v109, v15
    v_mul_f32 v110, v110, v15
    v_mul_f32 v111, v111, v15
    v_mul_f32 v128, v96, v96
    v_mul_f32 v129, v97, v97
    v_mul_f32 v130, v98, v98
    v_mul_f32 v131, v99, v99
    v_mul_f32 v132, v100, v100
    v_mul_f32 v133, v101, v101
    v_mul_f32 v134, v102, v102
    v_mul_f32 v135, v103, v103
    v_mul_f32 v136, v104, v104
    v_mul_f32 v137, v105, v105
    v_mul_f32 v138, v106, v106
    v_mul_f32 v139, v107, v107
    v_mul_f32 v140, v108, v108
    v_mul_f32 v141, v109, v109
    v_mul_f32 v142, v110, v110
    v_mul_f32 v143, v111, v111
    v_fmaak_f32 v128, v128, v9, 0xc0135761
    v_fmaak_f32 v129, v129, v9, 0xc0135761
    v_fmaak_f32 v130, v130, v9, 0xc0135761
    v_fmaak_f32 v131, v131, v9, 0xc0135761
    v_fmaak_f32 v132, v132, v9, 0xc0135761
    v_fmaak_f32 v133, v133, v9, 0xc0135761
    v_fmaak_f32 v134, v134, v9, 0xc0135761
    v_fmaak_f32 v135, v135, v9, 0xc0135761
    v_fmaak_f32 v136, v136, v9, 0xc0135761
    v_fmaak_f32 v137, v137, v9, 0xc0135761
    v_fmaak_f32 v138, v138, v9, 0xc0135761
    v_fmaak_f32 v139, v139, v9, 0xc0135761
    v_fmaak_f32 v140, v140, v9, 0xc0135761
    v_fmaak_f32 v141, v141, v9, 0xc0135761
    v_fmaak_f32 v142, v142, v9, 0xc0135761
    v_fmaak_f32 v143, v143, v9, 0xc0135761
    v_mul_f32 v128, v128, v96
    v_mul_f32 v129, v129, v97
    v_mul_f32 v130, v130, v98
    v_mul_f32 v131, v131, v99
    v_mul_f32 v132, v132, v100
    v_mul_f32 v133, v133, v101
    v_mul_f32 v134, v134, v102
    v_mul_f32 v135, v135, v103
    v_mul_f32 v136, v136, v104
    v_mul_f32 v137, v137, v105
    v_mul_f32 v138, v138, v106
    v_mul_f32 v139, v139, v107
    v_mul_f32 v140, v140, v108
    v_mul_f32 v141, v141, v109
    v_mul_f32 v142, v142, v110
    v_mul_f32 v143, v143, v111
    v_exp_f32 v128, v128
    v_exp_f32 v129, v129
    v_exp_f32 v130, v130
    v_exp_f32 v131, v131
    v_exp_f32 v132, v132
    v_exp_f32 v133, v133
    v_exp_f32 v134, v134
    v_exp_f32 v135, v135
    v_exp_f32 v136, v136
    v_exp_f32 v137, v137
    v_exp_f32 v138, v138
    v_exp_f32 v139, v139
    v_exp_f32 v140, v140
    v_exp_f32 v141, v141
    v_exp_f32 v142, v142
    v_exp_f32 v143, v143
    v_add_f32 v128, 1.0, v128
    v_add_f32 v129, 1.0, v129
    v_add_f32 v130, 1.0, v130
    v_add_f32 v131, 1.0, v131
    v_add_f32 v132, 1.0, v132
    v_add_f32 v133, 1.0, v133
    v_add_f32 v134, 1.0, v134
    v_add_f32 v135, 1.0, v135
    v_add_f32 v136, 1.0, v136
    v_add_f32 v137, 1.0, v137
    v_add_f32 v138, 1.0, v138
    v_add_f32 v139, 1.0, v139
    v_add_f32 v140, 1.0, v140
    v_add_f32 v141, 1.0, v141
    v_add_f32 v142, 1.0, v142
    v_add_f32 v143, 1.0, v143
    v_rcp_f32 v128, v128
    v_rcp_f32 v129, v129
    v_rcp_f32 v130, v130
    v_rcp_f32 v131, v131
    v_rcp_f32 v132, v132
    v_rcp_f32 v133, v133
    v_rcp_f32 v134, v134
    v_rcp_f32 v135, v135
    v_rcp_f32 v136, v136
    v_rcp_f32 v137, v137
    v_rcp_f32 v138, v138
    v_rcp_f32 v139, v139
    v_rcp_f32 v140, v140
    v_rcp_f32 v141, v141
    v_rcp_f32 v142, v142
    v_rcp_f32 v143, v143
    v_mul_f32 v96, v96, v128
    v_mul_f32 v97, v97, v129
    v_mul_f32 v98, v98, v130
    v_mul_f32 v99, v99, v131
    v_mul_f32 v100, v100, v132
    v_mul_f32 v101, v101, v133
    v_mul_f32 v102, v102, v134
    v_mul_f32 v103, v103, v135
    v_mul_f32 v104, v104, v136
    v_mul_f32 v105, v105, v137
    v_mul_f32 v106, v106, v138
    v_mul_f32 v107, v107, v139
    v_mul_f32 v108, v108, v140
    v_mul_f32 v109, v109, v141
    v_mul_f32 v110, v110, v142
    v_mul_f32 v111, v111, v143
    v_cvt_pk_bf16_f32 v16, v96, v97
    v_cvt_pk_bf16_f32 v17, v98, v99
    v_cvt_pk_bf16_f32 v18, v100, v101
    v_cvt_pk_bf16_f32 v19, v102, v103
    s_nop 0
    v_permlane16_swap_b32 v16, v18
    v_permlane16_swap_b32 v17, v19
    buffer_store_dwordx4 v[16:19], v5, s[12:15], s24 offen sc1
    v_cvt_pk_bf16_f32 v20, v104, v105
    v_cvt_pk_bf16_f32 v21, v106, v107
    v_cvt_pk_bf16_f32 v22, v108, v109
    v_cvt_pk_bf16_f32 v23, v110, v111
    s_nop 0
    v_permlane16_swap_b32 v20, v22
    v_permlane16_swap_b32 v21, v23
    buffer_store_dwordx4 v[20:23], v5, s[12:15], s26 offen sc1
    s_mov_b64 exec, 1
    s_waitcnt vmcnt(0)
    ds_add_rtn_u32 v8, v7, v10 offset:4
    s_waitcnt lgkmcnt(0)
    v_readfirstlane_b32 s27, v8
    s_nop 0
    s_cmp_lg_u32 s27, 5
    s_cbranch_scc1 Lnosig_36
    buffer_store_dword v10, v11, s[12:15], s28 offen sc1
Lnosig_36:
    s_mov_b64 exec, -1
    s_branch K3_join
K3_ks:
    s_lshr_b32 s41, s3, 2
    s_and_b32 s19, s3, 1
    s_mul_i32 s22, s17, 6
    s_lshl_b32 s42, s19, 1
    s_add_u32 s22, s22, s42
    s_add_u32 s22, s22, s41
    s_mul_i32 s23, s22, 18432
    s_mul_i32 s42, s41, 9216
    s_add_u32 s23, s23, s42
    s_add_u32 s23, s23, 0x1104000
    s_mul_i32 s25, s41, 36864
    s_sub_u32 s25, s23, s25
    s_add_u32 s25, s25, 18432
    s_mul_i32 s42, s41, 36864
    v_add_u32 v164, s42, v164
    s_barrier
    s_add_u32 m0, s21, 0
    s_nop 0
    buffer_load_dwordx4 v166, s[12:15], s20 offen sc1 lds
    s_add_u32 s20, s20, 32768
    s_add_u32 m0, s21, 1024
    s_nop 0
    buffer_load_dwordx4 v166, s[12:15], s20 offen sc1 lds
    s_add_u32 s20, s20, 32768
    s_add_u32 m0, s21, 2048
    s_nop 0
    buffer_load_dwordx4 v166, s[12:15], s20 offen sc1 lds
    s_add_u32 s20, s20, 32768
    s_add_u32 m0, s21, 3072
    s_nop 0
    buffer_load_dwordx4 v166, s[12:15], s20 offen sc1 lds
    s_add_u32 s20, s20, 32768
    s_add_u32 m0, s21, 4096
    s_nop 0
    buffer_load_dwordx4 v166, s[12:15], s20 offen sc1 lds
    s_add_u32 s20, s20, 32768
    s_add_u32 m0, s21, 5120
    s_nop 0
    buffer_load_dwordx4 v166, s[12:15], s20 offen sc1 lds
    s_barrier
    buffer_load_dwordx4 v[24:27], v3, s[12:15], s23 offen offset:0 sc1
    buffer_load_dwordx4 v[28:31], v3, s[12:15], s25 offen offset:0 sc1
    buffer_load_dwordx4 v[32:35], v3, s[12:15], s23 offen offset:1024 sc1
    buffer_load_dwordx4 v[36:39], v3, s[12:15], s25 offen offset:1024 sc1
    buffer_load_dwordx4 v[40:43], v3, s[12:15], s23 offen offset:2048 sc1
    buffer_load_dwordx4 v[44:47], v3, s[12:15], s25 offen offset:2048 sc1
    v_bfe_u32 v6, v0, 3, 1
    v_mul_u32_u24 v5, 18432, v6
    v_and_b32 v6, 7, v0
    v_lshl_add_u32 v5, v6, 5, v5
    v_bfe_u32 v6, v0, 4, 1
    v_lshl_add_u32 v5, v6, 4, v5
    v_lshrrev_b32 v6, 5, v0
    v_lshl_add_u32 v5, v6, 8, v5
    v_and_b32 v6, 15, v0
    v_lshlrev_b32 v6, 4, v6
    v_add_u32 v6, 73728, v6
    v_mov_b32 v7, 73984
    v_mov_b32 v9, 0xbdd2d3e8
    v_mov_b32 v10, 1
    v_mov_b32 v11, 0
    s_lshl_b32 s24, s22, 9
    s_add_u32 s24, s24, s18
    s_add_u32 s24, s24, 0xb40000
    s_add_u32 s26, s24, 36864
    s_lshl_b32 s28, s16, 7
    s_lshl_b32 s29, s17, 4
    s_add_u32 s28, s28, s29
    s_add_u32 s28, s28, 0x2dd6000
    s_lshl_b32 s42, s19, 13
    s_lshl_b32 s43, s41, 12
    s_add_u32 s42, s42, 87552
    s_add_u32 s29, s42, s43
    v_add_u32 v1, s29, v3
    s_xor_b32 s43, s43, 4096
    s_add_u32 s29, s42, s43
    v_add_u32 v2, s29, v3
    s_lshl_b32 s42, s19, 2
    v_add_u32 v4, s42, v7
    s_waitcnt vmcnt(6)
    s_barrier
    buffer_load_dwordx4 v[48:51], v3, s[12:15], s23 offen offset:3072 sc1
    buffer_load_dwordx4 v[52:55], v3, s[12:15], s25 offen offset:3072 sc1
    s_add_u32 s23, s23, 4096
    s_add_u32 s25, s25, 4096
    buffer_load_dwordx4 v[56:59], v3, s[12:15], s23 offen offset:0 sc1
    buffer_load_dwordx4 v[60:63], v3, s[12:15], s25 offen offset:0 sc1
    buffer_load_dwordx4 v[64:67], v3, s[12:15], s23 offen offset:1024 sc1
    buffer_load_dwordx4 v[68:71], v3, s[12:15], s25 offen offset:1024 sc1
    buffer_load_dwordx4 v[72:75], v3, s[12:15], s23 offen offset:2048 sc1
    buffer_load_dwordx4 v[76:79], v3, s[12:15], s25 offen offset:2048 sc1
    buffer_load_dwordx4 v[80:83], v3, s[12:15], s23 offen offset:3072 sc1
    buffer_load_dwordx4 v[84:87], v3, s[12:15], s25 offen offset:3072 sc1
    s_add_u32 s23, s23, 4096
    s_add_u32 s25, s25, 4096
    buffer_load_dwordx4 v[88:91], v3, s[12:15], s23 offen offset:0 sc1
    buffer_load_dwordx4 v[92:95], v3, s[12:15], s25 offen offset:0 sc1
    ds_read_b128 v[128:131], v164 offset:0
    ds_read_b128 v[136:139], v164 offset:512
    ds_read_b128 v[140:143], v164 offset:256
    ds_read_b128 v[148:151], v164 offset:768
    ds_read_b128 v[152:155], v164 offset:4096
    ds_read_b128 v[160:163], v164 offset:4608
    s_waitcnt vmcnt(16) lgkmcnt(4)
    v_mov_b64 v[134:135], v[128:129]
    v_mov_b64 v[132:133], v[138:139]
    ds_read_b128 v[12:15], v164 offset:4352
    ds_read_b128 v[20:23], v164 offset:4864
    v_mfma_f32_16x16x32_bf16 v[96:99], v[24:27], v[134:137], 0
    v_mfma_f32_16x16x32_bf16 v[112:115], v[28:31], v[134:137], 0
    v_mfma_f32_16x16x32_bf16 v[100:103], v[24:27], v[130:133], 0
    v_mfma_f32_16x16x32_bf16 v[116:119], v[28:31], v[130:133], 0
    s_waitcnt lgkmcnt(4)
    v_mov_b64 v[146:147], v[140:141]
    v_mov_b64 v[144:145], v[150:151]
    ds_read_b128 v[128:131], v164 offset:8192
    ds_read_b128 v[136:139], v164 offset:8704
    v_mfma_f32_16x16x32_bf16 v[104:107], v[24:27], v[146:149], 0
    v_mfma_f32_16x16x32_bf16 v[120:123], v[28:31], v[146:149], 0
    v_mfma_f32_16x16x32_bf16 v[108:111], v[24:27], v[142:145], 0
    v_mfma_f32_16x16x32_bf16 v[124:127], v[28:31], v[142:145], 0
    s_waitcnt vmcnt(14) lgkmcnt(4)
    v_mov_b64 v[158:159], v[152:153]
    v_mov_b64 v[156:157], v[162:163]
    ds_read_b128 v[140:143], v164 offset:8448
    ds_read_b128 v[148:151], v164 offset:8960
    v_mfma_f32_16x16x32_bf16 v[96:99], v[32:35], v[158:161], v[96:99]
    v_mfma_f32_16x16x32_bf16 v[112:115], v[36:39], v[158:161], v[112:115]
    v_mfma_f32_16x16x32_bf16 v[100:103], v[32:35], v[154:157], v[100:103]
    v_mfma_f32_16x16x32_bf16 v[116:119], v[36:39], v[154:157], v[116:119]
    s_waitcnt lgkmcnt(4)
    v_mov_b64 v[18:19], v[12:13]
    v_mov_b64 v[16:17], v[22:23]
    ds_read_b128 v[152:155], v164 offset:12288
    ds_read_b128 v[160:163], v164 offset:12800
    v_mfma_f32_16x16x32_bf16 v[104:107], v[32:35], v[18:21], v[104:107]
    v_mfma_f32_16x16x32_bf16 v[120:123], v[36:39], v[18:21], v[120:123]
    v_mfma_f32_16x16x32_bf16 v[108:111], v[32:35], v[14:17], v[108:111]
    v_mfma_f32_16x16x32_bf16 v[124:127], v[36:39], v[14:17], v[124:127]
    s_waitcnt vmcnt(12) lgkmcnt(4)
    v_mov_b64 v[134:135], v[128:129]
    v_mov_b64 v[132:133], v[138:139]
    ds_read_b128 v[12:15], v164 offset:12544
    ds_read_b128 v[20:23], v164 offset:13056
    v_mfma_f32_16x16x32_bf16 v[96:99], v[40:43], v[134:137], v[96:99]
    v_mfma_f32_16x16x32_bf16 v[112:115], v[44:47], v[134:137], v[112:115]
    v_mfma_f32_16x16x32_bf16 v[100:103], v[40:43], v[130:133], v[100:103]
    v_mfma_f32_16x16x32_bf16 v[116:119], v[44:47], v[130:133], v[116:119]
    s_waitcnt lgkmcnt(4)
    v_mov_b64 v[146:147], v[140:141]
    v_mov_b64 v[144:145], v[150:151]
    ds_read_b128 v[128:131], v164 offset:16384
    ds_read_b128 v[136:139], v164 offset:16896
    v_mfma_f32_16x16x32_bf16 v[104:107], v[40:43], v[146:149], v[104:107]
    v_mfma_f32_16x16x32_bf16 v[120:123], v[44:47], v[146:149], v[120:123]
    v_mfma_f32_16x16x32_bf16 v[108:111], v[40:43], v[142:145], v[108:111]
    v_mfma_f32_16x16x32_bf16 v[124:127], v[44:47], v[142:145], v[124:127]
    s_waitcnt vmcnt(10) lgkmcnt(4)
    v_mov_b64 v[158:159], v[152:153]
    v_mov_b64 v[156:157], v[162:163]
    ds_read_b128 v[140:143], v164 offset:16640
    ds_read_b128 v[148:151], v164 offset:17152
    v_mfma_f32_16x16x32_bf16 v[96:99], v[48:51], v[158:161], v[96:99]
    v_mfma_f32_16x16x32_bf16 v[112:115], v[52:55], v[158:161], v[112:115]
    v_mfma_f32_16x16x32_bf16 v[100:103], v[48:51], v[154:157], v[100:103]
    v_mfma_f32_16x16x32_bf16 v[116:119], v[52:55], v[154:157], v[116:119]
    s_waitcnt lgkmcnt(4)
    v_mov_b64 v[18:19], v[12:13]
    v_mov_b64 v[16:17], v[22:23]
    ds_read_b128 v[152:155], v164 offset:20480
    ds_read_b128 v[160:163], v164 offset:20992
    v_mfma_f32_16x16x32_bf16 v[104:107], v[48:51], v[18:21], v[104:107]
    v_mfma_f32_16x16x32_bf16 v[120:123], v[52:55], v[18:21], v[120:123]
    v_mfma_f32_16x16x32_bf16 v[108:111], v[48:51], v[14:17], v[108:111]
    v_mfma_f32_16x16x32_bf16 v[124:127], v[52:55], v[14:17], v[124:127]
    s_waitcnt vmcnt(8) lgkmcnt(4)
    v_mov_b64 v[134:135], v[128:129]
    v_mov_b64 v[132:133], v[138:139]
    ds_read_b128 v[12:15], v164 offset:20736
    ds_read_b128 v[20:23], v164 offset:21248
    v_mfma_f32_16x16x32_bf16 v[96:99], v[56:59], v[134:137], v[96:99]
    v_mfma_f32_16x16x32_bf16 v[112:115], v[60:63], v[134:137], v[112:115]
    v_mfma_f32_16x16x32_bf16 v[100:103], v[56:59], v[130:133], v[100:103]
    v_mfma_f32_16x16x32_bf16 v[116:119], v[60:63], v[130:133], v[116:119]
    s_waitcnt lgkmcnt(4)
    v_mov_b64 v[146:147], v[140:141]
    v_mov_b64 v[144:145], v[150:151]
    ds_read_b128 v[128:131], v164 offset:24576
    ds_read_b128 v[136:139], v164 offset:25088
    v_mfma_f32_16x16x32_bf16 v[104:107], v[56:59], v[146:149], v[104:107]
    v_mfma_f32_16x16x32_bf16 v[120:123], v[60:63], v[146:149], v[120:123]
    v_mfma_f32_16x16x32_bf16 v[108:111], v[56:59], v[142:145], v[108:111]
    v_mfma_f32_16x16x32_bf16 v[124:127], v[60:63], v[142:145], v[124:127]
    s_waitcnt vmcnt(6) lgkmcnt(4)
    v_mov_b64 v[158:159], v[152:153]
    v_mov_b64 v[156:157], v[162:163]
    ds_read_b128 v[140:143], v164 offset:24832
    ds_read_b128 v[148:151], v164 offset:25344
    v_mfma_f32_16x16x32_bf16 v[96:99], v[64:67], v[158:161], v[96:99]
    v_mfma_f32_16x16x32_bf16 v[112:115], v[68:71], v[158:161], v[112:115]
    v_mfma_f32_16x16x32_bf16 v[100:103], v[64:67], v[154:157], v[100:103]
    v_mfma_f32_16x16x32_bf16 v[116:119], v[68:71], v[154:157], v[116:119]
    s_waitcnt lgkmcnt(4)
    v_mov_b64 v[18:19], v[12:13]
    v_mov_b64 v[16:17], v[22:23]
    ds_read_b128 v[152:155], v164 offset:28672
    ds_read_b128 v[160:163], v164 offset:29184
    v_mfma_f32_16x16x32_bf16 v[104:107], v[64:67], v[18:21], v[104:107]
    v_mfma_f32_16x16x32_bf16 v[120:123], v[68:71], v[18:21], v[120:123]
    v_mfma_f32_16x16x32_bf16 v[108:111], v[64:67], v[14:17], v[108:111]
    v_mfma_f32_16x16x32_bf16 v[124:127], v[68:71], v[14:17], v[124:127]
    s_waitcnt vmcnt(4) lgkmcnt(4)
    v_mov_b64 v[134:135], v[128:129]
    v_mov_b64 v[132:133], v[138:139]
    ds_read_b128 v[12:15], v164 offset:28928
    ds_read_b128 v[20:23], v164 offset:29440
    v_mfma_f32_16x16x32_bf16 v[96:99], v[72:75], v[134:137], v[96:99]
    v_mfma_f32_16x16x32_bf16 v[112:115], v[76:79], v[134:137], v[112:115]
    v_mfma_f32_16x16x32_bf16 v[100:103], v[72:75], v[130:133], v[100:103]
    v_mfma_f32_16x16x32_bf16 v[116:119], v[76:79], v[130:133], v[116:119]
    s_waitcnt lgkmcnt(4)
    v_mov_b64 v[146:147], v[140:141]
    v_mov_b64 v[144:145], v[150:151]
    ds_read_b128 v[128:131], v164 offset:32768
    ds_read_b128 v[136:139], v164 offset:33280
    v_mfma_f32_16x16x32_bf16 v[104:107], v[72:75], v[146:149], v[104:107]
    v_mfma_f32_16x16x32_bf16 v[120:123], v[76:79], v[146:149], v[120:123]
    v_mfma_f32_16x16x32_bf16 v[108:111], v[72:75], v[142:145], v[108:111]
    v_mfma_f32_16x16x32_bf16 v[124:127], v[76:79], v[142:145], v[124:127]
    s_waitcnt vmcnt(2) lgkmcnt(4)
    v_mov_b64 v[158:159], v[152:153]
    v_mov_b64 v[156:157], v[162:163]
    ds_read_b128 v[140:143], v164 offset:33024
    ds_read_b128 v[148:151], v164 offset:33536
    v_mfma_f32_16x16x32_bf16 v[96:99], v[80:83], v[158:161], v[96:99]
    v_mfma_f32_16x16x32_bf16 v[112:115], v[84:87], v[158:161], v[112:115]
    v_mfma_f32_16x16x32_bf16 v[100:103], v[80:83], v[154:157], v[100:103]
    v_mfma_f32_16x16x32_bf16 v[116:119], v[84:87], v[154:157], v[116:119]
    s_waitcnt lgkmcnt(4)
    v_mov_b64 v[18:19], v[12:13]
    v_mov_b64 v[16:17], v[22:23]
    s_nop 0
    v_mfma_f32_16x16x32_bf16 v[104:107], v[80:83], v[18:21], v[104:107]
    v_mfma_f32_16x16x32_bf16 v[120:123], v[84:87], v[18:21], v[120:123]
    v_mfma_f32_16x16x32_bf16 v[108:111], v[80:83], v[14:17], v[108:111]
    v_mfma_f32_16x16x32_bf16 v[124:127], v[84:87], v[14:17], v[124:127]
    s_waitcnt vmcnt(0) lgkmcnt(2)
    v_mov_b64 v[134:135], v[128:129]
    v_mov_b64 v[132:133], v[138:139]
    s_nop 0
    v_mfma_f32_16x16x32_bf16 v[96:99], v[88:91], v[134:137], v[96:99]
    v_mfma_f32_16x16x32_bf16 v[112:115], v[92:95], v[134:137], v[112:115]
    v_mfma_f32_16x16x32_bf16 v[100:103], v[88:91], v[130:133], v[100:103]
    v_mfma_f32_16x16x32_bf16 v[116:119], v[92:95], v[130:133], v[116:119]
    s_waitcnt lgkmcnt(0)
    v_mov_b64 v[146:147], v[140:141]
    v_mov_b64 v[144:145], v[150:151]
    s_nop 0
    v_mfma_f32_16x16x32_bf16 v[104:107], v[88:91], v[146:149], v[104:107]
    v_mfma_f32_16x16x32_bf16 v[120:123], v[92:95], v[146:149], v[120:123]
    v_mfma_f32_16x16x32_bf16 v[108:111], v[88:91], v[142:145], v[108:111]
    v_mfma_f32_16x16x32_bf16 v[124:127], v[92:95], v[142:145], v[124:127]
    ds_write_b128 v1, v[112:115] offset:0
    ds_write_b128 v1, v[116:119] offset:1024
    s_nop 3
    ds_write_b128 v1, v[120:123] offset:2048
    s_nop 0
    ds_write_b128 v1, v[124:127] offset:3072
    s_mov_b64 exec, 1
    s_waitcnt lgkmcnt(0)
    ds_add_u32 v4, v10 offset:12
    s_mov_b64 exec, -1
    buffer_load_dwordx4 v[24:27], v3, s[12:15], s39 offen offset:0 sc1
    buffer_load_dwordx4 v[28:31], v3, s[12:15], s39 offen offset:1024 sc1
    buffer_load_dwordx4 v[32:35], v3, s[12:15], s39 offen offset:2048 sc1
    buffer_load_dwordx4 v[36:39], v3, s[12:15], s39 offen offset:3072 sc1
    s_add_u32 s39, s39, 4096
    buffer_load_dwordx4 v[40:43], v3, s[12:15], s39 offen offset:0 sc1
    buffer_load_dwordx4 v[44:47], v3, s[12:15], s39 offen offset:1024 sc1
    buffer_load_dwordx4 v[48:51], v3, s[12:15], s39 offen offset:2048 sc1
    buffer_load_dwordx4 v[52:55], v3, s[12:15], s39 offen offset:3072 sc1
    s_add_u32 s39, s39, 4096
    buffer_load_dwordx4 v[56:59], v3, s[12:15], s39 offen offset:0 sc1
    s_mov_b32 s93, 0x800000
Lgw_37:
    ds_read_b32 v8, v4 offset:12
    s_waitcnt lgkmcnt(0)
    v_readfirstlane_b32 s27, v8
    s_nop 0
    s_cmp_ge_u32 s27, 2
    s_cbranch_scc1 Lgd_38
    s_sleep 1
    s_sub_u32 s93, s93, 1
    s_cbranch_scc0 Lgw_37
Lgd_38:
    ds_read_b128 v[112:115], v2 offset:0
    ds_read_b128 v[116:119], v2 offset:1024
    ds_read_b128 v[120:123], v2 offset:2048
    ds_read_b128 v[124:127], v2 offset:3072
    s_mov_b32 s93, 0x800000
Lgw_39:
    ds_read_b32 v8, v7 offset:0
    s_waitcnt lgkmcnt(0)
    v_readfirstlane_b32 s27, v8
    s_nop 0
    s_cmp_ge_u32 s27, 2
    s_cbranch_scc1 Lgd_40
    s_sleep 1
    s_sub_u32 s93, s93, 1
    s_cbranch_scc0 Lgw_39
Lgd_40:
    ds_read_b128 v[12:15], v6
    v_add_f32 v96, v96, v112
    v_add_f32 v97, v97, v113
    v_add_f32 v98, v98, v114
    v_add_f32 v99, v99, v115
    v_add_f32 v100, v100, v116
    v_add_f32 v101, v101, v117
    v_add_f32 v102, v102, v118
    v_add_f32 v103, v103, v119
    v_add_f32 v104, v104, v120
    v_add_f32 v105, v105, v121
    v_add_f32 v106, v106, v122
    v_add_f32 v107, v107, v123
    v_add_f32 v108, v108, v124
    v_add_f32 v109, v109, v125
    v_add_f32 v110, v110, v126
    v_add_f32 v111, v111, v127
    s_waitcnt lgkmcnt(0)
    v_mul_f32 v96, v96, v12
    v_mul_f32 v97, v97, v12
    v_mul_f32 v98, v98, v12
    v_mul_f32 v99, v99, v12
    v_mul_f32 v100, v100, v13
    v_mul_f32 v101, v101, v13
    v_mul_f32 v102, v102, v13
    v_mul_f32 v103, v103, v13
    v_mul_f32 v104, v104, v14
    v_mul_f32 v105, v105, v14
    v_mul_f32 v106, v106, v14
    v_mul_f32 v107, v107, v14
    v_mul_f32 v108, v108, v15
    v_mul_f32 v109, v109, v15
    v_mul_f32 v110, v110, v15
    v_mul_f32 v111, v111, v15
    v_mul_f32 v128, v96, v96
    v_mul_f32 v129, v97, v97
    v_mul_f32 v130, v98, v98
    v_mul_f32 v131, v99, v99
    v_mul_f32 v132, v100, v100
    v_mul_f32 v133, v101, v101
    v_mul_f32 v134, v102, v102
    v_mul_f32 v135, v103, v103
    v_mul_f32 v136, v104, v104
    v_mul_f32 v137, v105, v105
    v_mul_f32 v138, v106, v106
    v_mul_f32 v139, v107, v107
    v_mul_f32 v140, v108, v108
    v_mul_f32 v141, v109, v109
    v_mul_f32 v142, v110, v110
    v_mul_f32 v143, v111, v111
    v_fmaak_f32 v128, v128, v9, 0xc0135761
    v_fmaak_f32 v129, v129, v9, 0xc0135761
    v_fmaak_f32 v130, v130, v9, 0xc0135761
    v_fmaak_f32 v131, v131, v9, 0xc0135761
    v_fmaak_f32 v132, v132, v9, 0xc0135761
    v_fmaak_f32 v133, v133, v9, 0xc0135761
    v_fmaak_f32 v134, v134, v9, 0xc0135761
    v_fmaak_f32 v135, v135, v9, 0xc0135761
    v_fmaak_f32 v136, v136, v9, 0xc0135761
    v_fmaak_f32 v137, v137, v9, 0xc0135761
    v_fmaak_f32 v138, v138, v9, 0xc0135761
    v_fmaak_f32 v139, v139, v9, 0xc0135761
    v_fmaak_f32 v140, v140, v9, 0xc0135761
    v_fmaak_f32 v141, v141, v9, 0xc0135761
    v_fmaak_f32 v142, v142, v9, 0xc0135761
    v_fmaak_f32 v143, v143, v9, 0xc0135761
    v_mul_f32 v128, v128, v96
    v_mul_f32 v129, v129, v97
    v_mul_f32 v130, v130, v98
    v_mul_f32 v131, v131, v99
    v_mul_f32 v132, v132, v100
    v_mul_f32 v133, v133, v101
    v_mul_f32 v134, v134, v102
    v_mul_f32 v135, v135, v103
    v_mul_f32 v136, v136, v104
    v_mul_f32 v137, v137, v105
    v_mul_f32 v138, v138, v106
    v_mul_f32 v139, v139, v107
    v_mul_f32 v140, v140, v108
    v_mul_f32 v141, v141, v109
    v_mul_f32 v142, v142, v110
    v_mul_f32 v143, v143, v111
    v_exp_f32 v128, v128
    v_exp_f32 v129, v129
    v_exp_f32 v130, v130
    v_exp_f32 v131, v131
    v_exp_f32 v132, v132
    v_exp_f32 v133, v133
    v_exp_f32 v134, v134
    v_exp_f32 v135, v135
    v_exp_f32 v136, v136
    v_exp_f32 v137, v137
    v_exp_f32 v138, v138
    v_exp_f32 v139, v139
    v_exp_f32 v140, v140
    v_exp_f32 v141, v141
    v_exp_f32 v142, v142
    v_exp_f32 v143, v143
    v_add_f32 v128, 1.0, v128
    v_add_f32 v129, 1.0, v129
    v_add_f32 v130, 1.0, v130
    v_add_f32 v131, 1.0, v131
    v_add_f32 v132, 1.0, v132
    v_add_f32 v133, 1.0, v133
    v_add_f32 v134, 1.0, v134
    v_add_f32 v135, 1.0, v135
    v_add_f32 v136, 1.0, v136
    v_add_f32 v137, 1.0, v137
    v_add_f32 v138, 1.0, v138
    v_add_f32 v139, 1.0, v139
    v_add_f32 v140, 1.0, v140
    v_add_f32 v141, 1.0, v141
    v_add_f32 v142, 1.0, v142
    v_add_f32 v143, 1.0, v143
    v_rcp_f32 v128, v128
    v_rcp_f32 v129, v129
    v_rcp_f32 v130, v130
    v_rcp_f32 v131, v131
    v_rcp_f32 v132, v132
    v_rcp_f32 v133, v133
    v_rcp_f32 v134, v134
    v_rcp_f32 v135, v135
    v_rcp_f32 v136, v136
    v_rcp_f32 v137, v137
    v_rcp_f32 v138, v138
    v_rcp_f32 v139, v139
    v_rcp_f32 v140, v140
    v_rcp_f32 v141, v141
    v_rcp_f32 v142, v142
    v_rcp_f32 v143, v143
    v_mul_f32 v96, v96, v128
    v_mul_f32 v97, v97, v129
    v_mul_f32 v98, v98, v130
    v_mul_f32 v99, v99, v131
    v_mul_f32 v100, v100, v132
    v_mul_f32 v101, v101, v133
    v_mul_f32 v102, v102, v134
    v_mul_f32 v103, v103, v135
    v_mul_f32 v104, v104, v136
    v_mul_f32 v105, v105, v137
    v_mul_f32 v106, v106, v138
    v_mul_f32 v107, v107, v139
    v_mul_f32 v108, v108, v140
    v_mul_f32 v109, v109, v141
    v_mul_f32 v110, v110, v142
    v_mul_f32 v111, v111, v143
    v_cvt_pk_bf16_f32 v16, v96, v97
    v_cvt_pk_bf16_f32 v17, v98, v99
    v_cvt_pk_bf16_f32 v18, v100, v101
    v_cvt_pk_bf16_f32 v19, v102, v103
    s_nop 0
    v_permlane16_swap_b32 v16, v18
    v_permlane16_swap_b32 v17, v19
    buffer_store_dwordx4 v[16:19], v5, s[12:15], s24 offen sc1
    v_cvt_pk_bf16_f32 v20, v104, v105
    v_cvt_pk_bf16_f32 v21, v106, v107
    v_cvt_pk_bf16_f32 v22, v108, v109
    v_cvt_pk_bf16_f32 v23, v110, v111
    s_nop 0
    v_permlane16_swap_b32 v20, v22
    v_permlane16_swap_b32 v21, v23
    buffer_store_dwordx4 v[20:23], v5, s[12:15], s26 offen sc1
    s_mov_b64 exec, 1
    s_waitcnt vmcnt(0)
    ds_add_rtn_u32 v8, v7, v10 offset:4
    s_waitcnt lgkmcnt(0)
    v_readfirstlane_b32 s27, v8
    s_nop 0
    s_cmp_lg_u32 s27, 5
    s_cbranch_scc1 Lnosig_41
    buffer_store_dword v10, v11, s[12:15], s28 offen sc1
Lnosig_41:
    s_mov_b64 exec, -1
    s_branch K3_join
K3_stat:
    s_sub_u32 s22, s3, 6
    s_min_u32 s22, s22, 2
    s_setprio 3
    v_mov_b32 v8, 0
    v_mov_b32 v73, 73984
    ds_write_b32 v73, v8
    ds_write_b32 v73, v8 offset:4
    ds_write_b32 v73, v8 offset:8
    ds_write_b32 v73, v8 offset:12
    ds_write_b32 v73, v8 offset:16
    s_cmp_lt_u32 s3, 6
    s_cbranch_scc1 L9_43
    s_and_b32 s30, s2, 7
    s_mul_i32 s30, s30, 32768
    s_add_u32 s30, s30, 0x2dee800
    v_lshlrev_b32 v9, 5, v0
    s_lshl_b32 s31, s22, 11
    s_add_u32 s31, s31, 8192
    v_add_u32 v9, s31, v9
    s_cmp_lg_u32 s22, 2
    s_cbranch_scc1 L8_42
    s_mul_i32 s32, s17, 96
    s_add_u32 s31, s32, 95
    s_lshr_b32 s32, s32, 6
    s_lshr_b32 s31, s31, 6
    v_and_b32 v8, 1, v0
    v_mov_b32 v11, s32
    v_mov_b32 v10, s31
    v_cmp_eq_u32 vcc, 1, v8
    s_nop 1
    v_cndmask_b32 v11, v11, v10, vcc
    v_bfe_u32 v8, v0, 1, 3
    v_lshl_add_u32 v10, v8, 3, v11
    v_add_u32 v8, 40, v8
    v_cmp_eq_u32 vcc, 8, v11
    s_nop 1
    v_cndmask_b32 v11, v10, v8, vcc
    v_add_u32 v11, 400, v11
    v_add_u32 v8, 214, v0
    v_cmp_lt_u32 vcc, 25, v0
    s_nop 1
    v_cndmask_b32 v11, v11, v8, vcc
    v_lshlrev_b32 v11, 5, v11
    v_cmp_lt_u32 vcc, 15, v0
    s_nop 1
    v_cndmask_b32 v9, v9, v11, vcc
    s_mov_b32 exec_hi, 0xff
L8_42:
    s_mov_b32 s93, 0x1fffff
Lpoll_44:
    buffer_load_dword v10, v9, s[12:15], s30 offen sc1
    s_and_b32 s92, s93, 63
    s_cbranch_scc1 Lchk_46
    s_waitcnt vmcnt(0)
    v_mov_b32 v10, 0
    buffer_atomic_or v10, v9, s[12:15], s30 offen sc0 sc1
Lchk_46:
    s_waitcnt vmcnt(0)
    v_cmp_eq_u32 vcc, 0, v10
    s_nop 4
    s_cbranch_vccz Lgo_45
    s_mov_b64 exec, vcc
    s_sleep 3
    s_sub_u32 s93, s93, 1
    s_cbranch_scc0 Lpoll_44
Lgo_45:
    s_mov_b64 exec, -1
L9_43:
    s_barrier
    s_add_u32 m0, s21, 0
    s_nop 0
    buffer_load_dwordx4 v166, s[12:15], s20 offen sc1 lds
    s_add_u32 s20, s20, 32768
    s_add_u32 m0, s21, 1024
    s_nop 0
    buffer_load_dwordx4 v166, s[12:15], s20 offen sc1 lds
    s_add_u32 s20, s20, 32768
    s_add_u32 m0, s21, 2048
    s_nop 0
    buffer_load_dwordx4 v166, s[12:15], s20 offen sc1 lds
    s_add_u32 s20, s20, 32768
    s_add_u32 m0, s21, 3072
    s_nop 0
    buffer_load_dwordx4 v166, s[12:15], s20 offen sc1 lds
    s_add_u32 s20, s20, 32768
    s_add_u32 m0, s21, 4096
    s_nop 0
    buffer_load_dwordx4 v166, s[12:15], s20 offen sc1 lds
    s_add_u32 s20, s20, 32768
    s_add_u32 m0, s21, 5120
    s_nop 0
    buffer_load_dwordx4 v166, s[12:15], s20 offen sc1 lds
    s_barrier
    s_cmp_eq_u32 s22, 2
    s_cbranch_scc1 Lidle_47
    v_and_b32 v7, 15, v0
    s_lshl_b32 s24, s16, 6
    s_lshl_b32 s25, s22, 5
    s_add_u32 s24, s24, s25
    v_add_u32 v1, s24, v7
    s_lshr_b32 s24, s24, 5
    s_lshr_b32 s25, s24, 5
    s_lshl_b32 s25, s25, 2
    s_bfe_u32 s26, s24, 0x20002
    s_add_u32 s25, s25, s26
    s_lshl_b32 s25, s25, 11
    s_bfe_u32 s26, s24, 0x10004
    s_lshl_b32 s26, s26, 7
    s_add_u32 s25, s25, s26
    s_and_b32 s26, s24, 3
    s_lshl_b32 s26, s26, 3
    s_add_u32 s25, s25, s26
    s_add_u32 s25, s25, 0x2dc8000
    v_lshrrev_b32 v1, 1, v7
    v_lshlrev_b32 v1, 8, v1
    v_and_b32 v2, 1, v7
    v_lshl_add_u32 v1, v2, 6, v1
    buffer_load_dwordx2 v[18:19], v1, s[12:15], s25 offen offset:0 sc1
    buffer_load_dwordx2 v[22:23], v1, s[12:15], s25 offen offset:32 sc1
    s_lshl_b32 s23, s22, 8
    v_add_u32 v164, s23, v164
    v_add_u32 v165, s23, v165
    v_lshrrev_b32 v6, 4, v0
    v_cmp_eq_u32 vcc, 3, v6
    v_mov_b32 v5, -1
    v_mov_b32 v6, 0xffff
    v_cndmask_b32 v5, v5, v6, vcc
    v_and_b32 v2, 3, v0
    v_cmp_eq_u32 s[30:31], 1, v2
    v_cmp_eq_u32 s[32:33], 2, v2
    v_cmp_eq_u32 s[34:35], 3, v2
    v_lshlrev_b32 v7, 4, v7
    s_lshl_b32 s23, s22, 3
    s_add_u32 s23, s23, 73728
    v_add_u32 v1, s23, v7
    v_lshlrev_b32 v7, 1, v7
    s_lshl_b32 s23, s22, 9
    s_add_u32 s23, s23, 74240
    v_add_u32 v7, s23, v7
    s_waitcnt vmcnt(2) lgkmcnt(0)
    s_barrier
    ds_read_b128 v[24:27], v164 offset:0
    ds_read_b128 v[32:35], v164 offset:512
    ds_read_b128 v[36:39], v164 offset:4096
    ds_read_b128 v[44:47], v164 offset:4608
    ds_read_b128 v[48:51], v164 offset:8192
    ds_read_b128 v[56:59], v164 offset:8704
    ds_read_b128 v[60:63], v164 offset:12288
    ds_read_b128 v[68:71], v164 offset:12800
    ds_read_b128 v[76:79], v164 offset:16384
    ds_read_b128 v[84:87], v164 offset:16896
    s_waitcnt lgkmcnt(8)
    v_mov_b64 v[30:31], v[24:25]
    v_mov_b64 v[28:29], v[34:35]
    ds_read_b128 v[88:91], v164 offset:20480
    ds_read_b128 v[96:99], v164 offset:20992
    v_mfma_f32_16x16x32_bf16 v[8:11], v[30:33], v[30:33], 0
    v_mfma_f32_16x16x32_bf16 v[12:15], v[26:29], v[26:29], 0
    s_waitcnt lgkmcnt(8)
    v_mov_b64 v[42:43], v[36:37]
    v_mov_b64 v[40:41], v[46:47]
    ds_read_b128 v[24:27], v164 offset:24576
    ds_read_b128 v[32:35], v164 offset:25088
    v_mfma_f32_16x16x32_bf16 v[8:11], v[42:45], v[42:45], v[8:11]
    v_mfma_f32_16x16x32_bf16 v[12:15], v[38:41], v[38:41], v[12:15]
    s_waitcnt lgkmcnt(8)
    v_mov_b64 v[54:55], v[48:49]
    v_mov_b64 v[52:53], v[58:59]
    ds_read_b128 v[36:39], v164 offset:28672
    ds_read_b128 v[44:47], v164 offset:29184
    v_mfma_f32_16x16x32_bf16 v[8:11], v[54:57], v[54:57], v[8:11]
    v_mfma_f32_16x16x32_bf16 v[12:15], v[50:53], v[50:53], v[12:15]
    s_waitcnt lgkmcnt(8)
    v_mov_b64 v[66:67], v[60:61]
    v_mov_b64 v[64:65], v[70:71]
    ds_read_b128 v[48:51], v164 offset:32768
    ds_read_b128 v[56:59], v164 offset:33280
    v_mfma_f32_16x16x32_bf16 v[8:11], v[66:69], v[66:69], v[8:11]
    v_mfma_f32_16x16x32_bf16 v[12:15], v[62:65], v[62:65], v[12:15]
    s_waitcnt lgkmcnt(8)
    v_mov_b64 v[82:83], v[76:77]
    v_mov_b64 v[80:81], v[86:87]
    ds_read_b128 v[60:63], v165 offset:0
    ds_read_b128 v[68:71], v165 offset:512
    v_mfma_f32_16x16x32_bf16 v[8:11], v[82:85], v[82:85], v[8:11]
    v_mfma_f32_16x16x32_bf16 v[12:15], v[78:81], v[78:81], v[12:15]
    s_waitcnt lgkmcnt(8)
    v_mov_b64 v[94:95], v[88:89]
    v_mov_b64 v[92:93], v[98:99]
    ds_read_b128 v[76:79], v165 offset:4096
    ds_read_b128 v[84:87], v165 offset:4608
    v_mfma_f32_16x16x32_bf16 v[8:11], v[94:97], v[94:97], v[8:11]
    v_mfma_f32_16x16x32_bf16 v[12:15], v[90:93], v[90:93], v[12:15]
    s_waitcnt lgkmcnt(8)
    v_mov_b64 v[30:31], v[24:25]
    v_mov_b64 v[28:29], v[34:35]
    ds_read_b128 v[88:91], v165 offset:8192
    ds_read_b128 v[96:99], v165 offset:8704
    v_mfma_f32_16x16x32_bf16 v[8:11], v[30:33], v[30:33], v[8:11]
    v_mfma_f32_16x16x32_bf16 v[12:15], v[26:29], v[26:29], v[12:15]
    s_waitcnt lgkmcnt(8)
    v_mov_b64 v[42:43], v[36:37]
    v_mov_b64 v[40:41], v[46:47]
    ds_read_b128 v[24:27], v165 offset:12288
    ds_read_b128 v[32:35], v165 offset:12800
    v_mfma_f32_16x16x32_bf16 v[8:11], v[42:45], v[42:45], v[8:11]
    v_mfma_f32_16x16x32_bf16 v[12:15], v[38:41], v[38:41], v[12:15]
    s_waitcnt lgkmcnt(8)
    v_mov_b64 v[54:55], v[48:49]
    v_mov_b64 v[52:53], v[58:59]
    v_and_b32 v57, v5, v57
    v_and_b32 v53, v5, v53
    ds_read_b128 v[36:39], v165 offset:16384
    ds_read_b128 v[44:47], v165 offset:16896
    v_mfma_f32_16x16x32_bf16 v[8:11], v[54:57], v[54:57], v[8:11]
    v_mfma_f32_16x16x32_bf16 v[12:15], v[50:53], v[50:53], v[12:15]
    s_waitcnt lgkmcnt(8)
    v_mov_b64 v[66:67], v[60:61]
    v_mov_b64 v[64:65], v[70:71]
    ds_read_b128 v[48:51], v165 offset:20480
    ds_read_b128 v[56:59], v165 offset:20992
    v_mfma_f32_16x16x32_bf16 v[8:11], v[66:69], v[66:69], v[8:11]
    v_mfma_f32_16x16x32_bf16 v[12:15], v[62:65], v[62:65], v[12:15]
    s_waitcnt lgkmcnt(8)
    v_mov_b64 v[82:83], v[76:77]
    v_mov_b64 v[80:81], v[86:87]
    ds_read_b128 v[60:63], v165 offset:24576
    ds_read_b128 v[68:71], v165 offset:25088
    v_mfma_f32_16x16x32_bf16 v[8:11], v[82:85], v[82:85], v[8:11]
    v_mfma_f32_16x16x32_bf16 v[12:15], v[78:81], v[78:81], v[12:15]
    s_waitcnt lgkmcnt(8)
    v_mov_b64 v[94:95], v[88:89]
    v_mov_b64 v[92:93], v[98:99]
    ds_read_b128 v[76:79], v165 offset:28672
    ds_read_b128 v[84:87], v165 offset:29184
    v_mfma_f32_16x16x32_bf16 v[8:11], v[94:97], v[94:97], v[8:11]
    v_mfma_f32_16x16x32_bf16 v[12:15], v[90:93], v[90:93], v[12:15]
    s_waitcnt lgkmcnt(8)
    v_mov_b64 v[30:31], v[24:25]
    v_mov_b64 v[28:29], v[34:35]
    ds_read_b128 v[88:91], v165 offset:32768
    ds_read_b128 v[96:99], v165 offset:33280
    v_mfma_f32_16x16x32_bf16 v[8:11], v[30:33], v[30:33], v[8:11]
    v_mfma_f32_16x16x32_bf16 v[12:15], v[26:29], v[26:29], v[12:15]
    s_waitcnt lgkmcnt(8)
    v_mov_b64 v[42:43], v[36:37]
    v_mov_b64 v[40:41], v[46:47]
    s_nop 0
    v_mfma_f32_16x16x32_bf16 v[8:11], v[42:45], v[42:45], v[8:11]
    v_mfma_f32_16x16x32_bf16 v[12:15], v[38:41], v[38:41], v[12:15]
    s_waitcnt lgkmcnt(6)
    v_mov_b64 v[54:55], v[48:49]
    v_mov_b64 v[52:53], v[58:59]
    s_nop 0
    v_mfma_f32_16x16x32_bf16 v[8:11], v[54:57], v[54:57], v[8:11]
    v_mfma_f32_16x16x32_bf16 v[12:15], v[50:53], v[50:53], v[12:15]
    s_waitcnt lgkmcnt(4)
    v_mov_b64 v[66:67], v[60:61]
    v_mov_b64 v[64:65], v[70:71]
    s_nop 0
    v_mfma_f32_16x16x32_bf16 v[8:11], v[66:69], v[66:69], v[8:11]
    v_mfma_f32_16x16x32_bf16 v[12:15], v[62:65], v[62:65], v[12:15]
    s_waitcnt lgkmcnt(2)
    v_mov_b64 v[82:83], v[76:77]
    v_mov_b64 v[80:81], v[86:87]
    s_nop 0
    v_mfma_f32_16x16x32_bf16 v[8:11], v[82:85], v[82:85], v[8:11]
    v_mfma_f32_16x16x32_bf16 v[12:15], v[78:81], v[78:81], v[12:15]
    s_waitcnt lgkmcnt(0)
    v_mov_b64 v[94:95], v[88:89]
    v_mov_b64 v[92:93], v[98:99]
    s_nop 0
    v_mfma_f32_16x16x32_bf16 v[8:11], v[94:97], v[94:97], v[8:11]
    v_mfma_f32_16x16x32_bf16 v[12:15], v[90:93], v[90:93], v[12:15]
    s_waitcnt vmcnt(0)
    v_mov_b32 v17, v18
    v_mov_b32 v18, v19
    v_mov_b32 v21, v22
    v_mov_b32 v22, v23
    s_nop 1
    v_cndmask_b32 v8, v8, v9, s[30:31]
    v_cndmask_b32 v12, v12, v13, s[30:31]
    v_cndmask_b32 v8, v8, v10, s[32:33]
    v_cndmask_b32 v12, v12, v14, s[32:33]
    v_cndmask_b32 v8, v8, v11, s[34:35]
    v_cndmask_b32 v12, v12, v15, s[34:35]
    v_mul_f32 v9, v17, v17
    v_mul_f32 v8, 0x3ae38e39, v8
    v_mul_f32 v13, v21, v21
    v_mul_f32 v12, 0x3ae38e39, v12
    v_mul_f32 v8, v8, v9
    v_mul_f32 v12, v12, v13
    v_add_f32 v9, 0x3727c5ac, v8
    v_add_f32 v13, 0x3727c5ac, v12
    v_rsq_f32 v9, v9
    v_rsq_f32 v13, v13
    v_mul_f32 v10, v9, v9
    v_mul_f32 v14, v13, v13
    v_mul_f32 v16, v17, v9
    v_mul_f32 v20, v21, v13
    v_fmaak_f32 v10, v10, v8, 0x3727c5ac
    v_fmaak_f32 v14, v14, v12, 0x3727c5ac
    v_rsq_f32 v10, v10
    v_rsq_f32 v14, v14
    v_mul_f32 v10, v10, v16
    v_mul_f32 v14, v14, v20
    s_mov_b32 exec_lo, 0x00f0000f
    s_mov_b32 exec_hi, 0xf0000f00
    ds_write_b32 v1, v10
    ds_write_b32 v1, v14 offset:4
    ds_write_b128 v7, v[16:19]
    ds_write_b128 v7, v[20:23] offset:16
    s_mov_b64 exec, 1
    v_mov_b32 v8, 1
    s_waitcnt lgkmcnt(0)
    ds_add_u32 v73, v8
    s_mov_b64 exec, -1
    s_branch Lw2_48
Lidle_47:
    s_waitcnt vmcnt(0) lgkmcnt(0)
    s_barrier
Lw2_48:
    s_setprio 0
    buffer_load_dwordx4 v[24:27], v3, s[12:15], s39 offen offset:0 sc1
    buffer_load_dwordx4 v[28:31], v3, s[12:15], s39 offen offset:1024 sc1
    buffer_load_dwordx4 v[32:35], v3, s[12:15], s39 offen offset:2048 sc1
    buffer_load_dwordx4 v[36:39], v3, s[12:15], s39 offen offset:3072 sc1
    s_add_u32 s39, s39, 4096
    buffer_load_dwordx4 v[40:43], v3, s[12:15], s39 offen offset:0 sc1
    buffer_load_dwordx4 v[44:47], v3, s[12:15], s39 offen offset:1024 sc1
    buffer_load_dwordx4 v[48:51], v3, s[12:15], s39 offen offset:2048 sc1
    buffer_load_dwordx4 v[52:55], v3, s[12:15], s39 offen offset:3072 sc1
    s_add_u32 s39, s39, 4096
    buffer_load_dwordx4 v[56:59], v3, s[12:15], s39 offen offset:0 sc1
K3_join:
    v_and_b32 v1, 15, v0
    v_lshrrev_b32 v2, 4, v0
    s_lshr_b32 s20, s3, 1
    s_mul_i32 s19, s20, 12
    s_and_b32 s21, s3, 1
    s_mul_i32 s21, s21, 36864
    s_add_u32 s22, s21, s18
    s_mov_b32 s10, 0x240000
    s_mov_b32 s11, 0x20000
    s_add_u32 s8, s12, 0xb40000
    s_addc_u32 s9, s13, 0
    v_add_u32 v5, s19, v2
    s_add_u32 s19, s19, 4
    v_mul_u32_u24 v6, 57, v5
    v_lshrrev_b32 v6, 10, v6
    v_lshrrev_b32 v7, 1, v6
    v_add_u32 v7, 1, v7
    v_and_b32 v6, 1, v6
    v_lshl_add_u32 v6, v6, 1, -1
    v_mad_i32_i24 v6, v6, v7, v1
    v_ashrrev_i32 v7, 4, v6
    v_mul_i32_i24 v7, 18432, v7
    v_and_b32 v6, 15, v6
    v_lshl_add_u32 v7, v6, 4, v7
    v_lshl_add_u32 v7, v5, 8, v7
    v_add_u32 v8, s22, v7
    v_add_u32 v5, s19, v2
    s_add_u32 s19, s19, 4
    v_mul_u32_u24 v6, 57, v5
    v_lshrrev_b32 v6, 10, v6
    v_lshrrev_b32 v7, 1, v6
    v_add_u32 v7, 1, v7
    v_and_b32 v6, 1, v6
    v_lshl_add_u32 v6, v6, 1, -1
    v_mad_i32_i24 v6, v6, v7, v1
    v_ashrrev_i32 v7, 4, v6
    v_mul_i32_i24 v7, 18432, v7
    v_and_b32 v6, 15, v6
    v_lshl_add_u32 v7, v6, 4, v7
    v_lshl_add_u32 v7, v5, 8, v7
    v_add_u32 v9, s22, v7
    v_add_u32 v5, s19, v2
    v_mul_u32_u24 v6, 57, v5
    v_lshrrev_b32 v6, 10, v6
    v_lshrrev_b32 v7, 1, v6
    v_add_u32 v7, 1, v7
    v_and_b32 v6, 1, v6
    v_lshl_add_u32 v6, v6, 1, -1
    v_mad_i32_i24 v6, v6, v7, v1
    v_ashrrev_i32 v7, 4, v6
    v_mul_i32_i24 v7, 18432, v7
    v_and_b32 v6, 15, v6
    v_lshl_add_u32 v7, v6, 4, v7
    v_lshl_add_u32 v7, v5, 8, v7
    v_add_u32 v10, s22, v7
    s_mul_i32 s20, s20, 3072
    s_add_u32 s20, s20, s21
    v_mov_b32 v11, v3
    s_mul_i32 s24, s36, 36864
    s_add_u32 s25, s24, s40
    v_add_u32 v3, s25, v11
    s_xor_b32 s25, s24, 36864
    s_add_u32 s25, s25, s40
    v_add_u32 v4, s25, v11
    s_lshl_b32 s21, s38, 9
    s_add_u32 s21, s21, s18
    s_add_u32 s21, s21, s24
    s_add_u32 s23, s21, 0xd80000
    s_add_u32 s27, s21, 0x480000
    v_bfe_u32 v6, v0, 4, 1
    v_mul_u32_u24 v5, 18432, v6
    v_lshrrev_b32 v6, 5, v0
    v_lshl_add_u32 v5, v6, 8, v5
    v_and_b32 v6, 15, v0
    v_lshl_add_u32 v5, v6, 4, v5
    v_and_b32 v7, 31, v0
    v_lshlrev_b32 v7, 4, v7
    s_lshl_b32 s25, s36, 9
    s_add_u32 s25, s25, 74240
    v_add_u32 v7, s25, v7
    s_lshl_b32 s25, s37, 11
    s_lshl_b32 s26, s36, 10
    s_add_u32 s25, s25, s26
    s_add_u32 s25, s25, 75264
    v_add_u32 v12, s25, v11
    s_lshl_b32 s28, s3, 11
    s_add_u32 s28, s28, 87552
    v_add_u32 v6, s28, v11
    s_cmp_ge_u32 s3, 6
    s_cselect_b32 s29, -6, 6
    s_add_i32 s29, s29, s3
    s_lshl_b32 s29, s29, 11
    s_add_u32 s29, s29, 87552
    v_add_u32 v13, s29, v11
    s_mov_b32 s31, 0xffff0000
    s_waitcnt lgkmcnt(0)
    s_barrier
    s_cmp_lg_u32 s3, 9
    s_cbranch_scc1 Lnp_49
    v_mul_u32_u24 v14, 43, v0
    v_lshrrev_b32 v14, 8, v14
    v_mul_u32_u24 v15, 6, v14
    v_sub_u32 v15, v0, v15
    s_sub_u32 s25, s16, 1
    v_add_u32 v14, s25, v14
    v_max_i32 v14, 0, v14
    v_min_i32 v14, 31, v14
    v_lshlrev_b32 v14, 7, v14
    v_lshl_add_u32 v14, v15, 4, v14
    s_mov_b32 s25, 0x2dd6000
    s_waitcnt vmcnt(0)
    s_mov_b64 exec, 0x3ffff
    s_mov_b32 s93, 0x1fffff
Lpoll_50:
    buffer_load_dword v15, v14, s[12:15], s25 offen sc1
    s_and_b32 s92, s93, 63
    s_cbranch_scc1 Lchk_52
    s_waitcnt vmcnt(0)
    v_mov_b32 v15, 0
    buffer_atomic_or v15, v14, s[12:15], s25 offen sc0 sc1
Lchk_52:
    s_waitcnt vmcnt(0)
    v_cmp_eq_u32 vcc, 0, v15
    s_nop 4
    s_cbranch_vccz Lgo_51
    s_mov_b64 exec, vcc
    s_sleep 3
    s_sub_u32 s93, s93, 1
    s_cbranch_scc0 Lpoll_50
Lgo_51:
    s_mov_b64 exec, -1
Lnp_49:
    s_barrier
    s_add_u32 m0, s20, 0
    s_nop 0
    buffer_load_dwordx4 v8, s[8:11], 0 offen sc1 lds
    v_add_u32 v8, 18432, v8
    s_add_u32 m0, s20, 1024
    s_nop 0
    buffer_load_dwordx4 v9, s[8:11], 0 offen sc1 lds
    v_add_u32 v9, 18432, v9
    s_add_u32 m0, s20, 2048
    s_nop 0
    buffer_load_dwordx4 v10, s[8:11], 0 offen sc1 lds
    v_add_u32 v10, 18432, v10
    s_add_u32 m0, s20, 18432
    s_nop 0
    buffer_load_dwordx4 v8, s[8:11], 0 offen sc1 lds
    s_add_u32 m0, s20, 19456
    s_nop 0
    buffer_load_dwordx4 v9, s[8:11], 0 offen sc1 lds
    s_add_u32 m0, s20, 20480
    s_nop 0
    buffer_load_dwordx4 v10, s[8:11], 0 offen sc1 lds
    ds_read_b128 v[16:19], v7
    ds_read_b128 v[20:23], v12
    s_waitcnt lgkmcnt(0)
    v_lshlrev_b32 v64, 16, v20
    v_and_b32 v65, s31, v20
    v_lshlrev_b32 v66, 16, v21
    v_and_b32 v67, s31, v21
    v_lshlrev_b32 v68, 16, v22
    v_and_b32 v69, s31, v22
    v_lshlrev_b32 v70, 16, v23
    v_and_b32 v71, s31, v23
    v_mul_f32 v72, v64, v16
    v_fma_f32 v64, v64, v17, v18
    v_mul_f32 v73, v65, v16
    v_fma_f32 v65, v65, v17, v18
    v_mul_f32 v74, v66, v16
    v_fma_f32 v66, v66, v17, v18
    v_mul_f32 v75, v67, v16
    v_fma_f32 v67, v67, v17, v18
    v_mul_f32 v76, v68, v16
    v_fma_f32 v68, v68, v17, v18
    v_mul_f32 v77, v69, v16
    v_fma_f32 v69, v69, v17, v18
    v_mul_f32 v78, v70, v16
    v_fma_f32 v70, v70, v17, v18
    v_mul_f32 v79, v71, v16
    v_fma_f32 v71, v71, v17, v18
    s_waitcnt vmcnt(0)
    s_barrier
    ds_read_b128 v[128:131], v3 offset:0
    ds_read_b128 v[132:135], v3 offset:18432
    ds_read_b128 v[136:139], v4 offset:0
    ds_read_b128 v[140:143], v4 offset:18432
    ds_read_b128 v[144:147], v3 offset:1024
    ds_read_b128 v[148:151], v3 offset:19456
    ds_read_b128 v[152:155], v4 offset:1024
    ds_read_b128 v[156:159], v4 offset:19456
    s_waitcnt lgkmcnt(7)
    v_mfma_f32_16x16x32_bf16 v[96:99], v[24:27], v[128:131], 0
    ds_read_b128 v[128:131], v3 offset:2048
    s_waitcnt lgkmcnt(7)
    v_mfma_f32_16x16x32_bf16 v[100:103], v[24:27], v[132:135], 0
    ds_read_b128 v[132:135], v3 offset:20480
    s_waitcnt lgkmcnt(7)
    v_mfma_f32_16x16x32_bf16 v[104:107], v[24:27], v[136:139], 0
    ds_read_b128 v[136:139], v4 offset:2048
    s_waitcnt lgkmcnt(7)
    v_mfma_f32_16x16x32_bf16 v[108:111], v[24:27], v[140:143], 0
    ds_read_b128 v[140:143], v4 offset:20480
    s_waitcnt lgkmcnt(7)
    v_mfma_f32_16x16x32_bf16 v[96:99], v[28:31], v[144:147], v[96:99]
    ds_read_b128 v[144:147], v3 offset:3072
    s_waitcnt lgkmcnt(7)
    v_mfma_f32_16x16x32_bf16 v[100:103], v[28:31], v[148:151], v[100:103]
    ds_read_b128 v[148:151], v3 offset:21504
    s_waitcnt lgkmcnt(7)
    v_mfma_f32_16x16x32_bf16 v[104:107], v[28:31], v[152:155], v[104:107]
    ds_read_b128 v[152:155], v4 offset:3072
    s_waitcnt lgkmcnt(7)
    v_mfma_f32_16x16x32_bf16 v[108:111], v[28:31], v[156:159], v[108:111]
    ds_read_b128 v[156:159], v4 offset:21504
    s_waitcnt lgkmcnt(7)
    v_mfma_f32_16x16x32_bf16 v[96:99], v[32:35], v[128:131], v[96:99]
    ds_read_b128 v[128:131], v3 offset:4096
    s_waitcnt lgkmcnt(7)
    v_mfma_f32_16x16x32_bf16 v[100:103], v[32:35], v[132:135], v[100:103]
    ds_read_b128 v[132:135], v3 offset:22528
    s_waitcnt lgkmcnt(7)
    v_mfma_f32_16x16x32_bf16 v[104:107], v[32:35], v[136:139], v[104:107]
    ds_read_b128 v[136:139], v4 offset:4096
    s_waitcnt lgkmcnt(7)
    v_mfma_f32_16x16x32_bf16 v[108:111], v[32:35], v[140:143], v[108:111]
    ds_read_b128 v[140:143], v4 offset:22528
    s_waitcnt lgkmcnt(7)
    v_mfma_f32_16x16x32_bf16 v[96:99], v[36:39], v[144:147], v[96:99]
    ds_read_b128 v[144:147], v3 offset:5120
    s_waitcnt lgkmcnt(7)
    v_mfma_f32_16x16x32_bf16 v[100:103], v[36:39], v[148:151], v[100:103]
    ds_read_b128 v[148:151], v3 offset:23552
    s_waitcnt lgkmcnt(7)
    v_mfma_f32_16x16x32_bf16 v[104:107], v[36:39], v[152:155], v[104:107]
    ds_read_b128 v[152:155], v4 offset:5120
    s_waitcnt lgkmcnt(7)
    v_mfma_f32_16x16x32_bf16 v[108:111], v[36:39], v[156:159], v[108:111]
    ds_read_b128 v[156:159], v4 offset:23552
    s_waitcnt lgkmcnt(7)
    v_mfma_f32_16x16x32_bf16 v[96:99], v[40:43], v[128:131], v[96:99]
    ds_read_b128 v[128:131], v3 offset:6144
    s_waitcnt lgkmcnt(7)
    v_mfma_f32_16x16x32_bf16 v[100:103], v[40:43], v[132:135], v[100:103]
    ds_read_b128 v[132:135], v3 offset:24576
    s_waitcnt lgkmcnt(7)
    v_mfma_f32_16x16x32_bf16 v[104:107], v[40:43], v[136:139], v[104:107]
    ds_read_b128 v[136:139], v4 offset:6144
    s_waitcnt lgkmcnt(7)
    v_mfma_f32_16x16x32_bf16 v[108:111], v[40:43], v[140:143], v[108:111]
    ds_read_b128 v[140:143], v4 offset:24576
    s_waitcnt lgkmcnt(7)
    v_mfma_f32_16x16x32_bf16 v[96:99], v[44:47], v[144:147], v[96:99]
    ds_read_b128 v[144:147], v3 offset:7168
    s_waitcnt lgkmcnt(7)
    v_mfma_f32_16x16x32_bf16 v[100:103], v[44:47], v[148:151], v[100:103]
    ds_read_b128 v[148:151], v3 offset:25600
    s_waitcnt lgkmcnt(7)
    v_mfma_f32_16x16x32_bf16 v[104:107], v[44:47], v[152:155], v[104:107]
    ds_read_b128 v[152:155], v4 offset:7168
    s_waitcnt lgkmcnt(7)
    v_mfma_f32_16x16x32_bf16 v[108:111], v[44:47], v[156:159], v[108:111]
    ds_read_b128 v[156:159], v4 offset:25600
    s_waitcnt lgkmcnt(7)
    v_mfma_f32_16x16x32_bf16 v[96:99], v[48:51], v[128:131], v[96:99]
    ds_read_b128 v[128:131], v3 offset:8192
    s_waitcnt lgkmcnt(7)
    v_mfma_f32_16x16x32_bf16 v[100:103], v[48:51], v[132:135], v[100:103]
    ds_read_b128 v[132:135], v3 offset:26624
    s_waitcnt lgkmcnt(7)
    v_mfma_f32_16x16x32_bf16 v[104:107], v[48:51], v[136:139], v[104:107]
    ds_read_b128 v[136:139], v4 offset:8192
    s_waitcnt lgkmcnt(7)
    v_mfma_f32_16x16x32_bf16 v[108:111], v[48:51], v[140:143], v[108:111]
    ds_read_b128 v[140:143], v4 offset:26624
    s_waitcnt lgkmcnt(7)
    v_mfma_f32_16x16x32_bf16 v[96:99], v[52:55], v[144:147], v[96:99]
    s_waitcnt lgkmcnt(6)
    v_mfma_f32_16x16x32_bf16 v[100:103], v[52:55], v[148:151], v[100:103]
    s_waitcnt lgkmcnt(5)
    v_mfma_f32_16x16x32_bf16 v[104:107], v[52:55], v[152:155], v[104:107]
    s_waitcnt lgkmcnt(4)
    v_mfma_f32_16x16x32_bf16 v[108:111], v[52:55], v[156:159], v[108:111]
    s_waitcnt lgkmcnt(3)
    v_mfma_f32_16x16x32_bf16 v[96:99], v[56:59], v[128:131], v[96:99]
    s_waitcnt lgkmcnt(2)
    v_mfma_f32_16x16x32_bf16 v[100:103], v[56:59], v[132:135], v[100:103]
    s_waitcnt lgkmcnt(1)
    v_mfma_f32_16x16x32_bf16 v[104:107], v[56:59], v[136:139], v[104:107]
    s_waitcnt lgkmcnt(0)
    v_mfma_f32_16x16x32_bf16 v[108:111], v[56:59], v[140:143], v[108:111]
    s_nop 5
    ds_write_b128 v6, v[104:107]
    s_nop 0
    ds_write_b128 v6, v[108:111] offset:1024
    s_waitcnt lgkmcnt(0)
    s_barrier
    ds_read_b128 v[80:83], v13
    ds_read_b128 v[84:87], v13 offset:1024
    s_waitcnt lgkmcnt(0)
    v_pk_add_f32 v[96:97], v[96:97], v[80:81]
    v_pk_add_f32 v[98:99], v[98:99], v[82:83]
    v_pk_add_f32 v[100:101], v[100:101], v[84:85]
    v_pk_add_f32 v[102:103], v[102:103], v[86:87]
    s_nop 0
    v_permlane16_swap_b32 v96, v100
    v_permlane16_swap_b32 v97, v101
    v_permlane16_swap_b32 v98, v102
    v_permlane16_swap_b32 v99, v103
    v_pk_add_f32 v[96:97], v[96:97], v[72:73]
    v_pk_add_f32 v[98:99], v[98:99], v[74:75]
    v_pk_add_f32 v[100:101], v[100:101], v[76:77]
    v_pk_add_f32 v[102:103], v[102:103], v[78:79]
    v_pk_add_f32 v[64:65], v[64:65], v[96:97]
    v_pk_add_f32 v[66:67], v[66:67], v[98:99]
    v_pk_add_f32 v[68:69], v[68:69], v[100:101]
    v_pk_add_f32 v[70:71], v[70:71], v[102:103]
    v_cvt_pk_bf16_f32 v16, v96, v97
    v_cvt_pk_bf16_f32 v17, v98, v99
    v_cvt_pk_bf16_f32 v18, v100, v101
    v_cvt_pk_bf16_f32 v19, v102, v103
    buffer_store_dwordx4 v[16:19], v5, s[12:15], s23 offen sc1
    v_cvt_pk_bf16_f32 v20, v64, v65
    v_cvt_pk_bf16_f32 v21, v66, v67
    v_cvt_pk_bf16_f32 v22, v68, v69
    v_cvt_pk_bf16_f32 v23, v70, v71
    buffer_store_dwordx4 v[20:23], v5, s[12:15], s27 offen sc1
    s_lshl_b32 s28, s16, 7
    s_lshl_b32 s29, s17, 4
    s_add_u32 s28, s28, s29
    s_add_u32 s28, s28, 0x2dd7000
    s_mov_b64 s[30:31], 1
    s_branch K3_publish
K3_side:
    s_cmp_ge_u32 s2, 256
    s_cbranch_scc1 K3_exit
    s_sub_u32 s25, s2, 192
    s_sub_u32 s24, s2, 200
    s_cmp_ge_u32 s2, 248
    s_cselect_b32 s25, s24, s25
    s_add_u32 s24, s25, 8
    s_bfe_u32 s26, s2, 0x50003
    s_cmp_eq_u32 s26, 30
    s_cselect_b32 s25, s24, s25
    s_mul_i32 s24, s25, 11
    s_add_u32 s24, s24, s3
    s_cmp_ge_u32 s3, 11
    s_cselect_b32 s24, 648, s24
    s_load_dwordx2 s[16:17], s[0:1], 48
    s_mov_b32 s18, 0x510000
    s_mov_b32 s19, 0x20000
    s_load_dwordx2 s[20:21], s[0:1], 56
    s_mov_b32 s22, 0x510000
    s_mov_b32 s23, 0x20000
    s_lshl_b32 s44, s3, 13
    s_lshl_b32 s28, s25, 5
    s_add_u32 s28, s28, 0x2dee000
    s_waitcnt lgkmcnt(0)
    s_cmp_ge_u32 s24, 648
    s_cbranch_scc1 Lsk_53
    s_add_u32 s45, s24, 0
    s_mul_i32 s48, s45, 7282
    s_lshr_b32 s48, s48, 16
    s_mul_i32 s49, s48, 9
    s_sub_u32 s49, s45, s49
    s_mul_i32 s50, s48, 7282
    s_lshr_b32 s50, s50, 16
    s_mul_i32 s51, s50, 9
    s_sub_u32 s51, s48, s51
    v_lshrrev_b32 v3, 3, v0
    v_and_b32 v4, 2, v3
    v_and_b32 v1, 7, v0
    v_xor_b32 v1, v1, v4
    v_lshlrev_b32 v1, 4, v1
    v_mul_u32_u24 v3, 9216, v3
    v_xor_b32 v2, 64, v1
    v_add_u32 v1, v1, v3
    v_add_u32 v2, v2, v3
    s_mov_b32 s41, s44
    s_mul_i32 s40, s49, 589824
    s_lshl_b32 s45, s48, 7
    s_add_u32 s40, s40, s45
    s_mov_b32 m0, s41
    s_nop 0
    buffer_load_dwordx4 v1, s[16:19], s40 offen nt lds
    s_add_u32 s41, s41, 1024
    s_add_u32 s40, s40, 73728
    s_mov_b32 m0, s41
    s_nop 0
    buffer_load_dwordx4 v2, s[16:19], s40 offen nt lds
    s_add_u32 s41, s41, 1024
    s_add_u32 s40, s40, 73728
    s_mov_b32 m0, s41
    s_nop 0
    buffer_load_dwordx4 v1, s[16:19], s40 offen nt lds
    s_add_u32 s41, s41, 1024
    s_add_u32 s40, s40, 73728
    s_mov_b32 m0, s41
    s_nop 0
    buffer_load_dwordx4 v2, s[16:19], s40 offen nt lds
    s_add_u32 s41, s41, 1024
    s_add_u32 s40, s40, 73728
    s_mov_b32 m0, s41
    s_nop 0
    buffer_load_dwordx4 v1, s[16:19], s40 offen nt lds
    s_add_u32 s41, s41, 1024
    s_add_u32 s40, s40, 73728
    s_mov_b32 m0, s41
    s_nop 0
    buffer_load_dwordx4 v2, s[16:19], s40 offen nt lds
    s_add_u32 s41, s41, 1024
    s_add_u32 s40, s40, 73728
    s_mov_b32 m0, s41
    s_nop 0
    buffer_load_dwordx4 v1, s[16:19], s40 offen nt lds
    s_add_u32 s41, s41, 1024
    s_add_u32 s40, s40, 73728
    s_mov_b32 m0, s41
    s_nop 0
    buffer_load_dwordx4 v2, s[16:19], s40 offen nt lds
    s_add_u32 s41, s41, 1024
    s_add_u32 s40, s40, 73728
    v_lshrrev_b32 v1, 4, v0
    v_bfe_u32 v2, v0, 2, 2
    v_lshl_add_u32 v3, v1, 3, v2
    v_lshlrev_b32 v3, 7, v3
    v_and_b32 v1, 1, v1
    v_lshlrev_b32 v1, 1, v1
    v_lshrrev_b32 v2, 1, v2
    v_or_b32 v1, v1, v2
    v_lshl_add_u32 v3, v1, 5, v3
    v_and_b32 v2, 3, v0
    v_lshl_add_u32 v3, v2, 3, v3
    v_xor_b32 v4, 32, v3
    v_xor_b32 v5, 64, v3
    v_xor_b32 v6, 96, v3
    v_add_u32 v3, s44, v3
    v_add_u32 v4, s44, v4
    v_add_u32 v5, s44, v5
    v_add_u32 v6, s44, v6
    v_lshlrev_b32 v1, 4, v0
    s_waitcnt vmcnt(0)
    ds_read_b64_tr_b16 v[16:17], v3 offset:0
    ds_read_b64_tr_b16 v[18:19], v3 offset:512
    ds_read_b64_tr_b16 v[20:21], v3 offset:4096
    ds_read_b64_tr_b16 v[22:23], v3 offset:4608
    ds_read_b64_tr_b16 v[24:25], v4 offset:0
    ds_read_b64_tr_b16 v[26:27], v4 offset:512
    ds_read_b64_tr_b16 v[28:29], v4 offset:4096
    ds_read_b64_tr_b16 v[30:31], v4 offset:4608
    ds_read_b64_tr_b16 v[32:33], v5 offset:0
    ds_read_b64_tr_b16 v[34:35], v5 offset:512
    ds_read_b64_tr_b16 v[36:37], v5 offset:4096
    ds_read_b64_tr_b16 v[38:39], v5 offset:4608
    ds_read_b64_tr_b16 v[40:41], v6 offset:0
    ds_read_b64_tr_b16 v[42:43], v6 offset:512
    ds_read_b64_tr_b16 v[44:45], v6 offset:4096
    ds_read_b64_tr_b16 v[46:47], v6 offset:4608
    s_lshl_b32 s45, s51, 2
    s_mul_i32 s46, s50, 1296
    s_add_u32 s45, s45, s46
    s_mul_i32 s46, s49, 72
    s_add_u32 s45, s45, s46
    s_lshl_b32 s45, s45, 10
    s_add_u32 s42, s45, 0x11a6000
    s_waitcnt lgkmcnt(12)
    buffer_store_dwordx4 v[16:19], v1, s[12:15], s42 offen sc1
    s_add_u32 s43, s42, 36864
    buffer_store_dwordx4 v[20:23], v1, s[12:15], s43 offen sc1
    s_lshl_b32 s45, s51, 2
    s_mul_i32 s46, s50, 1296
    s_add_u32 s45, s45, s46
    s_mul_i32 s46, s49, 72
    s_add_u32 s45, s45, s46
    s_lshl_b32 s45, s45, 10
    s_add_u32 s42, s45, 0x11a6400
    s_waitcnt lgkmcnt(8)
    buffer_store_dwordx4 v[24:27], v1, s[12:15], s42 offen sc1
    s_add_u32 s43, s42, 36864
    buffer_store_dwordx4 v[28:31], v1, s[12:15], s43 offen sc1
    s_lshl_b32 s45, s51, 2
    s_mul_i32 s46, s50, 1296
    s_add_u32 s45, s45, s46
    s_mul_i32 s46, s49, 72
    s_add_u32 s45, s45, s46
    s_lshl_b32 s45, s45, 10
    s_add_u32 s42, s45, 0x11a6800
    s_waitcnt lgkmcnt(4)
    buffer_store_dwordx4 v[32:35], v1, s[12:15], s42 offen sc1
    s_add_u32 s43, s42, 36864
    buffer_store_dwordx4 v[36:39], v1, s[12:15], s43 offen sc1
    s_lshl_b32 s45, s51, 2
    s_mul_i32 s46, s50, 1296
    s_add_u32 s45, s45, s46
    s_mul_i32 s46, s49, 72
    s_add_u32 s45, s45, s46
    s_lshl_b32 s45, s45, 10
    s_add_u32 s42, s45, 0x11a6c00
    s_waitcnt lgkmcnt(0)
    buffer_store_dwordx4 v[40:43], v1, s[12:15], s42 offen sc1
    s_add_u32 s43, s42, 36864
    buffer_store_dwordx4 v[44:47], v1, s[12:15], s43 offen sc1
    s_nop 1
Lsk_53:
    s_cmp_ge_u32 s24, 648
    s_cbranch_scc1 Lsk_54
    s_add_u32 s45, s24, 0
    s_mul_i32 s48, s45, 7282
    s_lshr_b32 s48, s48, 16
    s_mul_i32 s49, s48, 9
    s_sub_u32 s49, s45, s49
    s_mul_i32 s50, s48, 7282
    s_lshr_b32 s50, s50, 16
    s_mul_i32 s51, s50, 9
    s_sub_u32 s51, s48, s51
    v_lshrrev_b32 v3, 3, v0
    v_and_b32 v4, 2, v3
    v_and_b32 v1, 7, v0
    v_xor_b32 v1, v1, v4
    v_lshlrev_b32 v1, 4, v1
    v_mul_u32_u24 v3, 1152, v3
    v_xor_b32 v2, 64, v1
    v_add_u32 v1, v1, v3
    v_add_u32 v2, v2, v3
    s_mov_b32 s41, s44
    s_mul_i32 s40, s48, 73728
    s_lshl_b32 s45, s49, 7
    s_add_u32 s40, s40, s45
    s_mov_b32 m0, s41
    s_nop 0
    buffer_load_dwordx4 v1, s[20:23], s40 offen nt lds
    s_add_u32 s41, s41, 1024
    s_add_u32 s40, s40, 9216
    s_mov_b32 m0, s41
    s_nop 0
    buffer_load_dwordx4 v2, s[20:23], s40 offen nt lds
    s_add_u32 s41, s41, 1024
    s_add_u32 s40, s40, 9216
    s_mov_b32 m0, s41
    s_nop 0
    buffer_load_dwordx4 v1, s[20:23], s40 offen nt lds
    s_add_u32 s41, s41, 1024
    s_add_u32 s40, s40, 9216
    s_mov_b32 m0, s41
    s_nop 0
    buffer_load_dwordx4 v2, s[20:23], s40 offen nt lds
    s_add_u32 s41, s41, 1024
    s_add_u32 s40, s40, 9216
    s_mov_b32 m0, s41
    s_nop 0
    buffer_load_dwordx4 v1, s[20:23], s40 offen nt lds
    s_add_u32 s41, s41, 1024
    s_add_u32 s40, s40, 9216
    s_mov_b32 m0, s41
    s_nop 0
    buffer_load_dwordx4 v2, s[20:23], s40 offen nt lds
    s_add_u32 s41, s41, 1024
    s_add_u32 s40, s40, 9216
    s_mov_b32 m0, s41
    s_nop 0
    buffer_load_dwordx4 v1, s[20:23], s40 offen nt lds
    s_add_u32 s41, s41, 1024
    s_add_u32 s40, s40, 9216
    s_mov_b32 m0, s41
    s_nop 0
    buffer_load_dwordx4 v2, s[20:23], s40 offen nt lds
    s_add_u32 s41, s41, 1024
    s_add_u32 s40, s40, 9216
    v_lshrrev_b32 v1, 4, v0
    v_bfe_u32 v2, v0, 2, 2
    v_lshl_add_u32 v3, v1, 3, v2
    v_lshlrev_b32 v3, 7, v3
    v_and_b32 v1, 1, v1
    v_lshlrev_b32 v1, 1, v1
    v_lshrrev_b32 v2, 1, v2
    v_or_b32 v1, v1, v2
    v_lshl_add_u32 v3, v1, 5, v3
    v_and_b32 v2, 3, v0
    v_lshl_add_u32 v3, v2, 3, v3
    v_xor_b32 v4, 32, v3
    v_xor_b32 v5, 64, v3
    v_xor_b32 v6, 96, v3
    v_add_u32 v3, s44, v3
    v_add_u32 v4, s44, v4
    v_add_u32 v5, s44, v5
    v_add_u32 v6, s44, v6
    v_lshlrev_b32 v1, 4, v0
    s_waitcnt vmcnt(0)
    ds_read_b64_tr_b16 v[48:49], v3 offset:0
    ds_read_b64_tr_b16 v[50:51], v3 offset:512
    ds_read_b64_tr_b16 v[52:53], v3 offset:4096
    ds_read_b64_tr_b16 v[54:55], v3 offset:4608
    ds_read_b64_tr_b16 v[56:57], v4 offset:0
    ds_read_b64_tr_b16 v[58:59], v4 offset:512
    ds_read_b64_tr_b16 v[60:61], v4 offset:4096
    ds_read_b64_tr_b16 v[62:63], v4 offset:4608
    ds_read_b64_tr_b16 v[64:65], v5 offset:0
    ds_read_b64_tr_b16 v[66:67], v5 offset:512
    ds_read_b64_tr_b16 v[68:69], v5 offset:4096
    ds_read_b64_tr_b16 v[70:71], v5 offset:4608
    ds_read_b64_tr_b16 v[72:73], v6 offset:0
    ds_read_b64_tr_b16 v[74:75], v6 offset:512
    ds_read_b64_tr_b16 v[76:77], v6 offset:4096
    ds_read_b64_tr_b16 v[78:79], v6 offset:4608
    s_lshl_b32 s45, s49, 2
    s_mul_i32 s46, s50, 1296
    s_add_u32 s45, s45, s46
    s_mul_i32 s46, s51, 72
    s_add_u32 s45, s45, s46
    s_lshl_b32 s45, s45, 10
    s_add_u32 s42, s45, 0x1248000
    s_waitcnt lgkmcnt(12)
    buffer_store_dwordx4 v[48:51], v1, s[12:15], s42 offen sc1
    s_add_u32 s43, s42, 36864
    buffer_store_dwordx4 v[52:55], v1, s[12:15], s43 offen sc1
    s_lshl_b32 s45, s49, 2
    s_mul_i32 s46, s50, 1296
    s_add_u32 s45, s45, s46
    s_mul_i32 s46, s51, 72
    s_add_u32 s45, s45, s46
    s_lshl_b32 s45, s45, 10
    s_add_u32 s42, s45, 0x1248400
    s_waitcnt lgkmcnt(8)
    buffer_store_dwordx4 v[56:59], v1, s[12:15], s42 offen sc1
    s_add_u32 s43, s42, 36864
    buffer_store_dwordx4 v[60:63], v1, s[12:15], s43 offen sc1
    s_lshl_b32 s45, s49, 2
    s_mul_i32 s46, s50, 1296
    s_add_u32 s45, s45, s46
    s_mul_i32 s46, s51, 72
    s_add_u32 s45, s45, s46
    s_lshl_b32 s45, s45, 10
    s_add_u32 s42, s45, 0x1248800
    s_waitcnt lgkmcnt(4)
    buffer_store_dwordx4 v[64:67], v1, s[12:15], s42 offen sc1
    s_add_u32 s43, s42, 36864
    buffer_store_dwordx4 v[68:71], v1, s[12:15], s43 offen sc1
    s_lshl_b32 s45, s49, 2
    s_mul_i32 s46, s50, 1296
    s_add_u32 s45, s45, s46
    s_mul_i32 s46, s51, 72
    s_add_u32 s45, s45, s46
    s_lshl_b32 s45, s45, 10
    s_add_u32 s42, s45, 0x1248c00
    s_waitcnt lgkmcnt(0)
    buffer_store_dwordx4 v[72:75], v1, s[12:15], s42 offen sc1
    s_add_u32 s43, s42, 36864
    buffer_store_dwordx4 v[76:79], v1, s[12:15], s43 offen sc1
    s_nop 1
Lsk_54:
    s_mov_b64 s[30:31], 0xff
K3_publish:
    s_waitcnt vmcnt(0)
    s_barrier
    s_cmp_lg_u32 s3, 0
    s_cbranch_scc1 Lp_55
    v_mov_b32 v8, 1
    v_mul_u32_u24 v9, 32768, v0
    s_mov_b64 exec, s[30:31]
    buffer_store_dword v8, v9, s[12:15], s28 offen sc1
    s_mov_b64 exec, -1
Lp_55:
    v_mbcnt_lo_u32_b32 v0, -1, 0
    v_mbcnt_hi_u32_b32 v0, -1, v0
    s_load_dwordx2 s[8:9], s[0:1], 64
    s_mov_b32 s10, 0x240000
    s_mov_b32 s11, 0x20000
    s_and_b32 s16, s2, 1
    s_lshl_b32 s16, s16, 4
    s_bfe_u32 s17, s2, 0x40003
    s_add_u32 s16, s16, s17
    s_bfe_u32 s17, s2, 0x20001
    s_lshl_b32 s17, s17, 1
    s_lshr_b32 s18, s2, 7
    s_add_u32 s17, s17, s18
    s_mul_i32 s18, s16, 73728
    v_lshlrev_b32 v3, 4, v0
    v_add_u32 v4, 36864, v3
    s_mul_i32 s19, s3, 6144
    s_add_u32 s20, s19, s18
    s_add_u32 s20, s20, 0xd80000
    s_add_u32 s21, s20, 4096
    s_mul_i32 s27, s17, 1327104
    s_add_u32 s27, s27, 0x11a6000
    s_mul_i32 s23, s3, 3072
    s_add_u32 s22, s27, s23
    s_cmp_lg_u32 s3, 0
    s_cbranch_scc1 Lnp_56
    s_mul_i32 s32, s17, 81
    s_add_u32 s33, s32, 80
    s_mul_i32 s32, s32, 5958
    s_lshr_b32 s32, s32, 16
    s_mul_i32 s33, s33, 5958
    s_lshr_b32 s33, s33, 16
    s_and_b32 s34, s2, 7
    s_mul_i32 s34, s34, 32768
    s_add_u32 s34, s34, 0x18000
    v_and_b32 v8, 15, v0
    v_add_u32 v9, s32, v8
    v_min_u32 v9, s33, v9
    v_lshlrev_b32 v9, 5, v9
    v_add_u32 v9, s34, v9
    v_min_u32 v8, 5, v8
    v_lshlrev_b32 v8, 4, v8
    s_lshl_b32 s32, s16, 7
    s_add_u32 s32, s32, 4096
    v_add_u32 v8, s32, v8
    v_cmp_gt_u32 vcc, 16, v0
    s_nop 1
    v_cndmask_b32 v8, v9, v8, vcc
    s_mov_b32 s32, 0x2dd6000
    s_mov_b32 exec_hi, 0
    s_mov_b32 s93, 0x1fffff
Lpoll_59:
    buffer_load_dword v9, v8, s[12:15], s32 offen sc1
    s_and_b32 s92, s93, 63
    s_cbranch_scc1 Lchk_61
    s_waitcnt vmcnt(0)
    v_mov_b32 v9, 0
    buffer_atomic_or v9, v8, s[12:15], s32 offen sc0 sc1
Lchk_61:
    s_waitcnt vmcnt(0)
    v_cmp_eq_u32 vcc, 0, v9
    s_nop 4
    s_cbranch_vccz Lgo_60
    s_mov_b64 exec, vcc
    s_sleep 8
    s_sub_u32 s93, s93, 1
    s_cbranch_scc0 Lpoll_59
Lgo_60:
    s_mov_b64 exec, -1
Lnp_56:
    s_barrier
    buffer_load_dwordx4 v[56:59], v3, s[12:15], s20 offen offset:0 sc1
    buffer_load_dwordx4 v[60:63], v3, s[12:15], s20 offen offset:1024 sc1
    buffer_load_dwordx4 v[64:67], v3, s[12:15], s20 offen offset:2048 sc1
    buffer_load_dwordx4 v[68:71], v3, s[12:15], s20 offen offset:3072 sc1
    buffer_load_dwordx4 v[72:75], v3, s[12:15], s21 offen offset:0 sc1
    buffer_load_dwordx4 v[76:79], v3, s[12:15], s21 offen offset:1024 sc1
    s_barrier
    buffer_load_dwordx4 v[88:91], v3, s[12:15], s22 offen offset:0 sc1
    buffer_load_dwordx4 v[92:95], v3, s[12:15], s22 offen offset:1024 sc1
    buffer_load_dwordx4 v[96:99], v3, s[12:15], s22 offen offset:2048 sc1
    s_add_u32 s22, s22, 36864
    s_mov_b32 s30, 0x3f803f80
    s_mov_b32 s31, 0xffff0000
    v_mov_b32 v8, 0
    v_mov_b32 v9, 0
    v_mov_b32 v10, 0
    v_mov_b32 v11, 0
    v_mov_b32 v7, 150528
    ds_write_b32 v7, v8
    ds_write_b32 v7, v8 offset:4
    ds_write_b32 v7, v8 offset:8
    ds_write_b32 v7, v8 offset:12
    ds_write_b32 v7, v8 offset:16
    ds_write_b32 v7, v8 offset:20
    ds_write_b32 v7, v8 offset:24
    ds_write_b32 v7, v8 offset:28
    v_mov_b32 v164, s30
    v_mov_b32 v165, s30
    v_mov_b32 v166, s30
    v_mov_b32 v167, s30
    v_and_b32 v2, 3, v0
    v_cmp_eq_u32 s[36:37], 1, v2
    v_cmp_eq_u32 s[38:39], 2, v2
    v_cmp_eq_u32 s[40:41], 3, v2
    v_and_b32 v5, 15, v0
    v_lshlrev_b32 v5, 3, v5
    s_lshl_b32 s23, s3, 7
    s_add_u32 s23, s23, 147456
    v_add_u32 v6, s23, v5
    s_mul_i32 s23, s3, 43
    s_lshr_b32 s23, s23, 7
    s_mul_i32 s23, s23, 384
    s_add_u32 s23, s23, 147456
    v_add_u32 v5, s23, v5
    s_waitcnt vmcnt(3)
    s_setprio 1
    v_mfma_f32_16x16x32_bf16 v[8:11], v[164:167], v[56:59], 0
    v_mfma_f32_16x16x32_bf16 v[12:15], v[56:59], v[56:59], 0
    v_mfma_f32_16x16x32_bf16 v[8:11], v[164:167], v[60:63], v[8:11]
    v_mfma_f32_16x16x32_bf16 v[12:15], v[60:63], v[60:63], v[12:15]
    v_mfma_f32_16x16x32_bf16 v[8:11], v[164:167], v[64:67], v[8:11]
    v_mfma_f32_16x16x32_bf16 v[12:15], v[64:67], v[64:67], v[12:15]
    v_mfma_f32_16x16x32_bf16 v[8:11], v[164:167], v[68:71], v[8:11]
    v_mfma_f32_16x16x32_bf16 v[12:15], v[68:71], v[68:71], v[12:15]
    v_mfma_f32_16x16x32_bf16 v[8:11], v[164:167], v[72:75], v[8:11]
    v_mfma_f32_16x16x32_bf16 v[12:15], v[72:75], v[72:75], v[12:15]
    v_mfma_f32_16x16x32_bf16 v[8:11], v[164:167], v[76:79], v[8:11]
    v_mfma_f32_16x16x32_bf16 v[12:15], v[76:79], v[76:79], v[12:15]
    v_lshlrev_b32 v16, 16, v56
    v_and_b32 v17, s31, v56
    v_lshlrev_b32 v18, 16, v57
    v_and_b32 v19, s31, v57
    v_lshlrev_b32 v20, 16, v58
    v_and_b32 v21, s31, v58
    v_lshlrev_b32 v22, 16, v59
    v_and_b32 v23, s31, v59
    v_lshlrev_b32 v24, 16, v60
    v_and_b32 v25, s31, v60
    v_lshlrev_b32 v26, 16, v61
    v_and_b32 v27, s31, v61
    v_lshlrev_b32 v28, 16, v62
    v_and_b32 v29, s31, v62
    v_lshlrev_b32 v30, 16, v63
    v_and_b32 v31, s31, v63
    v_cndmask_b32 v12, v12, v13, s[36:37]
    v_cndmask_b32 v12, v12, v14, s[38:39]
    v_cndmask_b32 v12, v12, v15, s[40:41]
    s_mov_b32 exec_lo, 0x00f0000f
    s_mov_b32 exec_hi, 0xf0000f00
    ds_write2_b32 v6, v8, v12 offset0:0 offset1:1
    s_mov_b64 exec, -1
    v_lshlrev_b32 v32, 16, v64
    v_and_b32 v33, s31, v64
    v_lshlrev_b32 v34, 16, v65
    v_and_b32 v35, s31, v65
    v_lshlrev_b32 v36, 16, v66
    v_and_b32 v37, s31, v66
    v_lshlrev_b32 v38, 16, v67
    v_and_b32 v39, s31, v67
    v_lshlrev_b32 v40, 16, v68
    v_and_b32 v41, s31, v68
    v_lshlrev_b32 v42, 16, v69
    v_and_b32 v43, s31, v69
    v_lshlrev_b32 v44, 16, v70
    v_and_b32 v45, s31, v70
    v_lshlrev_b32 v46, 16, v71
    v_and_b32 v47, s31, v71
    v_lshlrev_b32 v48, 16, v72
    v_and_b32 v49, s31, v72
    v_lshlrev_b32 v50, 16, v73
    v_and_b32 v51, s31, v73
    v_lshlrev_b32 v52, 16, v74
    v_and_b32 v53, s31, v74
    v_lshlrev_b32 v54, 16, v75
    v_and_b32 v55, s31, v75
    s_waitcnt lgkmcnt(0)
    s_barrier
    ds_read_b64 v[8:9], v5
    ds_read_b64 v[10:11], v5 offset:128
    ds_read_b64 v[12:13], v5 offset:256
    buffer_load_dwordx4 v[100:103], v3, s[12:15], s22 offen offset:0 sc1
    buffer_load_dwordx4 v[104:107], v3, s[12:15], s22 offen offset:1024 sc1
    buffer_load_dwordx4 v[108:111], v3, s[12:15], s22 offen offset:2048 sc1
    s_add_u32 s22, s22, 36864
    s_waitcnt lgkmcnt(0)
    v_pk_add_f32 v[8:9], v[8:9], v[10:11]
    v_pk_add_f32 v[8:9], v[8:9], v[12:13]
    v_mul_f32 v8, 0x3ae38e39, v8
    v_mul_f32 v10, v8, v8
    v_mov_b32 v11, 0x3ae38e39
    v_fma_f32 v9, v9, v11, -v10
    v_max_f32 v9, 0, v9
    v_add_f32 v9, 0x3727c5ac, v9
    v_rsq_f32 v9, v9
    s_nop 0
    v_mul_f32 v8, v8, v9
    v_add_u32 v6, s19, v3
    v_pk_fma_f32 v[16:17], v[16:17], v[8:9], v[8:9] op_sel:[0,1,0] op_sel_hi:[1,1,0] neg_lo:[0,0,1] neg_hi:[0,0,1]
    v_pk_fma_f32 v[18:19], v[18:19], v[8:9], v[8:9] op_sel:[0,1,0] op_sel_hi:[1,1,0] neg_lo:[0,0,1] neg_hi:[0,0,1]
    v_pk_fma_f32 v[20:21], v[20:21], v[8:9], v[8:9] op_sel:[0,1,0] op_sel_hi:[1,1,0] neg_lo:[0,0,1] neg_hi:[0,0,1]
    v_pk_fma_f32 v[22:23], v[22:23], v[8:9], v[8:9] op_sel:[0,1,0] op_sel_hi:[1,1,0] neg_lo:[0,0,1] neg_hi:[0,0,1]
    v_cvt_pk_bf16_f32 v56, v16, v17
    v_cvt_pk_bf16_f32 v57, v18, v19
    v_cvt_pk_bf16_f32 v58, v20, v21
    v_cvt_pk_bf16_f32 v59, v22, v23
    ds_write_b128 v6, v[56:59] offset:0
    v_pk_fma_f32 v[24:25], v[24:25], v[8:9], v[8:9] op_sel:[0,1,0] op_sel_hi:[1,1,0] neg_lo:[0,0,1] neg_hi:[0,0,1]
    v_pk_fma_f32 v[26:27], v[26:27], v[8:9], v[8:9] op_sel:[0,1,0] op_sel_hi:[1,1,0] neg_lo:[0,0,1] neg_hi:[0,0,1]
    v_pk_fma_f32 v[28:29], v[28:29], v[8:9], v[8:9] op_sel:[0,1,0] op_sel_hi:[1,1,0] neg_lo:[0,0,1] neg_hi:[0,0,1]
    v_pk_fma_f32 v[30:31], v[30:31], v[8:9], v[8:9] op_sel:[0,1,0] op_sel_hi:[1,1,0] neg_lo:[0,0,1] neg_hi:[0,0,1]
    v_cvt_pk_bf16_f32 v60, v24, v25
    v_cvt_pk_bf16_f32 v61, v26, v27
    v_cvt_pk_bf16_f32 v62, v28, v29
    v_cvt_pk_bf16_f32 v63, v30, v31
    ds_write_b128 v6, v[60:63] offset:1024
    v_pk_fma_f32 v[32:33], v[32:33], v[8:9], v[8:9] op_sel:[0,1,0] op_sel_hi:[1,1,0] neg_lo:[0,0,1] neg_hi:[0,0,1]
    v_pk_fma_f32 v[34:35], v[34:35], v[8:9], v[8:9] op_sel:[0,1,0] op_sel_hi:[1,1,0] neg_lo:[0,0,1] neg_hi:[0,0,1]
    v_pk_fma_f32 v[36:37], v[36:37], v[8:9], v[8:9] op_sel:[0,1,0] op_sel_hi:[1,1,0] neg_lo:[0,0,1] neg_hi:[0,0,1]
    v_pk_fma_f32 v[38:39], v[38:39], v[8:9], v[8:9] op_sel:[0,1,0] op_sel_hi:[1,1,0] neg_lo:[0,0,1] neg_hi:[0,0,1]
    v_cvt_pk_bf16_f32 v64, v32, v33
    v_cvt_pk_bf16_f32 v65, v34, v35
    v_cvt_pk_bf16_f32 v66, v36, v37
    v_cvt_pk_bf16_f32 v67, v38, v39
    ds_write_b128 v6, v[64:67] offset:2048
    v_pk_fma_f32 v[40:41], v[40:41], v[8:9], v[8:9] op_sel:[0,1,0] op_sel_hi:[1,1,0] neg_lo:[0,0,1] neg_hi:[0,0,1]
    v_pk_fma_f32 v[42:43], v[42:43], v[8:9], v[8:9] op_sel:[0,1,0] op_sel_hi:[1,1,0] neg_lo:[0,0,1] neg_hi:[0,0,1]
    v_pk_fma_f32 v[44:45], v[44:45], v[8:9], v[8:9] op_sel:[0,1,0] op_sel_hi:[1,1,0] neg_lo:[0,0,1] neg_hi:[0,0,1]
    v_pk_fma_f32 v[46:47], v[46:47], v[8:9], v[8:9] op_sel:[0,1,0] op_sel_hi:[1,1,0] neg_lo:[0,0,1] neg_hi:[0,0,1]
    v_cvt_pk_bf16_f32 v68, v40, v41
    v_cvt_pk_bf16_f32 v69, v42, v43
    v_cvt_pk_bf16_f32 v70, v44, v45
    v_cvt_pk_bf16_f32 v71, v46, v47
    ds_write_b128 v6, v[68:71] offset:3072
    v_pk_fma_f32 v[48:49], v[48:49], v[8:9], v[8:9] op_sel:[0,1,0] op_sel_hi:[1,1,0] neg_lo:[0,0,1] neg_hi:[0,0,1]
    v_pk_fma_f32 v[50:51], v[50:51], v[8:9], v[8:9] op_sel:[0,1,0] op_sel_hi:[1,1,0] neg_lo:[0,0,1] neg_hi:[0,0,1]
    v_pk_fma_f32 v[52:53], v[52:53], v[8:9], v[8:9] op_sel:[0,1,0] op_sel_hi:[1,1,0] neg_lo:[0,0,1] neg_hi:[0,0,1]
    v_pk_fma_f32 v[54:55], v[54:55], v[8:9], v[8:9] op_sel:[0,1,0] op_sel_hi:[1,1,0] neg_lo:[0,0,1] neg_hi:[0,0,1]
    v_cvt_pk_bf16_f32 v72, v48, v49
    v_cvt_pk_bf16_f32 v73, v50, v51
    v_cvt_pk_bf16_f32 v74, v52, v53
    v_cvt_pk_bf16_f32 v75, v54, v55
    ds_write_b128 v6, v[72:75] offset:4096
    v_lshlrev_b32 v16, 16, v76
    v_and_b32 v17, s31, v76
    v_lshlrev_b32 v18, 16, v77
    v_and_b32 v19, s31, v77
    v_lshlrev_b32 v20, 16, v78
    v_and_b32 v21, s31, v78
    v_lshlrev_b32 v22, 16, v79
    v_and_b32 v23, s31, v79
    v_pk_fma_f32 v[16:17], v[16:17], v[8:9], v[8:9] op_sel:[0,1,0] op_sel_hi:[1,1,0] neg_lo:[0,0,1] neg_hi:[0,0,1]
    v_pk_fma_f32 v[18:19], v[18:19], v[8:9], v[8:9] op_sel:[0,1,0] op_sel_hi:[1,1,0] neg_lo:[0,0,1] neg_hi:[0,0,1]
    v_pk_fma_f32 v[20:21], v[20:21], v[8:9], v[8:9] op_sel:[0,1,0] op_sel_hi:[1,1,0] neg_lo:[0,0,1] neg_hi:[0,0,1]
    v_pk_fma_f32 v[22:23], v[22:23], v[8:9], v[8:9] op_sel:[0,1,0] op_sel_hi:[1,1,0] neg_lo:[0,0,1] neg_hi:[0,0,1]
    v_cvt_pk_bf16_f32 v76, v16, v17
    v_cvt_pk_bf16_f32 v77, v18, v19
    v_cvt_pk_bf16_f32 v78, v20, v21
    v_cvt_pk_bf16_f32 v79, v22, v23
    ds_write_b128 v6, v[76:79] offset:5120
    v_bfe_u32 v6, v0, 4, 1
    v_mul_u32_u24 v5, 18432, v6
    v_lshrrev_b32 v6, 5, v0
    v_lshl_add_u32 v5, v6, 8, v5
    v_and_b32 v6, 15, v0
    v_lshl_add_u32 v5, v6, 4, v5
    s_mov_b32 s28, 0xbdd2d3e8
    s_mov_b32 s29, 0xc0135761
    v_mov_b32 v161, 0xbdd2d3e8
    s_mul_i32 s23, s3, 1536
    v_add_u32 v6, s23, v5
    v_add_u32 v6, 73728, v6
    v_add_u32 v1, 73728, v3
    v_add_u32 v2, 110592, v3
    s_mul_i32 s24, s17, 0x240000
    s_add_u32 s24, s24, s18
    s_add_u32 s24, s24, s23
    s_add_u32 s24, s24, 0x1bc6000
    s_add_u32 s25, s24, 36864
    s_waitcnt lgkmcnt(0)
    s_barrier
    ds_read_b128 v[56:59], v3 offset:0
    ds_read_b128 v[60:63], v3 offset:18432
    ds_read_b128 v[64:67], v4 offset:0
    ds_read_b128 v[68:71], v4 offset:18432
    buffer_load_dwordx4 v[112:115], v3, s[12:15], s22 offen offset:0 sc1
    buffer_load_dwordx4 v[116:119], v3, s[12:15], s22 offen offset:1024 sc1
    buffer_load_dwordx4 v[120:123], v3, s[12:15], s22 offen offset:2048 sc1
    s_add_u32 s22, s22, 36864
    buffer_load_dwordx4 v[124:127], v3, s[12:15], s22 offen offset:0 sc1
    buffer_load_dwordx4 v[128:131], v3, s[12:15], s22 offen offset:1024 sc1
    buffer_load_dwordx4 v[132:135], v3, s[12:15], s22 offen offset:2048 sc1
    s_add_u32 s22, s22, 36864
    buffer_load_dwordx4 v[136:139], v3, s[12:15], s22 offen offset:0 sc1
    buffer_load_dwordx4 v[140:143], v3, s[12:15], s22 offen offset:1024 sc1
    buffer_load_dwordx4 v[144:147], v3, s[12:15], s22 offen offset:2048 sc1
    s_add_u32 s22, s22, 36864
    buffer_load_dwordx4 v[148:151], v3, s[12:15], s22 offen offset:0 sc1
    buffer_load_dwordx4 v[152:155], v3, s[12:15], s22 offen offset:1024 sc1
    buffer_load_dwordx4 v[156:159], v3, s[12:15], s22 offen offset:2048 sc1
    s_add_u32 s22, s22, 36864
    ds_read_b128 v[72:75], v3 offset:1024
    ds_read_b128 v[76:79], v3 offset:19456
    ds_read_b128 v[80:83], v4 offset:1024
    ds_read_b128 v[84:87], v4 offset:19456
    s_waitcnt vmcnt(15) lgkmcnt(4)
    v_mfma_f32_16x16x32_bf16 v[8:11], v[88:91], v[56:59], 0
    v_mfma_f32_16x16x32_bf16 v[12:15], v[88:91], v[60:63], 0
    v_mfma_f32_16x16x32_bf16 v[16:19], v[88:91], v[64:67], 0
    v_mfma_f32_16x16x32_bf16 v[20:23], v[88:91], v[68:71], 0
    v_mfma_f32_16x16x32_bf16 v[24:27], v[92:95], v[56:59], 0
    v_mfma_f32_16x16x32_bf16 v[28:31], v[92:95], v[60:63], 0
    v_mfma_f32_16x16x32_bf16 v[32:35], v[92:95], v[64:67], 0
    v_mfma_f32_16x16x32_bf16 v[36:39], v[92:95], v[68:71], 0
    v_mfma_f32_16x16x32_bf16 v[40:43], v[96:99], v[56:59], 0
    v_mfma_f32_16x16x32_bf16 v[44:47], v[96:99], v[60:63], 0
    v_mfma_f32_16x16x32_bf16 v[48:51], v[96:99], v[64:67], 0
    v_mfma_f32_16x16x32_bf16 v[52:55], v[96:99], v[68:71], 0
    buffer_load_dwordx4 v[88:91], v3, s[12:15], s22 offen offset:0 sc1
    buffer_load_dwordx4 v[92:95], v3, s[12:15], s22 offen offset:1024 sc1
    buffer_load_dwordx4 v[96:99], v3, s[12:15], s22 offen offset:2048 sc1
    s_add_u32 s22, s22, 36864
    ds_read_b128 v[56:59], v3 offset:2048
    ds_read_b128 v[60:63], v3 offset:20480
    ds_read_b128 v[64:67], v4 offset:2048
    ds_read_b128 v[68:71], v4 offset:20480
    s_waitcnt vmcnt(15) lgkmcnt(4)
    v_mfma_f32_16x16x32_bf16 v[8:11], v[100:103], v[72:75], v[8:11]
    v_mfma_f32_16x16x32_bf16 v[12:15], v[100:103], v[76:79], v[12:15]
    v_mfma_f32_16x16x32_bf16 v[16:19], v[100:103], v[80:83], v[16:19]
    v_mfma_f32_16x16x32_bf16 v[20:23], v[100:103], v[84:87], v[20:23]
    v_mfma_f32_16x16x32_bf16 v[24:27], v[104:107], v[72:75], v[24:27]
    v_mfma_f32_16x16x32_bf16 v[28:31], v[104:107], v[76:79], v[28:31]
    v_mfma_f32_16x16x32_bf16 v[32:35], v[104:107], v[80:83], v[32:35]
    v_mfma_f32_16x16x32_bf16 v[36:39], v[104:107], v[84:87], v[36:39]
    v_mfma_f32_16x16x32_bf16 v[40:43], v[108:111], v[72:75], v[40:43]
    v_mfma_f32_16x16x32_bf16 v[44:47], v[108:111], v[76:79], v[44:47]
    v_mfma_f32_16x16x32_bf16 v[48:51], v[108:111], v[80:83], v[48:51]
    v_mfma_f32_16x16x32_bf16 v[52:55], v[108:111], v[84:87], v[52:55]
    buffer_load_dwordx4 v[100:103], v3, s[12:15], s22 offen offset:0 sc1
    buffer_load_dwordx4 v[104:107], v3, s[12:15], s22 offen offset:1024 sc1
    buffer_load_dwordx4 v[108:111], v3, s[12:15], s22 offen offset:2048 sc1
    s_add_u32 s22, s22, 36864
    ds_read_b128 v[72:75], v3 offset:3072
    ds_read_b128 v[76:79], v3 offset:21504
    ds_read_b128 v[80:83], v4 offset:3072
    ds_read_b128 v[84:87], v4 offset:21504
    s_waitcnt vmcnt(15) lgkmcnt(4)
    v_mfma_f32_16x16x32_bf16 v[8:11], v[112:115], v[56:59], v[8:11]
    v_mfma_f32_16x16x32_bf16 v[12:15], v[112:115], v[60:63], v[12:15]
    v_mfma_f32_16x16x32_bf16 v[16:19], v[112:115], v[64:67], v[16:19]
    v_mfma_f32_16x16x32_bf16 v[20:23], v[112:115], v[68:71], v[20:23]
    v_mfma_f32_16x16x32_bf16 v[24:27], v[116:119], v[56:59], v[24:27]
    v_mfma_f32_16x16x32_bf16 v[28:31], v[116:119], v[60:63], v[28:31]
    v_mfma_f32_16x16x32_bf16 v[32:35], v[116:119], v[64:67], v[32:35]
    v_mfma_f32_16x16x32_bf16 v[36:39], v[116:119], v[68:71], v[36:39]
    v_mfma_f32_16x16x32_bf16 v[40:43], v[120:123], v[56:59], v[40:43]
    v_mfma_f32_16x16x32_bf16 v[44:47], v[120:123], v[60:63], v[44:47]
    v_mfma_f32_16x16x32_bf16 v[48:51], v[120:123], v[64:67], v[48:51]
    v_mfma_f32_16x16x32_bf16 v[52:55], v[120:123], v[68:71], v[52:55]
    buffer_load_dwordx4 v[112:115], v3, s[12:15], s22 offen offset:0 sc1
    buffer_load_dwordx4 v[116:119], v3, s[12:15], s22 offen offset:1024 sc1
    buffer_load_dwordx4 v[120:123], v3, s[12:15], s22 offen offset:2048 sc1
    s_add_u32 s22, s22, 36864
    ds_read_b128 v[56:59], v3 offset:4096
    ds_read_b128 v[60:63], v3 offset:22528
    ds_read_b128 v[64:67], v4 offset:4096
    ds_read_b128 v[68:71], v4 offset:22528
    s_waitcnt vmcnt(15) lgkmcnt(4)
    v_mfma_f32_16x16x32_bf16 v[8:11], v[124:127], v[72:75], v[8:11]
    v_mfma_f32_16x16x32_bf16 v[12:15], v[124:127], v[76:79], v[12:15]
    v_mfma_f32_16x16x32_bf16 v[16:19], v[124:127], v[80:83], v[16:19]
    v_mfma_f32_16x16x32_bf16 v[20:23], v[124:127], v[84:87], v[20:23]
    v_mfma_f32_16x16x32_bf16 v[24:27], v[128:131], v[72:75], v[24:27]
    v_mfma_f32_16x16x32_bf16 v[28:31], v[128:131], v[76:79], v[28:31]
    v_mfma_f32_16x16x32_bf16 v[32:35], v[128:131], v[80:83], v[32:35]
    v_mfma_f32_16x16x32_bf16 v[36:39], v[128:131], v[84:87], v[36:39]
    v_mfma_f32_16x16x32_bf16 v[40:43], v[132:135], v[72:75], v[40:43]
    v_mfma_f32_16x16x32_bf16 v[44:47], v[132:135], v[76:79], v[44:47]
    v_mfma_f32_16x16x32_bf16 v[48:51], v[132:135], v[80:83], v[48:51]
    v_mfma_f32_16x16x32_bf16 v[52:55], v[132:135], v[84:87], v[52:55]
    buffer_load_dwordx4 v[124:127], v3, s[12:15], s22 offen offset:0 sc1
    buffer_load_dwordx4 v[128:131], v3, s[12:15], s22 offen offset:1024 sc1
    buffer_load_dwordx4 v[132:135], v3, s[12:15], s22 offen offset:2048 sc1
    s_add_u32 s22, s22, 36864
    ds_read_b128 v[72:75], v3 offset:5120
    ds_read_b128 v[76:79], v3 offset:23552
    ds_read_b128 v[80:83], v4 offset:5120
    ds_read_b128 v[84:87], v4 offset:23552
    s_waitcnt vmcnt(15) lgkmcnt(4)
    v_mfma_f32_16x16x32_bf16 v[8:11], v[136:139], v[56:59], v[8:11]
    v_mfma_f32_16x16x32_bf16 v[12:15], v[136:139], v[60:63], v[12:15]
    v_mfma_f32_16x16x32_bf16 v[16:19], v[136:139], v[64:67], v[16:19]
    v_mfma_f32_16x16x32_bf16 v[20:23], v[136:139], v[68:71], v[20:23]
    v_mfma_f32_16x16x32_bf16 v[24:27], v[140:143], v[56:59], v[24:27]
    v_mfma_f32_16x16x32_bf16 v[28:31], v[140:143], v[60:63], v[28:31]
    v_mfma_f32_16x16x32_bf16 v[32:35], v[140:143], v[64:67], v[32:35]
    v_mfma_f32_16x16x32_bf16 v[36:39], v[140:143], v[68:71], v[36:39]
    v_mfma_f32_16x16x32_bf16 v[40:43], v[144:147], v[56:59], v[40:43]
    v_mfma_f32_16x16x32_bf16 v[44:47], v[144:147], v[60:63], v[44:47]
    v_mfma_f32_16x16x32_bf16 v[48:51], v[144:147], v[64:67], v[48:51]
    v_mfma_f32_16x16x32_bf16 v[52:55], v[144:147], v[68:71], v[52:55]
    buffer_load_dwordx4 v[136:139], v3, s[12:15], s22 offen offset:0 sc1
    buffer_load_dwordx4 v[140:143], v3, s[12:15], s22 offen offset:1024 sc1
    buffer_load_dwordx4 v[144:147], v3, s[12:15], s22 offen offset:2048 sc1
    s_add_u32 s22, s22, 36864
    ds_read_b128 v[56:59], v3 offset:6144
    ds_read_b128 v[60:63], v3 offset:24576
    ds_read_b128 v[64:67], v4 offset:6144
    ds_read_b128 v[68:71], v4 offset:24576
    s_waitcnt vmcnt(15) lgkmcnt(4)
    v_mfma_f32_16x16x32_bf16 v[8:11], v[148:151], v[72:75], v[8:11]
    v_mfma_f32_16x16x32_bf16 v[12:15], v[148:151], v[76:79], v[12:15]
    v_mfma_f32_16x16x32_bf16 v[16:19], v[148:151], v[80:83], v[16:19]
    v_mfma_f32_16x16x32_bf16 v[20:23], v[148:151], v[84:87], v[20:23]
    v_mfma_f32_16x16x32_bf16 v[24:27], v[152:155], v[72:75], v[24:27]
    v_mfma_f32_16x16x32_bf16 v[28:31], v[152:155], v[76:79], v[28:31]
    v_mfma_f32_16x16x32_bf16 v[32:35], v[152:155], v[80:83], v[32:35]
    v_mfma_f32_16x16x32_bf16 v[36:39], v[152:155], v[84:87], v[36:39]
    v_mfma_f32_16x16x32_bf16 v[40:43], v[156:159], v[72:75], v[40:43]
    v_mfma_f32_16x16x32_bf16 v[44:47], v[156:159], v[76:79], v[44:47]
    v_mfma_f32_16x16x32_bf16 v[48:51], v[156:159], v[80:83], v[48:51]
    v_mfma_f32_16x16x32_bf16 v[52:55], v[156:159], v[84:87], v[52:55]
    buffer_load_dwordx4 v[148:151], v3, s[12:15], s22 offen offset:0 sc1
    buffer_load_dwordx4 v[152:155], v3, s[12:15], s22 offen offset:1024 sc1
    buffer_load_dwordx4 v[156:159], v3, s[12:15], s22 offen offset:2048 sc1
    s_add_u32 s22, s22, 36864
    ds_read_b128 v[72:75], v3 offset:7168
    ds_read_b128 v[76:79], v3 offset:25600
    ds_read_b128 v[80:83], v4 offset:7168
    ds_read_b128 v[84:87], v4 offset:25600
    s_waitcnt vmcnt(15) lgkmcnt(4)
    v_mfma_f32_16x16x32_bf16 v[8:11], v[88:91], v[56:59], v[8:11]
    v_mfma_f32_16x16x32_bf16 v[12:15], v[88:91], v[60:63], v[12:15]
    v_mfma_f32_16x16x32_bf16 v[16:19], v[88:91], v[64:67], v[16:19]
    v_mfma_f32_16x16x32_bf16 v[20:23], v[88:91], v[68:71], v[20:23]
    v_mfma_f32_16x16x32_bf16 v[24:27], v[92:95], v[56:59], v[24:27]
    v_mfma_f32_16x16x32_bf16 v[28:31], v[92:95], v[60:63], v[28:31]
    v_mfma_f32_16x16x32_bf16 v[32:35], v[92:95], v[64:67], v[32:35]
    v_mfma_f32_16x16x32_bf16 v[36:39], v[92:95], v[68:71], v[36:39]
    v_mfma_f32_16x16x32_bf16 v[40:43], v[96:99], v[56:59], v[40:43]
    v_mfma_f32_16x16x32_bf16 v[44:47], v[96:99], v[60:63], v[44:47]
    v_mfma_f32_16x16x32_bf16 v[48:51], v[96:99], v[64:67], v[48:51]
    v_mfma_f32_16x16x32_bf16 v[52:55], v[96:99], v[68:71], v[52:55]
    buffer_load_dwordx4 v[88:91], v3, s[12:15], s22 offen offset:0 sc1
    buffer_load_dwordx4 v[92:95], v3, s[12:15], s22 offen offset:1024 sc1
    buffer_load_dwordx4 v[96:99], v3, s[12:15], s22 offen offset:2048 sc1
    s_add_u32 s22, s22, 36864
    ds_read_b128 v[56:59], v3 offset:8192
    ds_read_b128 v[60:63], v3 offset:26624
    ds_read_b128 v[64:67], v4 offset:8192
    ds_read_b128 v[68:71], v4 offset:26624
    s_waitcnt vmcnt(15) lgkmcnt(4)
    v_mfma_f32_16x16x32_bf16 v[8:11], v[100:103], v[72:75], v[8:11]
    v_mfma_f32_16x16x32_bf16 v[12:15], v[100:103], v[76:79], v[12:15]
    v_mfma_f32_16x16x32_bf16 v[16:19], v[100:103], v[80:83], v[16:19]
    v_mfma_f32_16x16x32_bf16 v[20:23], v[100:103], v[84:87], v[20:23]
    v_mfma_f32_16x16x32_bf16 v[24:27], v[104:107], v[72:75], v[24:27]
    v_mfma_f32_16x16x32_bf16 v[28:31], v[104:107], v[76:79], v[28:31]
    v_mfma_f32_16x16x32_bf16 v[32:35], v[104:107], v[80:83], v[32:35]
    v_mfma_f32_16x16x32_bf16 v[36:39], v[104:107], v[84:87], v[36:39]
    v_mfma_f32_16x16x32_bf16 v[40:43], v[108:111], v[72:75], v[40:43]
    v_mfma_f32_16x16x32_bf16 v[44:47], v[108:111], v[76:79], v[44:47]
    v_mfma_f32_16x16x32_bf16 v[48:51], v[108:111], v[80:83], v[48:51]
    v_mfma_f32_16x16x32_bf16 v[52:55], v[108:111], v[84:87], v[52:55]
    buffer_load_dwordx4 v[100:103], v3, s[12:15], s22 offen offset:0 sc1
    buffer_load_dwordx4 v[104:107], v3, s[12:15], s22 offen offset:1024 sc1
    buffer_load_dwordx4 v[108:111], v3, s[12:15], s22 offen offset:2048 sc1
    s_add_u32 s22, s22, 36864
    ds_read_b128 v[72:75], v3 offset:9216
    ds_read_b128 v[76:79], v3 offset:27648
    ds_read_b128 v[80:83], v4 offset:9216
    ds_read_b128 v[84:87], v4 offset:27648
    s_waitcnt vmcnt(15) lgkmcnt(4)
    v_mfma_f32_16x16x32_bf16 v[8:11], v[112:115], v[56:59], v[8:11]
    v_mfma_f32_16x16x32_bf16 v[12:15], v[112:115], v[60:63], v[12:15]
    v_mfma_f32_16x16x32_bf16 v[16:19], v[112:115], v[64:67], v[16:19]
    v_mfma_f32_16x16x32_bf16 v[20:23], v[112:115], v[68:71], v[20:23]
    v_mfma_f32_16x16x32_bf16 v[24:27], v[116:119], v[56:59], v[24:27]
    v_mfma_f32_16x16x32_bf16 v[28:31], v[116:119], v[60:63], v[28:31]
    v_mfma_f32_16x16x32_bf16 v[32:35], v[116:119], v[64:67], v[32:35]
    v_mfma_f32_16x16x32_bf16 v[36:39], v[116:119], v[68:71], v[36:39]
    v_mfma_f32_16x16x32_bf16 v[40:43], v[120:123], v[56:59], v[40:43]
    v_mfma_f32_16x16x32_bf16 v[44:47], v[120:123], v[60:63], v[44:47]
    v_mfma_f32_16x16x32_bf16 v[48:51], v[120:123], v[64:67], v[48:51]
    v_mfma_f32_16x16x32_bf16 v[52:55], v[120:123], v[68:71], v[52:55]
    buffer_load_dwordx4 v[112:115], v3, s[12:15], s22 offen offset:0 sc1
    buffer_load_dwordx4 v[116:119], v3, s[12:15], s22 offen offset:1024 sc1
    buffer_load_dwordx4 v[120:123], v3, s[12:15], s22 offen offset:2048 sc1
    s_add_u32 s22, s22, 36864
    ds_read_b128 v[56:59], v3 offset:10240
    ds_read_b128 v[60:63], v3 offset:28672
    ds_read_b128 v[64:67], v4 offset:10240
    ds_read_b128 v[68:71], v4 offset:28672
    s_waitcnt vmcnt(15) lgkmcnt(4)
    v_mfma_f32_16x16x32_bf16 v[8:11], v[124:127], v[72:75], v[8:11]
    v_mfma_f32_16x16x32_bf16 v[12:15], v[124:127], v[76:79], v[12:15]
    v_mfma_f32_16x16x32_bf16 v[16:19], v[124:127], v[80:83], v[16:19]
    v_mfma_f32_16x16x32_bf16 v[20:23], v[124:127], v[84:87], v[20:23]
    v_mfma_f32_16x16x32_bf16 v[24:27], v[128:131], v[72:75], v[24:27]
    v_mfma_f32_16x16x32_bf16 v[28:31], v[128:131], v[76:79], v[28:31]
    v_mfma_f32_16x16x32_bf16 v[32:35], v[128:131], v[80:83], v[32:35]
    v_mfma_f32_16x16x32_bf16 v[36:39], v[128:131], v[84:87], v[36:39]
    v_mfma_f32_16x16x32_bf16 v[40:43], v[132:135], v[72:75], v[40:43]
    v_mfma_f32_16x16x32_bf16 v[44:47], v[132:135], v[76:79], v[44:47]
    v_mfma_f32_16x16x32_bf16 v[48:51], v[132:135], v[80:83], v[48:51]
    v_mfma_f32_16x16x32_bf16 v[52:55], v[132:135], v[84:87], v[52:55]
    buffer_load_dwordx4 v[124:127], v3, s[12:15], s22 offen offset:0 sc1
    buffer_load_dwordx4 v[128:131], v3, s[12:15], s22 offen offset:1024 sc1
    buffer_load_dwordx4 v[132:135], v3, s[12:15], s22 offen offset:2048 sc1
    s_add_u32 s22, s22, 36864
    ds_read_b128 v[72:75], v3 offset:11264
    ds_read_b128 v[76:79], v3 offset:29696
    ds_read_b128 v[80:83], v4 offset:11264
    ds_read_b128 v[84:87], v4 offset:29696
    s_waitcnt vmcnt(15) lgkmcnt(4)
    v_mfma_f32_16x16x32_bf16 v[8:11], v[136:139], v[56:59], v[8:11]
    v_mfma_f32_16x16x32_bf16 v[12:15], v[136:139], v[60:63], v[12:15]
    v_mfma_f32_16x16x32_bf16 v[16:19], v[136:139], v[64:67], v[16:19]
    v_mfma_f32_16x16x32_bf16 v[20:23], v[136:139], v[68:71], v[20:23]
    v_mfma_f32_16x16x32_bf16 v[24:27], v[140:143], v[56:59], v[24:27]
    v_mfma_f32_16x16x32_bf16 v[28:31], v[140:143], v[60:63], v[28:31]
    v_mfma_f32_16x16x32_bf16 v[32:35], v[140:143], v[64:67], v[32:35]
    v_mfma_f32_16x16x32_bf16 v[36:39], v[140:143], v[68:71], v[36:39]
    v_mfma_f32_16x16x32_bf16 v[40:43], v[144:147], v[56:59], v[40:43]
    v_mfma_f32_16x16x32_bf16 v[44:47], v[144:147], v[60:63], v[44:47]
    v_mfma_f32_16x16x32_bf16 v[48:51], v[144:147], v[64:67], v[48:51]
    v_mfma_f32_16x16x32_bf16 v[52:55], v[144:147], v[68:71], v[52:55]
    buffer_load_dwordx4 v[136:139], v3, s[12:15], s22 offen offset:0 sc1
    buffer_load_dwordx4 v[140:143], v3, s[12:15], s22 offen offset:1024 sc1
    buffer_load_dwordx4 v[144:147], v3, s[12:15], s22 offen offset:2048 sc1
    s_add_u32 s22, s22, 36864
    ds_read_b128 v[56:59], v3 offset:12288
    ds_read_b128 v[60:63], v3 offset:30720
    ds_read_b128 v[64:67], v4 offset:12288
    ds_read_b128 v[68:71], v4 offset:30720
    s_waitcnt vmcnt(15) lgkmcnt(4)
    v_mfma_f32_16x16x32_bf16 v[8:11], v[148:151], v[72:75], v[8:11]
    v_mfma_f32_16x16x32_bf16 v[12:15], v[148:151], v[76:79], v[12:15]
    v_mfma_f32_16x16x32_bf16 v[16:19], v[148:151], v[80:83], v[16:19]
    v_mfma_f32_16x16x32_bf16 v[20:23], v[148:151], v[84:87], v[20:23]
    v_mfma_f32_16x16x32_bf16 v[24:27], v[152:155], v[72:75], v[24:27]
    v_mfma_f32_16x16x32_bf16 v[28:31], v[152:155], v[76:79], v[28:31]
    v_mfma_f32_16x16x32_bf16 v[32:35], v[152:155], v[80:83], v[32:35]
    v_mfma_f32_16x16x32_bf16 v[36:39], v[152:155], v[84:87], v[36:39]
    v_mfma_f32_16x16x32_bf16 v[40:43], v[156:159], v[72:75], v[40:43]
    v_mfma_f32_16x16x32_bf16 v[44:47], v[156:159], v[76:79], v[44:47]
    v_mfma_f32_16x16x32_bf16 v[48:51], v[156:159], v[80:83], v[48:51]
    v_mfma_f32_16x16x32_bf16 v[52:55], v[156:159], v[84:87], v[52:55]
    buffer_load_dwordx4 v[148:151], v3, s[12:15], s22 offen offset:0 sc1
    buffer_load_dwordx4 v[152:155], v3, s[12:15], s22 offen offset:1024 sc1
    buffer_load_dwordx4 v[156:159], v3, s[12:15], s22 offen offset:2048 sc1
    s_add_u32 s22, s22, 36864
    ds_read_b128 v[72:75], v3 offset:13312
    ds_read_b128 v[76:79], v3 offset:31744
    ds_read_b128 v[80:83], v4 offset:13312
    ds_read_b128 v[84:87], v4 offset:31744
    s_waitcnt vmcnt(15) lgkmcnt(4)
    v_mfma_f32_16x16x32_bf16 v[8:11], v[88:91], v[56:59], v[8:11]
    v_mfma_f32_16x16x32_bf16 v[12:15], v[88:91], v[60:63], v[12:15]
    v_mfma_f32_16x16x32_bf16 v[16:19], v[88:91], v[64:67], v[16:19]
    v_mfma_f32_16x16x32_bf16 v[20:23], v[88:91], v[68:71], v[20:23]
    v_mfma_f32_16x16x32_bf16 v[24:27], v[92:95], v[56:59], v[24:27]
    v_mfma_f32_16x16x32_bf16 v[28:31], v[92:95], v[60:63], v[28:31]
    v_mfma_f32_16x16x32_bf16 v[32:35], v[92:95], v[64:67], v[32:35]
    v_mfma_f32_16x16x32_bf16 v[36:39], v[92:95], v[68:71], v[36:39]
    v_mfma_f32_16x16x32_bf16 v[40:43], v[96:99], v[56:59], v[40:43]
    v_mfma_f32_16x16x32_bf16 v[44:47], v[96:99], v[60:63], v[44:47]
    v_mfma_f32_16x16x32_bf16 v[48:51], v[96:99], v[64:67], v[48:51]
    v_mfma_f32_16x16x32_bf16 v[52:55], v[96:99], v[68:71], v[52:55]
    buffer_load_dwordx4 v[88:91], v3, s[12:15], s22 offen offset:0 sc1
    buffer_load_dwordx4 v[92:95], v3, s[12:15], s22 offen offset:1024 sc1
    buffer_load_dwordx4 v[96:99], v3, s[12:15], s22 offen offset:2048 sc1
    s_add_u32 s22, s22, 36864
    ds_read_b128 v[56:59], v3 offset:14336
    ds_read_b128 v[60:63], v3 offset:32768
    ds_read_b128 v[64:67], v4 offset:14336
    ds_read_b128 v[68:71], v4 offset:32768
    s_waitcnt vmcnt(15) lgkmcnt(4)
    v_mfma_f32_16x16x32_bf16 v[8:11], v[100:103], v[72:75], v[8:11]
    v_mfma_f32_16x16x32_bf16 v[12:15], v[100:103], v[76:79], v[12:15]
    v_mfma_f32_16x16x32_bf16 v[16:19], v[100:103], v[80:83], v[16:19]
    v_mfma_f32_16x16x32_bf16 v[20:23], v[100:103], v[84:87], v[20:23]
    v_mfma_f32_16x16x32_bf16 v[24:27], v[104:107], v[72:75], v[24:27]
    v_mfma_f32_16x16x32_bf16 v[28:31], v[104:107], v[76:79], v[28:31]
    v_mfma_f32_16x16x32_bf16 v[32:35], v[104:107], v[80:83], v[32:35]
    v_mfma_f32_16x16x32_bf16 v[36:39], v[104:107], v[84:87], v[36:39]
    v_mfma_f32_16x16x32_bf16 v[40:43], v[108:111], v[72:75], v[40:43]
    v_mfma_f32_16x16x32_bf16 v[44:47], v[108:111], v[76:79], v[44:47]
    v_mfma_f32_16x16x32_bf16 v[48:51], v[108:111], v[80:83], v[48:51]
    v_mfma_f32_16x16x32_bf16 v[52:55], v[108:111], v[84:87], v[52:55]
    buffer_load_dwordx4 v[100:103], v3, s[12:15], s22 offen offset:0 sc1
    buffer_load_dwordx4 v[104:107], v3, s[12:15], s22 offen offset:1024 sc1
    buffer_load_dwordx4 v[108:111], v3, s[12:15], s22 offen offset:2048 sc1
    s_add_u32 s22, s22, 36864
    ds_read_b128 v[72:75], v3 offset:15360
    ds_read_b128 v[76:79], v3 offset:33792
    ds_read_b128 v[80:83], v4 offset:15360
    ds_read_b128 v[84:87], v4 offset:33792
    s_waitcnt vmcnt(15) lgkmcnt(4)
    v_mfma_f32_16x16x32_bf16 v[8:11], v[112:115], v[56:59], v[8:11]
    v_mfma_f32_16x16x32_bf16 v[12:15], v[112:115], v[60:63], v[12:15]
    v_mfma_f32_16x16x32_bf16 v[16:19], v[112:115], v[64:67], v[16:19]
    v_mfma_f32_16x16x32_bf16 v[20:23], v[112:115], v[68:71], v[20:23]
    v_mfma_f32_16x16x32_bf16 v[24:27], v[116:119], v[56:59], v[24:27]
    v_mfma_f32_16x16x32_bf16 v[28:31], v[116:119], v[60:63], v[28:31]
    v_mfma_f32_16x16x32_bf16 v[32:35], v[116:119], v[64:67], v[32:35]
    v_mfma_f32_16x16x32_bf16 v[36:39], v[116:119], v[68:71], v[36:39]
    v_mfma_f32_16x16x32_bf16 v[40:43], v[120:123], v[56:59], v[40:43]
    v_mfma_f32_16x16x32_bf16 v[44:47], v[120:123], v[60:63], v[44:47]
    v_mfma_f32_16x16x32_bf16 v[48:51], v[120:123], v[64:67], v[48:51]
    v_mfma_f32_16x16x32_bf16 v[52:55], v[120:123], v[68:71], v[52:55]
    buffer_load_dwordx4 v[112:115], v3, s[12:15], s22 offen offset:0 sc1
    buffer_load_dwordx4 v[116:119], v3, s[12:15], s22 offen offset:1024 sc1
    buffer_load_dwordx4 v[120:123], v3, s[12:15], s22 offen offset:2048 sc1
    s_add_u32 s22, s22, 36864
    ds_read_b128 v[56:59], v3 offset:16384
    ds_read_b128 v[60:63], v3 offset:34816
    ds_read_b128 v[64:67], v4 offset:16384
    ds_read_b128 v[68:71], v4 offset:34816
    s_waitcnt vmcnt(15) lgkmcnt(4)
    v_mfma_f32_16x16x32_bf16 v[8:11], v[124:127], v[72:75], v[8:11]
    v_mfma_f32_16x16x32_bf16 v[12:15], v[124:127], v[76:79], v[12:15]
    v_mfma_f32_16x16x32_bf16 v[16:19], v[124:127], v[80:83], v[16:19]
    v_mfma_f32_16x16x32_bf16 v[20:23], v[124:127], v[84:87], v[20:23]
    v_mfma_f32_16x16x32_bf16 v[24:27], v[128:131], v[72:75], v[24:27]
    v_mfma_f32_16x16x32_bf16 v[28:31], v[128:131], v[76:79], v[28:31]
    v_mfma_f32_16x16x32_bf16 v[32:35], v[128:131], v[80:83], v[32:35]
    v_mfma_f32_16x16x32_bf16 v[36:39], v[128:131], v[84:87], v[36:39]
    v_mfma_f32_16x16x32_bf16 v[40:43], v[132:135], v[72:75], v[40:43]
    v_mfma_f32_16x16x32_bf16 v[44:47], v[132:135], v[76:79], v[44:47]
    v_mfma_f32_16x16x32_bf16 v[48:51], v[132:135], v[80:83], v[48:51]
    v_mfma_f32_16x16x32_bf16 v[52:55], v[132:135], v[84:87], v[52:55]
    buffer_load_dwordx4 v[124:127], v3, s[12:15], s22 offen offset:0 sc1
    buffer_load_dwordx4 v[128:131], v3, s[12:15], s22 offen offset:1024 sc1
    buffer_load_dwordx4 v[132:135], v3, s[12:15], s22 offen offset:2048 sc1
    s_add_u32 s22, s22, 36864
    ds_read_b128 v[72:75], v3 offset:17408
    ds_read_b128 v[76:79], v3 offset:35840
    ds_read_b128 v[80:83], v4 offset:17408
    ds_read_b128 v[84:87], v4 offset:35840
    s_waitcnt vmcnt(15) lgkmcnt(4)
    v_mfma_f32_16x16x32_bf16 v[8:11], v[136:139], v[56:59], v[8:11]
    v_mfma_f32_16x16x32_bf16 v[12:15], v[136:139], v[60:63], v[12:15]
    v_mfma_f32_16x16x32_bf16 v[16:19], v[136:139], v[64:67], v[16:19]
    v_mfma_f32_16x16x32_bf16 v[20:23], v[136:139], v[68:71], v[20:23]
    v_mfma_f32_16x16x32_bf16 v[24:27], v[140:143], v[56:59], v[24:27]
    v_mfma_f32_16x16x32_bf16 v[28:31], v[140:143], v[60:63], v[28:31]
    v_mfma_f32_16x16x32_bf16 v[32:35], v[140:143], v[64:67], v[32:35]
    v_mfma_f32_16x16x32_bf16 v[36:39], v[140:143], v[68:71], v[36:39]
    v_mfma_f32_16x16x32_bf16 v[40:43], v[144:147], v[56:59], v[40:43]
    v_mfma_f32_16x16x32_bf16 v[44:47], v[144:147], v[60:63], v[44:47]
    v_mfma_f32_16x16x32_bf16 v[48:51], v[144:147], v[64:67], v[48:51]
    v_mfma_f32_16x16x32_bf16 v[52:55], v[144:147], v[68:71], v[52:55]
    buffer_load_dwordx4 v[136:139], v3, s[12:15], s22 offen offset:0 sc1
    buffer_load_dwordx4 v[140:143], v3, s[12:15], s22 offen offset:1024 sc1
    buffer_load_dwordx4 v[144:147], v3, s[12:15], s22 offen offset:2048 sc1
    s_add_u32 s22, s22, 36864
    s_waitcnt vmcnt(15) lgkmcnt(0)
    v_mfma_f32_16x16x32_bf16 v[8:11], v[148:151], v[72:75], v[8:11]
    v_mfma_f32_16x16x32_bf16 v[12:15], v[148:151], v[76:79], v[12:15]
    v_mfma_f32_16x16x32_bf16 v[16:19], v[148:151], v[80:83], v[16:19]
    v_mfma_f32_16x16x32_bf16 v[20:23], v[148:151], v[84:87], v[20:23]
    v_mfma_f32_16x16x32_bf16 v[24:27], v[152:155], v[72:75], v[24:27]
    v_mfma_f32_16x16x32_bf16 v[28:31], v[152:155], v[76:79], v[28:31]
    v_mfma_f32_16x16x32_bf16 v[32:35], v[152:155], v[80:83], v[32:35]
    v_mfma_f32_16x16x32_bf16 v[36:39], v[152:155], v[84:87], v[36:39]
    v_mfma_f32_16x16x32_bf16 v[40:43], v[156:159], v[72:75], v[40:43]
    v_mfma_f32_16x16x32_bf16 v[44:47], v[156:159], v[76:79], v[44:47]
    v_mfma_f32_16x16x32_bf16 v[48:51], v[156:159], v[80:83], v[48:51]
    v_mfma_f32_16x16x32_bf16 v[52:55], v[156:159], v[84:87], v[52:55]
    buffer_load_dwordx4 v[148:151], v3, s[12:15], s22 offen offset:0 sc1
    buffer_load_dwordx4 v[152:155], v3, s[12:15], s22 offen offset:1024 sc1
    buffer_load_dwordx4 v[156:159], v3, s[12:15], s22 offen offset:2048 sc1
    s_add_u32 s22, s22, 36864
    s_setprio 2
    v_mul_f32 v56, v8, v8
    v_mul_f32 v57, v9, v9
    v_mul_f32 v58, v10, v10
    v_mul_f32 v59, v11, v11
    v_mul_f32 v60, v12, v12
    v_mul_f32 v61, v13, v13
    v_mul_f32 v62, v14, v14
    v_mul_f32 v63, v15, v15
    v_mul_f32 v64, v16, v16
    v_mul_f32 v65, v17, v17
    v_mul_f32 v66, v18, v18
    v_mul_f32 v67, v19, v19
    v_mul_f32 v68, v20, v20
    v_mul_f32 v69, v21, v21
    v_mul_f32 v70, v22, v22
    v_mul_f32 v71, v23, v23
    v_fmaak_f32 v56, v56, v161, 0xc0135761
    v_fmaak_f32 v57, v57, v161, 0xc0135761
    v_fmaak_f32 v58, v58, v161, 0xc0135761
    v_fmaak_f32 v59, v59, v161, 0xc0135761
    v_fmaak_f32 v60, v60, v161, 0xc0135761
    v_fmaak_f32 v61, v61, v161, 0xc0135761
    v_fmaak_f32 v62, v62, v161, 0xc0135761
    v_fmaak_f32 v63, v63, v161, 0xc0135761
    v_fmaak_f32 v64, v64, v161, 0xc0135761
    v_fmaak_f32 v65, v65, v161, 0xc0135761
    v_fmaak_f32 v66, v66, v161, 0xc0135761
    v_fmaak_f32 v67, v67, v161, 0xc0135761
    v_fmaak_f32 v68, v68, v161, 0xc0135761
    v_fmaak_f32 v69, v69, v161, 0xc0135761
    v_fmaak_f32 v70, v70, v161, 0xc0135761
    v_fmaak_f32 v71, v71, v161, 0xc0135761
    v_mul_f32 v56, v56, v8
    v_mul_f32 v57, v57, v9
    v_mul_f32 v58, v58, v10
    v_mul_f32 v59, v59, v11
    v_mul_f32 v60, v60, v12
    v_mul_f32 v61, v61, v13
    v_mul_f32 v62, v62, v14
    v_mul_f32 v63, v63, v15
    v_mul_f32 v64, v64, v16
    v_mul_f32 v65, v65, v17
    v_mul_f32 v66, v66, v18
    v_mul_f32 v67, v67, v19
    v_mul_f32 v68, v68, v20
    v_mul_f32 v69, v69, v21
    v_mul_f32 v70, v70, v22
    v_mul_f32 v71, v71, v23
    v_exp_f32 v56, v56
    v_exp_f32 v57, v57
    v_exp_f32 v58, v58
    v_exp_f32 v59, v59
    v_exp_f32 v60, v60
    v_exp_f32 v61, v61
    v_exp_f32 v62, v62
    v_exp_f32 v63, v63
    v_exp_f32 v64, v64
    v_exp_f32 v65, v65
    v_exp_f32 v66, v66
    v_exp_f32 v67, v67
    v_exp_f32 v68, v68
    v_exp_f32 v69, v69
    v_exp_f32 v70, v70
    v_exp_f32 v71, v71
    v_add_f32 v56, 1.0, v56
    v_add_f32 v57, 1.0, v57
    v_add_f32 v58, 1.0, v58
    v_add_f32 v59, 1.0, v59
    v_add_f32 v60, 1.0, v60
    v_add_f32 v61, 1.0, v61
    v_add_f32 v62, 1.0, v62
    v_add_f32 v63, 1.0, v63
    v_add_f32 v64, 1.0, v64
    v_add_f32 v65, 1.0, v65
    v_add_f32 v66, 1.0, v66
    v_add_f32 v67, 1.0, v67
    v_add_f32 v68, 1.0, v68
    v_add_f32 v69, 1.0, v69
    v_add_f32 v70, 1.0, v70
    v_add_f32 v71, 1.0, v71
    v_rcp_f32 v56, v56
    v_rcp_f32 v57, v57
    v_rcp_f32 v58, v58
    v_rcp_f32 v59, v59
    v_rcp_f32 v60, v60
    v_rcp_f32 v61, v61
    v_rcp_f32 v62, v62
    v_rcp_f32 v63, v63
    v_rcp_f32 v64, v64
    v_rcp_f32 v65, v65
    v_rcp_f32 v66, v66
    v_rcp_f32 v67, v67
    v_rcp_f32 v68, v68
    v_rcp_f32 v69, v69
    v_rcp_f32 v70, v70
    v_rcp_f32 v71, v71
    v_mul_f32 v8, v8, v56
    v_mul_f32 v9, v9, v57
    v_mul_f32 v10, v10, v58
    v_mul_f32 v11, v11, v59
    v_mul_f32 v12, v12, v60
    v_mul_f32 v13, v13, v61
    v_mul_f32 v14, v14, v62
    v_mul_f32 v15, v15, v63
    v_mul_f32 v16, v16, v64
    v_mul_f32 v17, v17, v65
    v_mul_f32 v18, v18, v66
    v_mul_f32 v19, v19, v67
    v_mul_f32 v20, v20, v68
    v_mul_f32 v21, v21, v69
    v_mul_f32 v22, v22, v70
    v_mul_f32 v23, v23, v71
    v_cvt_pk_bf16_f32 v72, v8, v9
    v_cvt_pk_bf16_f32 v73, v10, v11
    v_cvt_pk_bf16_f32 v74, v12, v13
    v_cvt_pk_bf16_f32 v75, v14, v15
    s_nop 0
    v_permlane16_swap_b32 v72, v74
    v_permlane16_swap_b32 v73, v75
    ds_write_b128 v6, v[72:75] offset:0
    v_cvt_pk_bf16_f32 v76, v16, v17
    v_cvt_pk_bf16_f32 v77, v18, v19
    v_cvt_pk_bf16_f32 v78, v20, v21
    v_cvt_pk_bf16_f32 v79, v22, v23
    s_nop 0
    v_permlane16_swap_b32 v76, v78
    v_permlane16_swap_b32 v77, v79
    ds_write_b128 v6, v[76:79] offset:36864
    v_mul_f32 v56, v24, v24
    v_mul_f32 v57, v25, v25
    v_mul_f32 v58, v26, v26
    v_mul_f32 v59, v27, v27
    v_mul_f32 v60, v28, v28
    v_mul_f32 v61, v29, v29
    v_mul_f32 v62, v30, v30
    v_mul_f32 v63, v31, v31
    v_mul_f32 v64, v32, v32
    v_mul_f32 v65, v33, v33
    v_mul_f32 v66, v34, v34
    v_mul_f32 v67, v35, v35
    v_mul_f32 v68, v36, v36
    v_mul_f32 v69, v37, v37
    v_mul_f32 v70, v38, v38
    v_mul_f32 v71, v39, v39
    v_fmaak_f32 v56, v56, v161, 0xc0135761
    v_fmaak_f32 v57, v57, v161, 0xc0135761
    v_fmaak_f32 v58, v58, v161, 0xc0135761
    v_fmaak_f32 v59, v59, v161, 0xc0135761
    v_fmaak_f32 v60, v60, v161, 0xc0135761
    v_fmaak_f32 v61, v61, v161, 0xc0135761
    v_fmaak_f32 v62, v62, v161, 0xc0135761
    v_fmaak_f32 v63, v63, v161, 0xc0135761
    v_fmaak_f32 v64, v64, v161, 0xc0135761
    v_fmaak_f32 v65, v65, v161, 0xc0135761
    v_fmaak_f32 v66, v66, v161, 0xc0135761
    v_fmaak_f32 v67, v67, v161, 0xc0135761
    v_fmaak_f32 v68, v68, v161, 0xc0135761
    v_fmaak_f32 v69, v69, v161, 0xc0135761
    v_fmaak_f32 v70, v70, v161, 0xc0135761
    v_fmaak_f32 v71, v71, v161, 0xc0135761
    v_mul_f32 v56, v56, v24
    v_mul_f32 v57, v57, v25
    v_mul_f32 v58, v58, v26
    v_mul_f32 v59, v59, v27
    v_mul_f32 v60, v60, v28
    v_mul_f32 v61, v61, v29
    v_mul_f32 v62, v62, v30
    v_mul_f32 v63, v63, v31
    v_mul_f32 v64, v64, v32
    v_mul_f32 v65, v65, v33
    v_mul_f32 v66, v66, v34
    v_mul_f32 v67, v67, v35
    v_mul_f32 v68, v68, v36
    v_mul_f32 v69, v69, v37
    v_mul_f32 v70, v70, v38
    v_mul_f32 v71, v71, v39
    v_exp_f32 v56, v56
    v_exp_f32 v57, v57
    v_exp_f32 v58, v58
    v_exp_f32 v59, v59
    v_exp_f32 v60, v60
    v_exp_f32 v61, v61
    v_exp_f32 v62, v62
    v_exp_f32 v63, v63
    v_exp_f32 v64, v64
    v_exp_f32 v65, v65
    v_exp_f32 v66, v66
    v_exp_f32 v67, v67
    v_exp_f32 v68, v68
    v_exp_f32 v69, v69
    v_exp_f32 v70, v70
    v_exp_f32 v71, v71
    v_add_f32 v56, 1.0, v56
    v_add_f32 v57, 1.0, v57
    v_add_f32 v58, 1.0, v58
    v_add_f32 v59, 1.0, v59
    v_add_f32 v60, 1.0, v60
    v_add_f32 v61, 1.0, v61
    v_add_f32 v62, 1.0, v62
    v_add_f32 v63, 1.0, v63
    v_add_f32 v64, 1.0, v64
    v_add_f32 v65, 1.0, v65
    v_add_f32 v66, 1.0, v66
    v_add_f32 v67, 1.0, v67
    v_add_f32 v68, 1.0, v68
    v_add_f32 v69, 1.0, v69
    v_add_f32 v70, 1.0, v70
    v_add_f32 v71, 1.0, v71
    v_rcp_f32 v56, v56
    v_rcp_f32 v57, v57
    v_rcp_f32 v58, v58
    v_rcp_f32 v59, v59
    v_rcp_f32 v60, v60
    v_rcp_f32 v61, v61
    v_rcp_f32 v62, v62
    v_rcp_f32 v63, v63
    v_rcp_f32 v64, v64
    v_rcp_f32 v65, v65
    v_rcp_f32 v66, v66
    v_rcp_f32 v67, v67
    v_rcp_f32 v68, v68
    v_rcp_f32 v69, v69
    v_rcp_f32 v70, v70
    v_rcp_f32 v71, v71
    v_mul_f32 v24, v24, v56
    v_mul_f32 v25, v25, v57
    v_mul_f32 v26, v26, v58
    v_mul_f32 v27, v27, v59
    v_mul_f32 v28, v28, v60
    v_mul_f32 v29, v29, v61
    v_mul_f32 v30, v30, v62
    v_mul_f32 v31, v31, v63
    v_mul_f32 v32, v32, v64
    v_mul_f32 v33, v33, v65
    v_mul_f32 v34, v34, v66
    v_mul_f32 v35, v35, v67
    v_mul_f32 v36, v36, v68
    v_mul_f32 v37, v37, v69
    v_mul_f32 v38, v38, v70
    v_mul_f32 v39, v39, v71
    v_cvt_pk_bf16_f32 v80, v24, v25
    v_cvt_pk_bf16_f32 v81, v26, v27
    v_cvt_pk_bf16_f32 v82, v28, v29
    v_cvt_pk_bf16_f32 v83, v30, v31
    s_nop 0
    v_permlane16_swap_b32 v80, v82
    v_permlane16_swap_b32 v81, v83
    ds_write_b128 v6, v[80:83] offset:512
    v_cvt_pk_bf16_f32 v84, v32, v33
    v_cvt_pk_bf16_f32 v85, v34, v35
    v_cvt_pk_bf16_f32 v86, v36, v37
    v_cvt_pk_bf16_f32 v87, v38, v39
    s_nop 0
    v_permlane16_swap_b32 v84, v86
    v_permlane16_swap_b32 v85, v87
    ds_write_b128 v6, v[84:87] offset:37376
    v_mul_f32 v56, v40, v40
    v_mul_f32 v57, v41, v41
    v_mul_f32 v58, v42, v42
    v_mul_f32 v59, v43, v43
    v_mul_f32 v60, v44, v44
    v_mul_f32 v61, v45, v45
    v_mul_f32 v62, v46, v46
    v_mul_f32 v63, v47, v47
    v_mul_f32 v64, v48, v48
    v_mul_f32 v65, v49, v49
    v_mul_f32 v66, v50, v50
    v_mul_f32 v67, v51, v51
    v_mul_f32 v68, v52, v52
    v_mul_f32 v69, v53, v53
    v_mul_f32 v70, v54, v54
    v_mul_f32 v71, v55, v55
    v_fmaak_f32 v56, v56, v161, 0xc0135761
    v_fmaak_f32 v57, v57, v161, 0xc0135761
    v_fmaak_f32 v58, v58, v161, 0xc0135761
    v_fmaak_f32 v59, v59, v161, 0xc0135761
    v_fmaak_f32 v60, v60, v161, 0xc0135761
    v_fmaak_f32 v61, v61, v161, 0xc0135761
    v_fmaak_f32 v62, v62, v161, 0xc0135761
    v_fmaak_f32 v63, v63, v161, 0xc0135761
    v_fmaak_f32 v64, v64, v161, 0xc0135761
    v_fmaak_f32 v65, v65, v161, 0xc0135761
    v_fmaak_f32 v66, v66, v161, 0xc0135761
    v_fmaak_f32 v67, v67, v161, 0xc0135761
    v_fmaak_f32 v68, v68, v161, 0xc0135761
    v_fmaak_f32 v69, v69, v161, 0xc0135761
    v_fmaak_f32 v70, v70, v161, 0xc0135761
    v_fmaak_f32 v71, v71, v161, 0xc0135761
    v_mul_f32 v56, v56, v40
    v_mul_f32 v57, v57, v41
    v_mul_f32 v58, v58, v42
    v_mul_f32 v59, v59, v43
    v_mul_f32 v60, v60, v44
    v_mul_f32 v61, v61, v45
    v_mul_f32 v62, v62, v46
    v_mul_f32 v63, v63, v47
    v_mul_f32 v64, v64, v48
    v_mul_f32 v65, v65, v49
    v_mul_f32 v66, v66, v50
    v_mul_f32 v67, v67, v51
    v_mul_f32 v68, v68, v52
    v_mul_f32 v69, v69, v53
    v_mul_f32 v70, v70, v54
    v_mul_f32 v71, v71, v55
    v_exp_f32 v56, v56
    v_exp_f32 v57, v57
    v_exp_f32 v58, v58
    v_exp_f32 v59, v59
    v_exp_f32 v60, v60
    v_exp_f32 v61, v61
    v_exp_f32 v62, v62
    v_exp_f32 v63, v63
    v_exp_f32 v64, v64
    v_exp_f32 v65, v65
    v_exp_f32 v66, v66
    v_exp_f32 v67, v67
    v_exp_f32 v68, v68
    v_exp_f32 v69, v69
    v_exp_f32 v70, v70
    v_exp_f32 v71, v71
    v_add_f32 v56, 1.0, v56
    v_add_f32 v57, 1.0, v57
    v_add_f32 v58, 1.0, v58
    v_add_f32 v59, 1.0, v59
    v_add_f32 v60, 1.0, v60
    v_add_f32 v61, 1.0, v61
    v_add_f32 v62, 1.0, v62
    v_add_f32 v63, 1.0, v63
    v_add_f32 v64, 1.0, v64
    v_add_f32 v65, 1.0, v65
    v_add_f32 v66, 1.0, v66
    v_add_f32 v67, 1.0, v67
    v_add_f32 v68, 1.0, v68
    v_add_f32 v69, 1.0, v69
    v_add_f32 v70, 1.0, v70
    v_add_f32 v71, 1.0, v71
    v_rcp_f32 v56, v56
    v_rcp_f32 v57, v57
    v_rcp_f32 v58, v58
    v_rcp_f32 v59, v59
    v_rcp_f32 v60, v60
    v_rcp_f32 v61, v61
    v_rcp_f32 v62, v62
    v_rcp_f32 v63, v63
    v_rcp_f32 v64, v64
    v_rcp_f32 v65, v65
    v_rcp_f32 v66, v66
    v_rcp_f32 v67, v67
    v_rcp_f32 v68, v68
    v_rcp_f32 v69, v69
    v_rcp_f32 v70, v70
    v_rcp_f32 v71, v71
    v_mul_f32 v40, v40, v56
    v_mul_f32 v41, v41, v57
    v_mul_f32 v42, v42, v58
    v_mul_f32 v43, v43, v59
    v_mul_f32 v44, v44, v60
    v_mul_f32 v45, v45, v61
    v_mul_f32 v46, v46, v62
    v_mul_f32 v47, v47, v63
    v_mul_f32 v48, v48, v64
    v_mul_f32 v49, v49, v65
    v_mul_f32 v50, v50, v66
    v_mul_f32 v51, v51, v67
    v_mul_f32 v52, v52, v68
    v_mul_f32 v53, v53, v69
    v_mul_f32 v54, v54, v70
    v_mul_f32 v55, v55, v71
    v_cvt_pk_bf16_f32 v72, v40, v41
    v_cvt_pk_bf16_f32 v73, v42, v43
    v_cvt_pk_bf16_f32 v74, v44, v45
    v_cvt_pk_bf16_f32 v75, v46, v47
    s_nop 0
    v_permlane16_swap_b32 v72, v74
    v_permlane16_swap_b32 v73, v75
    ds_write_b128 v6, v[72:75] offset:1024
    v_cvt_pk_bf16_f32 v76, v48, v49
    v_cvt_pk_bf16_f32 v77, v50, v51
    v_cvt_pk_bf16_f32 v78, v52, v53
    v_cvt_pk_bf16_f32 v79, v54, v55
    s_nop 0
    v_permlane16_swap_b32 v76, v78
    v_permlane16_swap_b32 v77, v79
    ds_write_b128 v6, v[76:79] offset:37888
    s_setprio 0
    s_lshr_b32 s26, s3, 2
    s_lshl_b32 s26, s26, 2
    v_add_u32 v6, s26, v7
    v_mov_b32 v0, 1
    s_mov_b64 exec, 1
    s_waitcnt lgkmcnt(0)
    ds_add_u32 v6, v0
    s_mov_b64 exec, -1
    s_mov_b32 s93, 0x800000
Lgw_62:
    ds_read_b32 v0, v7 offset:0
    s_waitcnt lgkmcnt(0)
    v_readfirstlane_b32 s26, v0
    s_nop 0
    s_cmp_ge_u32 s26, 4
    s_cbranch_scc1 Lgd_63
    s_sleep 2
    s_sub_u32 s93, s93, 1
    s_cbranch_scc0 Lgw_62
Lgd_63:
    ds_read_b128 v[56:59], v1 offset:0
    ds_read_b128 v[60:63], v1 offset:18432
    ds_read_b128 v[64:67], v2 offset:0
    ds_read_b128 v[68:71], v2 offset:18432
    ds_read_b128 v[72:75], v1 offset:1024
    ds_read_b128 v[76:79], v1 offset:19456
    ds_read_b128 v[80:83], v2 offset:1024
    ds_read_b128 v[84:87], v2 offset:19456
    s_waitcnt vmcnt(15) lgkmcnt(4)
    v_mfma_f32_16x16x32_bf16 v[8:11], v[88:91], v[56:59], 0
    v_mfma_f32_16x16x32_bf16 v[12:15], v[88:91], v[60:63], 0
    v_mfma_f32_16x16x32_bf16 v[16:19], v[88:91], v[64:67], 0
    v_mfma_f32_16x16x32_bf16 v[20:23], v[88:91], v[68:71], 0
    v_mfma_f32_16x16x32_bf16 v[24:27], v[92:95], v[56:59], 0
    v_mfma_f32_16x16x32_bf16 v[28:31], v[92:95], v[60:63], 0
    v_mfma_f32_16x16x32_bf16 v[32:35], v[92:95], v[64:67], 0
    v_mfma_f32_16x16x32_bf16 v[36:39], v[92:95], v[68:71], 0
    v_mfma_f32_16x16x32_bf16 v[40:43], v[96:99], v[56:59], 0
    v_mfma_f32_16x16x32_bf16 v[44:47], v[96:99], v[60:63], 0
    v_mfma_f32_16x16x32_bf16 v[48:51], v[96:99], v[64:67], 0
    v_mfma_f32_16x16x32_bf16 v[52:55], v[96:99], v[68:71], 0
    buffer_load_dwordx4 v[88:91], v3, s[12:15], s22 offen offset:0 sc1
    buffer_load_dwordx4 v[92:95], v3, s[12:15], s22 offen offset:1024 sc1
    buffer_load_dwordx4 v[96:99], v3, s[12:15], s22 offen offset:2048 sc1
    s_add_u32 s22, s22, 36864
    ds_read_b128 v[56:59], v1 offset:2048
    ds_read_b128 v[60:63], v1 offset:20480
    ds_read_b128 v[64:67], v2 offset:2048
    ds_read_b128 v[68:71], v2 offset:20480
    s_waitcnt vmcnt(15) lgkmcnt(4)
    v_mfma_f32_16x16x32_bf16 v[8:11], v[100:103], v[72:75], v[8:11]
    v_mfma_f32_16x16x32_bf16 v[12:15], v[100:103], v[76:79], v[12:15]
    v_mfma_f32_16x16x32_bf16 v[16:19], v[100:103], v[80:83], v[16:19]
    v_mfma_f32_16x16x32_bf16 v[20:23], v[100:103], v[84:87], v[20:23]
    v_mfma_f32_16x16x32_bf16 v[24:27], v[104:107], v[72:75], v[24:27]
    v_mfma_f32_16x16x32_bf16 v[28:31], v[104:107], v[76:79], v[28:31]
    v_mfma_f32_16x16x32_bf16 v[32:35], v[104:107], v[80:83], v[32:35]
    v_mfma_f32_16x16x32_bf16 v[36:39], v[104:107], v[84:87], v[36:39]
    v_mfma_f32_16x16x32_bf16 v[40:43], v[108:111], v[72:75], v[40:43]
    v_mfma_f32_16x16x32_bf16 v[44:47], v[108:111], v[76:79], v[44:47]
    v_mfma_f32_16x16x32_bf16 v[48:51], v[108:111], v[80:83], v[48:51]
    v_mfma_f32_16x16x32_bf16 v[52:55], v[108:111], v[84:87], v[52:55]
    buffer_load_dwordx4 v[100:103], v3, s[12:15], s22 offen offset:0 sc1
    buffer_load_dwordx4 v[104:107], v3, s[12:15], s22 offen offset:1024 sc1
    buffer_load_dwordx4 v[108:111], v3, s[12:15], s22 offen offset:2048 sc1
    s_add_u32 s22, s22, 36864
    ds_read_b128 v[72:75], v1 offset:3072
    ds_read_b128 v[76:79], v1 offset:21504
    ds_read_b128 v[80:83], v2 offset:3072
    ds_read_b128 v[84:87], v2 offset:21504
    s_waitcnt vmcnt(15) lgkmcnt(4)
    v_mfma_f32_16x16x32_bf16 v[8:11], v[112:115], v[56:59], v[8:11]
    v_mfma_f32_16x16x32_bf16 v[12:15], v[112:115], v[60:63], v[12:15]
    v_mfma_f32_16x16x32_bf16 v[16:19], v[112:115], v[64:67], v[16:19]
    v_mfma_f32_16x16x32_bf16 v[20:23], v[112:115], v[68:71], v[20:23]
    v_mfma_f32_16x16x32_bf16 v[24:27], v[116:119], v[56:59], v[24:27]
    v_mfma_f32_16x16x32_bf16 v[28:31], v[116:119], v[60:63], v[28:31]
    v_mfma_f32_16x16x32_bf16 v[32:35], v[116:119], v[64:67], v[32:35]
    v_mfma_f32_16x16x32_bf16 v[36:39], v[116:119], v[68:71], v[36:39]
    v_mfma_f32_16x16x32_bf16 v[40:43], v[120:123], v[56:59], v[40:43]
    v_mfma_f32_16x16x32_bf16 v[44:47], v[120:123], v[60:63], v[44:47]
    v_mfma_f32_16x16x32_bf16 v[48:51], v[120:123], v[64:67], v[48:51]
    v_mfma_f32_16x16x32_bf16 v[52:55], v[120:123], v[68:71], v[52:55]
    buffer_load_dwordx4 v[112:115], v3, s[12:15], s22 offen offset:0 sc1
    buffer_load_dwordx4 v[116:119], v3, s[12:15], s22 offen offset:1024 sc1
    buffer_load_dwordx4 v[120:123], v3, s[12:15], s22 offen offset:2048 sc1
    s_add_u32 s22, s22, 36864
    ds_read_b128 v[56:59], v1 offset:4096
    ds_read_b128 v[60:63], v1 offset:22528
    ds_read_b128 v[64:67], v2 offset:4096
    ds_read_b128 v[68:71], v2 offset:22528
    s_waitcnt vmcnt(15) lgkmcnt(4)
    v_mfma_f32_16x16x32_bf16 v[8:11], v[124:127], v[72:75], v[8:11]
    v_mfma_f32_16x16x32_bf16 v[12:15], v[124:127], v[76:79], v[12:15]
    v_mfma_f32_16x16x32_bf16 v[16:19], v[124:127], v[80:83], v[16:19]
    v_mfma_f32_16x16x32_bf16 v[20:23], v[124:127], v[84:87], v[20:23]
    v_mfma_f32_16x16x32_bf16 v[24:27], v[128:131], v[72:75], v[24:27]
    v_mfma_f32_16x16x32_bf16 v[28:31], v[128:131], v[76:79], v[28:31]
    v_mfma_f32_16x16x32_bf16 v[32:35], v[128:131], v[80:83], v[32:35]
    v_mfma_f32_16x16x32_bf16 v[36:39], v[128:131], v[84:87], v[36:39]
    v_mfma_f32_16x16x32_bf16 v[40:43], v[132:135], v[72:75], v[40:43]
    v_mfma_f32_16x16x32_bf16 v[44:47], v[132:135], v[76:79], v[44:47]
    v_mfma_f32_16x16x32_bf16 v[48:51], v[132:135], v[80:83], v[48:51]
    v_mfma_f32_16x16x32_bf16 v[52:55], v[132:135], v[84:87], v[52:55]
    buffer_load_dwordx4 v[124:127], v3, s[12:15], s22 offen offset:0 sc1
    buffer_load_dwordx4 v[128:131], v3, s[12:15], s22 offen offset:1024 sc1
    buffer_load_dwordx4 v[132:135], v3, s[12:15], s22 offen offset:2048 sc1
    s_add_u32 s22, s22, 36864
    ds_read_b128 v[72:75], v1 offset:5120
    ds_read_b128 v[76:79], v1 offset:23552
    ds_read_b128 v[80:83], v2 offset:5120
    ds_read_b128 v[84:87], v2 offset:23552
    s_waitcnt vmcnt(15) lgkmcnt(4)
    v_mfma_f32_16x16x32_bf16 v[8:11], v[136:139], v[56:59], v[8:11]
    v_mfma_f32_16x16x32_bf16 v[12:15], v[136:139], v[60:63], v[12:15]
    v_mfma_f32_16x16x32_bf16 v[16:19], v[136:139], v[64:67], v[16:19]
    v_mfma_f32_16x16x32_bf16 v[20:23], v[136:139], v[68:71], v[20:23]
    v_mfma_f32_16x16x32_bf16 v[24:27], v[140:143], v[56:59], v[24:27]
    v_mfma_f32_16x16x32_bf16 v[28:31], v[140:143], v[60:63], v[28:31]
    v_mfma_f32_16x16x32_bf16 v[32:35], v[140:143], v[64:67], v[32:35]
    v_mfma_f32_16x16x32_bf16 v[36:39], v[140:143], v[68:71], v[36:39]
    v_mfma_f32_16x16x32_bf16 v[40:43], v[144:147], v[56:59], v[40:43]
    v_mfma_f32_16x16x32_bf16 v[44:47], v[144:147], v[60:63], v[44:47]
    v_mfma_f32_16x16x32_bf16 v[48:51], v[144:147], v[64:67], v[48:51]
    v_mfma_f32_16x16x32_bf16 v[52:55], v[144:147], v[68:71], v[52:55]
    buffer_load_dwordx4 v[136:139], v3, s[12:15], s22 offen offset:0 sc1
    buffer_load_dwordx4 v[140:143], v3, s[12:15], s22 offen offset:1024 sc1
    buffer_load_dwordx4 v[144:147], v3, s[12:15], s22 offen offset:2048 sc1
    s_add_u32 s22, s22, 36864
    s_waitcnt vmcnt(15) lgkmcnt(0)
    v_mfma_f32_16x16x32_bf16 v[8:11], v[148:151], v[72:75], v[8:11]
    v_mfma_f32_16x16x32_bf16 v[12:15], v[148:151], v[76:79], v[12:15]
    v_mfma_f32_16x16x32_bf16 v[16:19], v[148:151], v[80:83], v[16:19]
    v_mfma_f32_16x16x32_bf16 v[20:23], v[148:151], v[84:87], v[20:23]
    v_mfma_f32_16x16x32_bf16 v[24:27], v[152:155], v[72:75], v[24:27]
    v_mfma_f32_16x16x32_bf16 v[28:31], v[152:155], v[76:79], v[28:31]
    v_mfma_f32_16x16x32_bf16 v[32:35], v[152:155], v[80:83], v[32:35]
    v_mfma_f32_16x16x32_bf16 v[36:39], v[152:155], v[84:87], v[36:39]
    v_mfma_f32_16x16x32_bf16 v[40:43], v[156:159], v[72:75], v[40:43]
    v_mfma_f32_16x16x32_bf16 v[44:47], v[156:159], v[76:79], v[44:47]
    v_mfma_f32_16x16x32_bf16 v[48:51], v[156:159], v[80:83], v[48:51]
    v_mfma_f32_16x16x32_bf16 v[52:55], v[156:159], v[84:87], v[52:55]
    buffer_load_dwordx4 v[148:151], v3, s[12:15], s22 offen offset:0 sc1
    buffer_load_dwordx4 v[152:155], v3, s[12:15], s22 offen offset:1024 sc1
    buffer_load_dwordx4 v[156:159], v3, s[12:15], s22 offen offset:2048 sc1
    s_add_u32 s22, s22, 36864
    s_mov_b32 s93, 0x800000
    s_nop 2
Lgw_64:
    ds_read_b32 v0, v7 offset:4
    s_waitcnt lgkmcnt(0)
    v_readfirstlane_b32 s26, v0
    s_nop 0
    s_cmp_ge_u32 s26, 4
    s_cbranch_scc1 Lgd_65
    s_sleep 2
    s_sub_u32 s93, s93, 1
    s_cbranch_scc0 Lgw_64
Lgd_65:
    ds_read_b128 v[56:59], v1 offset:6144
    ds_read_b128 v[60:63], v1 offset:24576
    ds_read_b128 v[64:67], v2 offset:6144
    ds_read_b128 v[68:71], v2 offset:24576
    ds_read_b128 v[72:75], v1 offset:7168
    ds_read_b128 v[76:79], v1 offset:25600
    ds_read_b128 v[80:83], v2 offset:7168
    ds_read_b128 v[84:87], v2 offset:25600
    s_waitcnt vmcnt(15) lgkmcnt(4)
    v_mfma_f32_16x16x32_bf16 v[8:11], v[88:91], v[56:59], v[8:11]
    v_mfma_f32_16x16x32_bf16 v[12:15], v[88:91], v[60:63], v[12:15]
    v_mfma_f32_16x16x32_bf16 v[16:19], v[88:91], v[64:67], v[16:19]
    v_mfma_f32_16x16x32_bf16 v[20:23], v[88:91], v[68:71], v[20:23]
    v_mfma_f32_16x16x32_bf16 v[24:27], v[92:95], v[56:59], v[24:27]
    v_mfma_f32_16x16x32_bf16 v[28:31], v[92:95], v[60:63], v[28:31]
    v_mfma_f32_16x16x32_bf16 v[32:35], v[92:95], v[64:67], v[32:35]
    v_mfma_f32_16x16x32_bf16 v[36:39], v[92:95], v[68:71], v[36:39]
    v_mfma_f32_16x16x32_bf16 v[40:43], v[96:99], v[56:59], v[40:43]
    v_mfma_f32_16x16x32_bf16 v[44:47], v[96:99], v[60:63], v[44:47]
    v_mfma_f32_16x16x32_bf16 v[48:51], v[96:99], v[64:67], v[48:51]
    v_mfma_f32_16x16x32_bf16 v[52:55], v[96:99], v[68:71], v[52:55]
    buffer_load_dwordx4 v[88:91], v3, s[12:15], s22 offen offset:0 sc1
    buffer_load_dwordx4 v[92:95], v3, s[12:15], s22 offen offset:1024 sc1
    buffer_load_dwordx4 v[96:99], v3, s[12:15], s22 offen offset:2048 sc1
    s_add_u32 s22, s22, 36864
    ds_read_b128 v[56:59], v1 offset:8192
    ds_read_b128 v[60:63], v1 offset:26624
    ds_read_b128 v[64:67], v2 offset:8192
    ds_read_b128 v[68:71], v2 offset:26624
    s_waitcnt vmcnt(15) lgkmcnt(4)
    v_mfma_f32_16x16x32_bf16 v[8:11], v[100:103], v[72:75], v[8:11]
    v_mfma_f32_16x16x32_bf16 v[12:15], v[100:103], v[76:79], v[12:15]
    v_mfma_f32_16x16x32_bf16 v[16:19], v[100:103], v[80:83], v[16:19]
    v_mfma_f32_16x16x32_bf16 v[20:23], v[100:103], v[84:87], v[20:23]
    v_mfma_f32_16x16x32_bf16 v[24:27], v[104:107], v[72:75], v[24:27]
    v_mfma_f32_16x16x32_bf16 v[28:31], v[104:107], v[76:79], v[28:31]
    v_mfma_f32_16x16x32_bf16 v[32:35], v[104:107], v[80:83], v[32:35]
    v_mfma_f32_16x16x32_bf16 v[36:39], v[104:107], v[84:87], v[36:39]
    v_mfma_f32_16x16x32_bf16 v[40:43], v[108:111], v[72:75], v[40:43]
    v_mfma_f32_16x16x32_bf16 v[44:47], v[108:111], v[76:79], v[44:47]
    v_mfma_f32_16x16x32_bf16 v[48:51], v[108:111], v[80:83], v[48:51]
    v_mfma_f32_16x16x32_bf16 v[52:55], v[108:111], v[84:87], v[52:55]
    buffer_load_dwordx4 v[100:103], v3, s[12:15], s22 offen offset:0 sc1
    buffer_load_dwordx4 v[104:107], v3, s[12:15], s22 offen offset:1024 sc1
    buffer_load_dwordx4 v[108:111], v3, s[12:15], s22 offen offset:2048 sc1
    s_add_u32 s22, s22, 36864
    ds_read_b128 v[72:75], v1 offset:9216
    ds_read_b128 v[76:79], v1 offset:27648
    ds_read_b128 v[80:83], v2 offset:9216
    ds_read_b128 v[84:87], v2 offset:27648
    s_waitcnt vmcnt(15) lgkmcnt(4)
    v_mfma_f32_16x16x32_bf16 v[8:11], v[112:115], v[56:59], v[8:11]
    v_mfma_f32_16x16x32_bf16 v[12:15], v[112:115], v[60:63], v[12:15]
    v_mfma_f32_16x16x32_bf16 v[16:19], v[112:115], v[64:67], v[16:19]
    v_mfma_f32_16x16x32_bf16 v[20:23], v[112:115], v[68:71], v[20:23]
    v_mfma_f32_16x16x32_bf16 v[24:27], v[116:119], v[56:59], v[24:27]
    v_mfma_f32_16x16x32_bf16 v[28:31], v[116:119], v[60:63], v[28:31]
    v_mfma_f32_16x16x32_bf16 v[32:35], v[116:119], v[64:67], v[32:35]
    v_mfma_f32_16x16x32_bf16 v[36:39], v[116:119], v[68:71], v[36:39]
    v_mfma_f32_16x16x32_bf16 v[40:43], v[120:123], v[56:59], v[40:43]
    v_mfma_f32_16x16x32_bf16 v[44:47], v[120:123], v[60:63], v[44:47]
    v_mfma_f32_16x16x32_bf16 v[48:51], v[120:123], v[64:67], v[48:51]
    v_mfma_f32_16x16x32_bf16 v[52:55], v[120:123], v[68:71], v[52:55]
    buffer_load_dwordx4 v[112:115], v3, s[12:15], s22 offen offset:0 sc1
    buffer_load_dwordx4 v[116:119], v3, s[12:15], s22 offen offset:1024 sc1
    buffer_load_dwordx4 v[120:123], v3, s[12:15], s22 offen offset:2048 sc1
    s_add_u32 s22, s22, 36864
    ds_read_b128 v[56:59], v1 offset:10240
    ds_read_b128 v[60:63], v1 offset:28672
    ds_read_b128 v[64:67], v2 offset:10240
    ds_read_b128 v[68:71], v2 offset:28672
    s_waitcnt vmcnt(15) lgkmcnt(4)
    v_mfma_f32_16x16x32_bf16 v[8:11], v[124:127], v[72:75], v[8:11]
    v_mfma_f32_16x16x32_bf16 v[12:15], v[124:127], v[76:79], v[12:15]
    v_mfma_f32_16x16x32_bf16 v[16:19], v[124:127], v[80:83], v[16:19]
    v_mfma_f32_16x16x32_bf16 v[20:23], v[124:127], v[84:87], v[20:23]
    v_mfma_f32_16x16x32_bf16 v[24:27], v[128:131], v[72:75], v[24:27]
    v_mfma_f32_16x16x32_bf16 v[28:31], v[128:131], v[76:79], v[28:31]
    v_mfma_f32_16x16x32_bf16 v[32:35], v[128:131], v[80:83], v[32:35]
    v_mfma_f32_16x16x32_bf16 v[36:39], v[128:131], v[84:87], v[36:39]
    v_mfma_f32_16x16x32_bf16 v[40:43], v[132:135], v[72:75], v[40:43]
    v_mfma_f32_16x16x32_bf16 v[44:47], v[132:135], v[76:79], v[44:47]
    v_mfma_f32_16x16x32_bf16 v[48:51], v[132:135], v[80:83], v[48:51]
    v_mfma_f32_16x16x32_bf16 v[52:55], v[132:135], v[84:87], v[52:55]
    buffer_load_dwordx4 v[124:127], v3, s[12:15], s22 offen offset:0 sc1
    buffer_load_dwordx4 v[128:131], v3, s[12:15], s22 offen offset:1024 sc1
    buffer_load_dwordx4 v[132:135], v3, s[12:15], s22 offen offset:2048 sc1
    s_add_u32 s22, s22, 36864
    ds_read_b128 v[72:75], v1 offset:11264
    ds_read_b128 v[76:79], v1 offset:29696
    ds_read_b128 v[80:83], v2 offset:11264
    ds_read_b128 v[84:87], v2 offset:29696
    s_waitcnt vmcnt(15) lgkmcnt(4)
    v_mfma_f32_16x16x32_bf16 v[8:11], v[136:139], v[56:59], v[8:11]
    v_mfma_f32_16x16x32_bf16 v[12:15], v[136:139], v[60:63], v[12:15]
    v_mfma_f32_16x16x32_bf16 v[16:19], v[136:139], v[64:67], v[16:19]
    v_mfma_f32_16x16x32_bf16 v[20:23], v[136:139], v[68:71], v[20:23]
    v_mfma_f32_16x16x32_bf16 v[24:27], v[140:143], v[56:59], v[24:27]
    v_mfma_f32_16x16x32_bf16 v[28:31], v[140:143], v[60:63], v[28:31]
    v_mfma_f32_16x16x32_bf16 v[32:35], v[140:143], v[64:67], v[32:35]
    v_mfma_f32_16x16x32_bf16 v[36:39], v[140:143], v[68:71], v[36:39]
    v_mfma_f32_16x16x32_bf16 v[40:43], v[144:147], v[56:59], v[40:43]
    v_mfma_f32_16x16x32_bf16 v[44:47], v[144:147], v[60:63], v[44:47]
    v_mfma_f32_16x16x32_bf16 v[48:51], v[144:147], v[64:67], v[48:51]
    v_mfma_f32_16x16x32_bf16 v[52:55], v[144:147], v[68:71], v[52:55]
    buffer_load_dwordx4 v[136:139], v3, s[12:15], s22 offen offset:0 sc1
    buffer_load_dwordx4 v[140:143], v3, s[12:15], s22 offen offset:1024 sc1
    buffer_load_dwordx4 v[144:147], v3, s[12:15], s22 offen offset:2048 sc1
    s_add_u32 s22, s22, 36864
    s_waitcnt vmcnt(15) lgkmcnt(0)
    v_mfma_f32_16x16x32_bf16 v[8:11], v[148:151], v[72:75], v[8:11]
    v_mfma_f32_16x16x32_bf16 v[12:15], v[148:151], v[76:79], v[12:15]
    v_mfma_f32_16x16x32_bf16 v[16:19], v[148:151], v[80:83], v[16:19]
    v_mfma_f32_16x16x32_bf16 v[20:23], v[148:151], v[84:87], v[20:23]
    v_mfma_f32_16x16x32_bf16 v[24:27], v[152:155], v[72:75], v[24:27]
    v_mfma_f32_16x16x32_bf16 v[28:31], v[152:155], v[76:79], v[28:31]
    v_mfma_f32_16x16x32_bf16 v[32:35], v[152:155], v[80:83], v[32:35]
    v_mfma_f32_16x16x32_bf16 v[36:39], v[152:155], v[84:87], v[36:39]
    v_mfma_f32_16x16x32_bf16 v[40:43], v[156:159], v[72:75], v[40:43]
    v_mfma_f32_16x16x32_bf16 v[44:47], v[156:159], v[76:79], v[44:47]
    v_mfma_f32_16x16x32_bf16 v[48:51], v[156:159], v[80:83], v[48:51]
    v_mfma_f32_16x16x32_bf16 v[52:55], v[156:159], v[84:87], v[52:55]
    buffer_load_dwordx4 v[148:151], v3, s[12:15], s22 offen offset:0 sc1
    buffer_load_dwordx4 v[152:155], v3, s[12:15], s22 offen offset:1024 sc1
    buffer_load_dwordx4 v[156:159], v3, s[12:15], s22 offen offset:2048 sc1
    s_add_u32 s22, s22, 36864
    s_mov_b32 s93, 0x800000
    s_nop 2
Lgw_66:
    ds_read_b32 v0, v7 offset:8
    s_waitcnt lgkmcnt(0)
    v_readfirstlane_b32 s26, v0
    s_nop 0
    s_cmp_ge_u32 s26, 4
    s_cbranch_scc1 Lgd_67
    s_sleep 2
    s_sub_u32 s93, s93, 1
    s_cbranch_scc0 Lgw_66
Lgd_67:
    ds_read_b128 v[56:59], v1 offset:12288
    ds_read_b128 v[60:63], v1 offset:30720
    ds_read_b128 v[64:67], v2 offset:12288
    ds_read_b128 v[68:71], v2 offset:30720
    ds_read_b128 v[72:75], v1 offset:13312
    ds_read_b128 v[76:79], v1 offset:31744
    ds_read_b128 v[80:83], v2 offset:13312
    ds_read_b128 v[84:87], v2 offset:31744
    s_waitcnt vmcnt(15) lgkmcnt(4)
    v_mfma_f32_16x16x32_bf16 v[8:11], v[88:91], v[56:59], v[8:11]
    v_mfma_f32_16x16x32_bf16 v[12:15], v[88:91], v[60:63], v[12:15]
    v_mfma_f32_16x16x32_bf16 v[16:19], v[88:91], v[64:67], v[16:19]
    v_mfma_f32_16x16x32_bf16 v[20:23], v[88:91], v[68:71], v[20:23]
    v_mfma_f32_16x16x32_bf16 v[24:27], v[92:95], v[56:59], v[24:27]
    v_mfma_f32_16x16x32_bf16 v[28:31], v[92:95], v[60:63], v[28:31]
    v_mfma_f32_16x16x32_bf16 v[32:35], v[92:95], v[64:67], v[32:35]
    v_mfma_f32_16x16x32_bf16 v[36:39], v[92:95], v[68:71], v[36:39]
    v_mfma_f32_16x16x32_bf16 v[40:43], v[96:99], v[56:59], v[40:43]
    v_mfma_f32_16x16x32_bf16 v[44:47], v[96:99], v[60:63], v[44:47]
    v_mfma_f32_16x16x32_bf16 v[48:51], v[96:99], v[64:67], v[48:51]
    v_mfma_f32_16x16x32_bf16 v[52:55], v[96:99], v[68:71], v[52:55]
    ds_read_b128 v[56:59], v1 offset:14336
    ds_read_b128 v[60:63], v1 offset:32768
    ds_read_b128 v[64:67], v2 offset:14336
    ds_read_b128 v[68:71], v2 offset:32768
    s_waitcnt vmcnt(12) lgkmcnt(4)
    v_mfma_f32_16x16x32_bf16 v[8:11], v[100:103], v[72:75], v[8:11]
    v_mfma_f32_16x16x32_bf16 v[12:15], v[100:103], v[76:79], v[12:15]
    v_mfma_f32_16x16x32_bf16 v[16:19], v[100:103], v[80:83], v[16:19]
    v_mfma_f32_16x16x32_bf16 v[20:23], v[100:103], v[84:87], v[20:23]
    v_mfma_f32_16x16x32_bf16 v[24:27], v[104:107], v[72:75], v[24:27]
    v_mfma_f32_16x16x32_bf16 v[28:31], v[104:107], v[76:79], v[28:31]
    v_mfma_f32_16x16x32_bf16 v[32:35], v[104:107], v[80:83], v[32:35]
    v_mfma_f32_16x16x32_bf16 v[36:39], v[104:107], v[84:87], v[36:39]
    v_mfma_f32_16x16x32_bf16 v[40:43], v[108:111], v[72:75], v[40:43]
    v_mfma_f32_16x16x32_bf16 v[44:47], v[108:111], v[76:79], v[44:47]
    v_mfma_f32_16x16x32_bf16 v[48:51], v[108:111], v[80:83], v[48:51]
    v_mfma_f32_16x16x32_bf16 v[52:55], v[108:111], v[84:87], v[52:55]
    ds_read_b128 v[72:75], v1 offset:15360
    ds_read_b128 v[76:79], v1 offset:33792
    ds_read_b128 v[80:83], v2 offset:15360
    ds_read_b128 v[84:87], v2 offset:33792
    s_waitcnt vmcnt(9) lgkmcnt(4)
    v_mfma_f32_16x16x32_bf16 v[8:11], v[112:115], v[56:59], v[8:11]
    v_mfma_f32_16x16x32_bf16 v[12:15], v[112:115], v[60:63], v[12:15]
    v_mfma_f32_16x16x32_bf16 v[16:19], v[112:115], v[64:67], v[16:19]
    v_mfma_f32_16x16x32_bf16 v[20:23], v[112:115], v[68:71], v[20:23]
    v_mfma_f32_16x16x32_bf16 v[24:27], v[116:119], v[56:59], v[24:27]
    v_mfma_f32_16x16x32_bf16 v[28:31], v[116:119], v[60:63], v[28:31]
    v_mfma_f32_16x16x32_bf16 v[32:35], v[116:119], v[64:67], v[32:35]
    v_mfma_f32_16x16x32_bf16 v[36:39], v[116:119], v[68:71], v[36:39]
    v_mfma_f32_16x16x32_bf16 v[40:43], v[120:123], v[56:59], v[40:43]
    v_mfma_f32_16x16x32_bf16 v[44:47], v[120:123], v[60:63], v[44:47]
    v_mfma_f32_16x16x32_bf16 v[48:51], v[120:123], v[64:67], v[48:51]
    v_mfma_f32_16x16x32_bf16 v[52:55], v[120:123], v[68:71], v[52:55]
    ds_read_b128 v[56:59], v1 offset:16384
    ds_read_b128 v[60:63], v1 offset:34816
    ds_read_b128 v[64:67], v2 offset:16384
    ds_read_b128 v[68:71], v2 offset:34816
    s_waitcnt vmcnt(6) lgkmcnt(4)
    v_mfma_f32_16x16x32_bf16 v[8:11], v[124:127], v[72:75], v[8:11]
    v_mfma_f32_16x16x32_bf16 v[12:15], v[124:127], v[76:79], v[12:15]
    v_mfma_f32_16x16x32_bf16 v[16:19], v[124:127], v[80:83], v[16:19]
    v_mfma_f32_16x16x32_bf16 v[20:23], v[124:127], v[84:87], v[20:23]
    v_mfma_f32_16x16x32_bf16 v[24:27], v[128:131], v[72:75], v[24:27]
    v_mfma_f32_16x16x32_bf16 v[28:31], v[128:131], v[76:79], v[28:31]
    v_mfma_f32_16x16x32_bf16 v[32:35], v[128:131], v[80:83], v[32:35]
    v_mfma_f32_16x16x32_bf16 v[36:39], v[128:131], v[84:87], v[36:39]
    v_mfma_f32_16x16x32_bf16 v[40:43], v[132:135], v[72:75], v[40:43]
    v_mfma_f32_16x16x32_bf16 v[44:47], v[132:135], v[76:79], v[44:47]
    v_mfma_f32_16x16x32_bf16 v[48:51], v[132:135], v[80:83], v[48:51]
    v_mfma_f32_16x16x32_bf16 v[52:55], v[132:135], v[84:87], v[52:55]
    ds_read_b128 v[72:75], v1 offset:17408
    ds_read_b128 v[76:79], v1 offset:35840
    ds_read_b128 v[80:83], v2 offset:17408
    ds_read_b128 v[84:87], v2 offset:35840
    s_waitcnt vmcnt(3) lgkmcnt(4)
    v_mfma_f32_16x16x32_bf16 v[8:11], v[136:139], v[56:59], v[8:11]
    v_mfma_f32_16x16x32_bf16 v[12:15], v[136:139], v[60:63], v[12:15]
    v_mfma_f32_16x16x32_bf16 v[16:19], v[136:139], v[64:67], v[16:19]
    v_mfma_f32_16x16x32_bf16 v[20:23], v[136:139], v[68:71], v[20:23]
    v_mfma_f32_16x16x32_bf16 v[24:27], v[140:143], v[56:59], v[24:27]
    v_mfma_f32_16x16x32_bf16 v[28:31], v[140:143], v[60:63], v[28:31]
    v_mfma_f32_16x16x32_bf16 v[32:35], v[140:143], v[64:67], v[32:35]
    v_mfma_f32_16x16x32_bf16 v[36:39], v[140:143], v[68:71], v[36:39]
    v_mfma_f32_16x16x32_bf16 v[40:43], v[144:147], v[56:59], v[40:43]
    v_mfma_f32_16x16x32_bf16 v[44:47], v[144:147], v[60:63], v[44:47]
    v_mfma_f32_16x16x32_bf16 v[48:51], v[144:147], v[64:67], v[48:51]
    v_mfma_f32_16x16x32_bf16 v[52:55], v[144:147], v[68:71], v[52:55]
    s_waitcnt vmcnt(0) lgkmcnt(0)
    v_mfma_f32_16x16x32_bf16 v[8:11], v[148:151], v[72:75], v[8:11]
    v_mfma_f32_16x16x32_bf16 v[12:15], v[148:151], v[76:79], v[12:15]
    v_mfma_f32_16x16x32_bf16 v[16:19], v[148:151], v[80:83], v[16:19]
    v_mfma_f32_16x16x32_bf16 v[20:23], v[148:151], v[84:87], v[20:23]
    v_mfma_f32_16x16x32_bf16 v[24:27], v[152:155], v[72:75], v[24:27]
    v_mfma_f32_16x16x32_bf16 v[28:31], v[152:155], v[76:79], v[28:31]
    v_mfma_f32_16x16x32_bf16 v[32:35], v[152:155], v[80:83], v[32:35]
    v_mfma_f32_16x16x32_bf16 v[36:39], v[152:155], v[84:87], v[36:39]
    v_mfma_f32_16x16x32_bf16 v[40:43], v[156:159], v[72:75], v[40:43]
    v_mfma_f32_16x16x32_bf16 v[44:47], v[156:159], v[76:79], v[44:47]
    v_mfma_f32_16x16x32_bf16 v[48:51], v[156:159], v[80:83], v[48:51]
    v_mfma_f32_16x16x32_bf16 v[52:55], v[156:159], v[84:87], v[52:55]
    s_mov_b64 exec, 1
    v_mov_b32 v0, 1
    ds_add_u32 v7, v0 offset:24
    s_mov_b64 exec, -1
    v_cvt_pk_bf16_f32 v56, v8, v9
    v_cvt_pk_bf16_f32 v57, v10, v11
    v_cvt_pk_bf16_f32 v58, v12, v13
    v_cvt_pk_bf16_f32 v59, v14, v15
    s_nop 0
    v_permlane16_swap_b32 v56, v58
    v_permlane16_swap_b32 v57, v59
    buffer_store_dwordx4 v[56:59], v5, s[12:15], s24 offen offset:0 sc1
    v_cvt_pk_bf16_f32 v60, v16, v17
    v_cvt_pk_bf16_f32 v61, v18, v19
    v_cvt_pk_bf16_f32 v62, v20, v21
    v_cvt_pk_bf16_f32 v63, v22, v23
    s_nop 0
    v_permlane16_swap_b32 v60, v62
    v_permlane16_swap_b32 v61, v63
    buffer_store_dwordx4 v[60:63], v5, s[12:15], s25 offen offset:0 sc1
    v_cvt_pk_bf16_f32 v64, v24, v25
    v_cvt_pk_bf16_f32 v65, v26, v27
    v_cvt_pk_bf16_f32 v66, v28, v29
    v_cvt_pk_bf16_f32 v67, v30, v31
    s_nop 0
    v_permlane16_swap_b32 v64, v66
    v_permlane16_swap_b32 v65, v67
    buffer_store_dwordx4 v[64:67], v5, s[12:15], s24 offen offset:512 sc1
    v_cvt_pk_bf16_f32 v68, v32, v33
    v_cvt_pk_bf16_f32 v69, v34, v35
    v_cvt_pk_bf16_f32 v70, v36, v37
    v_cvt_pk_bf16_f32 v71, v38, v39
    s_nop 0
    v_permlane16_swap_b32 v68, v70
    v_permlane16_swap_b32 v69, v71
    buffer_store_dwordx4 v[68:71], v5, s[12:15], s25 offen offset:512 sc1
    v_cvt_pk_bf16_f32 v72, v40, v41
    v_cvt_pk_bf16_f32 v73, v42, v43
    v_cvt_pk_bf16_f32 v74, v44, v45
    v_cvt_pk_bf16_f32 v75, v46, v47
    s_nop 0
    v_permlane16_swap_b32 v72, v74
    v_permlane16_swap_b32 v73, v75
    buffer_store_dwordx4 v[72:75], v5, s[12:15], s24 offen offset:1024 sc1
    v_cvt_pk_bf16_f32 v76, v48, v49
    v_cvt_pk_bf16_f32 v77, v50, v51
    v_cvt_pk_bf16_f32 v78, v52, v53
    v_cvt_pk_bf16_f32 v79, v54, v55
    s_nop 0
    v_permlane16_swap_b32 v76, v78
    v_permlane16_swap_b32 v77, v79
    buffer_store_dwordx4 v[76:79], v5, s[12:15], s25 offen offset:1024 sc1
    s_lshr_b32 s26, s3, 2
    s_and_b32 s27, s3, 3
    s_lshl_b32 s28, s26, 2
    v_add_u32 v6, s28, v7
    v_mov_b32 v8, 1
    v_mov_b32 v10, 0
    s_mul_i32 s28, s16, 3
    s_add_u32 s28, s28, s26
    s_lshl_b32 s28, s28, 7
    s_add_u32 s28, s28, 0x2dd8000
    s_mul_i32 s29, s17, 3
    s_add_u32 s29, s29, s27
    s_mul_i32 s30, s29, 43
    s_lshr_b32 s30, s30, 8
    s_mul_i32 s31, s30, 6
    s_sub_u32 s31, s29, s31
    s_cmp_ge_u32 s31, 3
    s_cselect_b32 s37, 1, 0
    s_mul_i32 s29, s37, 3
    s_sub_u32 s31, s31, s29
    s_lshl_b32 s31, s31, 1
    s_mul_i32 s29, s26, 6
    s_add_u32 s31, s31, s29
    s_mul_i32 s29, s30, 18432
    s_add_u32 s29, s29, s18
    s_lshl_b32 s32, s31, 6
    s_add_u32 s32, s32, s29
    s_mul_i32 s30, s37, 9216
    s_add_u32 s32, s32, s30
    s_lshl_b32 s31, s31, 10
    s_add_u32 s29, s29, s31
    s_lshl_b32 s30, s37, 7
    s_add_u32 s29, s29, s30
    s_add_u32 s33, s29, 0x480000
    s_mov_b64 exec, 1
    s_waitcnt vmcnt(0)
    ds_add_rtn_u32 v9, v6, v8 offset:12
    s_waitcnt lgkmcnt(0)
    v_readfirstlane_b32 s34, v9
    s_nop 0
    s_cmp_lg_u32 s34, 3
    s_cbranch_scc1 Lnosig_68
    s_lshl_b32 s36, s17, 4
    s_add_u32 s36, s36, s28
    buffer_store_dword v8, v10, s[12:15], s36 offen sc1
Lnosig_68:
    s_mov_b64 exec, -1
    s_cmp_eq_u32 s27, 3
    s_cbranch_scc1 Ldone_69
    v_lshrrev_b32 v11, 4, v3
    s_lshl_b32 s35, s3, 10
    v_and_b32 v12, 7, v11
    v_lshrrev_b32 v15, 3, v11
    v_lshlrev_b32 v13, 7, v12
    v_xor_b32 v14, v15, v12
    v_lshl_add_u32 v13, v14, 4, v13
    v_add_u32 v40, s35, v13
    v_lshlrev_b32 v13, 7, v15
    v_lshl_add_u32 v13, v14, 4, v13
    v_add_u32 v13, s35, v13
    v_mul_u32_u24 v14, 1152, v15
    v_lshl_add_u32 v14, v12, 4, v14
    v_lshlrev_b32 v15, 8, v15
    v_lshl_add_u32 v41, v12, 4, v15
    v_mov_b32 v12, v40
    s_cmp_eq_u32 s26, 0
    s_cselect_b32 s36, 8, 12
    s_mov_b32 s93, 0x800000
Lgw_70:
    ds_read_b32 v9, v7 offset:24
    s_waitcnt lgkmcnt(0)
    v_readfirstlane_b32 s34, v9
    s_nop 0
    s_cmp_ge_u32 s34, s36
    s_cbranch_scc1 Lgd_71
    s_sleep 8
    s_sub_u32 s93, s93, 1
    s_cbranch_scc0 Lgw_70
Lgd_71:
    buffer_load_dwordx4 v[120:123], v41, s[12:15], s33 offen sc1
    v_lshrrev_b32 v10, 4, v3
    v_lshlrev_b32 v10, 4, v10
    s_mov_b64 exec, 0xff
    s_mov_b32 s93, 0x1fffff
Lpoll_74:
    buffer_load_dword v9, v10, s[12:15], s28 offen sc1
    s_and_b32 s92, s93, 63
    s_cbranch_scc1 Lchk_76
    s_waitcnt vmcnt(0)
    v_mov_b32 v9, 0
    buffer_atomic_or v9, v10, s[12:15], s28 offen sc0 sc1
Lchk_76:
    s_waitcnt vmcnt(0)
    v_cmp_eq_u32 vcc, 0, v9
    s_nop 4
    s_cbranch_vccz Lgo_75
    s_mov_b64 exec, vcc
    s_sleep 4
    s_sub_u32 s93, s93, 1
    s_cbranch_scc0 Lpoll_74
Lgo_75:
    s_mov_b64 exec, -1
    s_add_u32 s29, s29, 0x1bc6000
    buffer_load_dwordx4 v[88:91], v41, s[12:15], s29 offen sc1
    s_add_u32 s29, s29, 0x240000
    buffer_load_dwordx4 v[92:95], v41, s[12:15], s29 offen sc1
    s_add_u32 s29, s29, 0x240000
    buffer_load_dwordx4 v[96:99], v41, s[12:15], s29 offen sc1
    s_add_u32 s29, s29, 0x240000
    buffer_load_dwordx4 v[100:103], v41, s[12:15], s29 offen sc1
    s_add_u32 s29, s29, 0x240000
    buffer_load_dwordx4 v[104:107], v41, s[12:15], s29 offen sc1
    s_add_u32 s29, s29, 0x240000
    buffer_load_dwordx4 v[108:111], v41, s[12:15], s29 offen sc1
    s_add_u32 s29, s29, 0x240000
    buffer_load_dwordx4 v[112:115], v41, s[12:15], s29 offen sc1
    s_add_u32 s29, s29, 0x240000
    buffer_load_dwordx4 v[116:119], v41, s[12:15], s29 offen sc1
    s_mov_b32 s31, 0xffff0000
    v_lshlrev_b32 v16, 16, v120
    v_and_b32 v17, s31, v120
    v_lshlrev_b32 v18, 16, v121
    v_and_b32 v19, s31, v121
    v_lshlrev_b32 v20, 16, v122
    v_and_b32 v21, s31, v122
    v_lshlrev_b32 v22, 16, v123
    v_and_b32 v23, s31, v123
    s_waitcnt vmcnt(7)
    v_lshlrev_b32 v24, 16, v88
    v_and_b32 v25, s31, v88
    v_lshlrev_b32 v26, 16, v89
    v_and_b32 v27, s31, v89
    v_lshlrev_b32 v28, 16, v90
    v_and_b32 v29, s31, v90
    v_lshlrev_b32 v30, 16, v91
    v_and_b32 v31, s31, v91
    v_add_f32 v16, v16, v24
    v_add_f32 v17, v17, v25
    v_add_f32 v18, v18, v26
    v_add_f32 v19, v19, v27
    v_add_f32 v20, v20, v28
    v_add_f32 v21, v21, v29
    v_add_f32 v22, v22, v30
    v_add_f32 v23, v23, v31
    s_waitcnt vmcnt(6)
    v_lshlrev_b32 v24, 16, v92
    v_and_b32 v25, s31, v92
    v_lshlrev_b32 v26, 16, v93
    v_and_b32 v27, s31, v93
    v_lshlrev_b32 v28, 16, v94
    v_and_b32 v29, s31, v94
    v_lshlrev_b32 v30, 16, v95
    v_and_b32 v31, s31, v95
    v_add_f32 v16, v16, v24
    v_add_f32 v17, v17, v25
    v_add_f32 v18, v18, v26
    v_add_f32 v19, v19, v27
    v_add_f32 v20, v20, v28
    v_add_f32 v21, v21, v29
    v_add_f32 v22, v22, v30
    v_add_f32 v23, v23, v31
    s_waitcnt vmcnt(5)
    v_lshlrev_b32 v24, 16, v96
    v_and_b32 v25, s31, v96
    v_lshlrev_b32 v26, 16, v97
    v_and_b32 v27, s31, v97
    v_lshlrev_b32 v28, 16, v98
    v_and_b32 v29, s31, v98
    v_lshlrev_b32 v30, 16, v99
    v_and_b32 v31, s31, v99
    v_add_f32 v16, v16, v24
    v_add_f32 v17, v17, v25
    v_add_f32 v18, v18, v26
    v_add_f32 v19, v19, v27
    v_add_f32 v20, v20, v28
    v_add_f32 v21, v21, v29
    v_add_f32 v22, v22, v30
    v_add_f32 v23, v23, v31
    s_waitcnt vmcnt(4)
    v_lshlrev_b32 v24, 16, v100
    v_and_b32 v25, s31, v100
    v_lshlrev_b32 v26, 16, v101
    v_and_b32 v27, s31, v101
    v_lshlrev_b32 v28, 16, v102
    v_and_b32 v29, s31, v102
    v_lshlrev_b32 v30, 16, v103
    v_and_b32 v31, s31, v103
    v_add_f32 v16, v16, v24
    v_add_f32 v17, v17, v25
    v_add_f32 v18, v18, v26
    v_add_f32 v19, v19, v27
    v_add_f32 v20, v20, v28
    v_add_f32 v21, v21, v29
    v_add_f32 v22, v22, v30
    v_add_f32 v23, v23, v31
    s_waitcnt vmcnt(3)
    v_lshlrev_b32 v24, 16, v104
    v_and_b32 v25, s31, v104
    v_lshlrev_b32 v26, 16, v105
    v_and_b32 v27, s31, v105
    v_lshlrev_b32 v28, 16, v106
    v_and_b32 v29, s31, v106
    v_lshlrev_b32 v30, 16, v107
    v_and_b32 v31, s31, v107
    v_add_f32 v16, v16, v24
    v_add_f32 v17, v17, v25
    v_add_f32 v18, v18, v26
    v_add_f32 v19, v19, v27
    v_add_f32 v20, v20, v28
    v_add_f32 v21, v21, v29
    v_add_f32 v22, v22, v30
    v_add_f32 v23, v23, v31
    s_waitcnt vmcnt(2)
    v_lshlrev_b32 v24, 16, v108
    v_and_b32 v25, s31, v108
    v_lshlrev_b32 v26, 16, v109
    v_and_b32 v27, s31, v109
    v_lshlrev_b32 v28, 16, v110
    v_and_b32 v29, s31, v110
    v_lshlrev_b32 v30, 16, v111
    v_and_b32 v31, s31, v111
    v_add_f32 v16, v16, v24
    v_add_f32 v17, v17, v25
    v_add_f32 v18, v18, v26
    v_add_f32 v19, v19, v27
    v_add_f32 v20, v20, v28
    v_add_f32 v21, v21, v29
    v_add_f32 v22, v22, v30
    v_add_f32 v23, v23, v31
    s_waitcnt vmcnt(1)
    v_lshlrev_b32 v24, 16, v112
    v_and_b32 v25, s31, v112
    v_lshlrev_b32 v26, 16, v113
    v_and_b32 v27, s31, v113
    v_lshlrev_b32 v28, 16, v114
    v_and_b32 v29, s31, v114
    v_lshlrev_b32 v30, 16, v115
    v_and_b32 v31, s31, v115
    v_add_f32 v16, v16, v24
    v_add_f32 v17, v17, v25
    v_add_f32 v18, v18, v26
    v_add_f32 v19, v19, v27
    v_add_f32 v20, v20, v28
    v_add_f32 v21, v21, v29
    v_add_f32 v22, v22, v30
    v_add_f32 v23, v23, v31
    s_waitcnt vmcnt(0)
    v_lshlrev_b32 v24, 16, v116
    v_and_b32 v25, s31, v116
    v_lshlrev_b32 v26, 16, v117
    v_and_b32 v27, s31, v117
    v_lshlrev_b32 v28, 16, v118
    v_and_b32 v29, s31, v118
    v_lshlrev_b32 v30, 16, v119
    v_and_b32 v31, s31, v119
    v_add_f32 v16, v16, v24
    v_add_f32 v17, v17, v25
    v_add_f32 v18, v18, v26
    v_add_f32 v19, v19, v27
    v_add_f32 v20, v20, v28
    v_add_f32 v21, v21, v29
    v_add_f32 v22, v22, v30
    v_add_f32 v23, v23, v31
    v_cvt_pk_bf16_f32 v32, v16, v17
    v_cvt_pk_bf16_f32 v33, v18, v19
    v_cvt_pk_bf16_f32 v34, v20, v21
    v_cvt_pk_bf16_f32 v35, v22, v23
    ds_write_b128 v12, v[32:35]
    s_waitcnt lgkmcnt(0)
    ds_read_b128 v[36:39], v13
    s_waitcnt lgkmcnt(0)
    buffer_store_dwordx4 v[36:39], v14, s[8:11], s32 offen sc1
Ldone_69:
    s_cmp_lg_u32 s2, 255
    s_cbranch_scc1 Lz_77
    s_cmp_lg_u32 s3, 3
    s_cbranch_scc1 Lz_77
    v_lshrrev_b32 v10, 4, v3
    v_lshlrev_b32 v10, 5, v10
    s_mov_b32 s28, 0x2dee800
    s_mov_b32 s93, 0x1fffff
Lpoll_78:
    buffer_load_dword v9, v10, s[12:15], s28 offen sc1
    s_and_b32 s92, s93, 63
    s_cbranch_scc1 Lchk_80
    s_waitcnt vmcnt(0)
    v_mov_b32 v9, 0
    buffer_atomic_or v9, v10, s[12:15], s28 offen sc0 sc1
Lchk_80:
    s_waitcnt vmcnt(0)
    v_cmp_eq_u32 vcc, 0, v9
    s_nop 4
    s_cbranch_vccz Lgo_79
    s_mov_b64 exec, vcc
    s_sleep 8
    s_sub_u32 s93, s93, 1
    s_cbranch_scc0 Lpoll_78
Lgo_79:
    s_mov_b64 exec, -1
    s_add_u32 s28, s28, 2048
    s_mov_b32 s93, 0x1fffff
Lpoll_81:
    buffer_load_dword v9, v10, s[12:15], s28 offen sc1
    s_and_b32 s92, s93, 63
    s_cbranch_scc1 Lchk_83
    s_waitcnt vmcnt(0)
    v_mov_b32 v9, 0
    buffer_atomic_or v9, v10, s[12:15], s28 offen sc0 sc1
Lchk_83:
    s_waitcnt vmcnt(0)
    v_cmp_eq_u32 vcc, 0, v9
    s_nop 4
    s_cbranch_vccz Lgo_82
    s_mov_b64 exec, vcc
    s_sleep 8
    s_sub_u32 s93, s93, 1
    s_cbranch_scc0 Lpoll_81
Lgo_82:
    s_mov_b64 exec, -1
    s_add_u32 s28, s28, 2048
    s_mov_b32 s93, 0x1fffff
Lpoll_84:
    buffer_load_dword v9, v10, s[12:15], s28 offen sc1
    s_and_b32 s92, s93, 63
    s_cbranch_scc1 Lchk_86
    s_waitcnt vmcnt(0)
    v_mov_b32 v9, 0
    buffer_atomic_or v9, v10, s[12:15], s28 offen sc0 sc1
Lchk_86:
    s_waitcnt vmcnt(0)
    v_cmp_eq_u32 vcc, 0, v9
    s_nop 4
    s_cbranch_vccz Lgo_85
    s_mov_b64 exec, vcc
    s_sleep 8
    s_sub_u32 s93, s93, 1
    s_cbranch_scc0 Lpoll_84
Lgo_85:
    s_mov_b64 exec, -1
    s_add_u32 s28, s28, 2048
    s_mov_b32 s93, 0x1fffff
Lpoll_87:
    buffer_load_dword v9, v10, s[12:15], s28 offen sc1
    s_and_b32 s92, s93, 63
    s_cbranch_scc1 Lchk_89
    s_waitcnt vmcnt(0)
    v_mov_b32 v9, 0
    buffer_atomic_or v9, v10, s[12:15], s28 offen sc0 sc1
Lchk_89:
    s_waitcnt vmcnt(0)
    v_cmp_eq_u32 vcc, 0, v9
    s_nop 4
    s_cbranch_vccz Lgo_88
    s_mov_b64 exec, vcc
    s_sleep 8
    s_sub_u32 s93, s93, 1
    s_cbranch_scc0 Lpoll_87
Lgo_88:
    s_mov_b64 exec, -1
    s_add_u32 s28, s28, 2048
    v_lshrrev_b32 v10, 2, v3
    v_mov_b32 v9, 0
    buffer_store_dword v9, v10, s[4:7], 0 offen sc1
Lz_77:
K3_exit:
    s_endpgm
CODE_END:
.section .rodata,"a"
.p2align 6
.amdhsa_kernel sequential_preLN__spectral_gfnet__mixer_s_mlp__prompt_kernel
  .amdhsa_next_free_vgpr 168
  .amdhsa_next_free_sgpr 96
  .amdhsa_accum_offset 168
  .amdhsa_group_segment_fixed_size 0
  .amdhsa_kernarg_size 88
  .amdhsa_user_sgpr_count 2
  .amdhsa_user_sgpr_kernarg_segment_ptr 1
  .amdhsa_system_sgpr_workgroup_id_x 1
.end_amdhsa_kernel
.text
```
